```python
import torch

def _softmax(x, axis=-1):
    return torch.softmax(x, dim=axis)
def _gelu(x):
    return torch.nn.functional.gelu(x, approximate="tanh")
def _silu(x):
    return torch.nn.functional.silu(x)
def _sigmoid(x):
    return torch.sigmoid(x)
def _layernorm(x, axis=-1, eps=1e-5):
    m = x.mean(dim=axis, keepdim=True)
    v = x.var(dim=axis, keepdim=True, unbiased=False)
    return (x - m) / torch.sqrt(v + eps)
def _scatter_add(tgt, idx, src, axis=0):
    return tgt.clone().index_add_(axis, idx, src)
def _segment_sum(src, seg, n):
    out = torch.zeros((n,) + src.shape[1:], dtype=src.dtype)
    return out.index_add_(0, seg, src)
def _pad(x, pw):
    flat = tuple(v for pair in reversed(pw) for v in pair)
    return torch.nn.functional.pad(x, flat)

kernel_name = 'sequential_preLN__ssm_conv_s4__glu_gated_swiglu__prompt'

def setup_inputs():

    _w = (lambda a: (lambda t: t.to(torch.bfloat16) if t.is_floating_point() else t)(torch.as_tensor(a)))
    def _A_setup():
        B, L, D, N = 1, 2048, 576, 128
        A_re = -(lambda _x: torch.exp(torch.as_tensor(_x)))((lambda *s: torch.randn(*s, dtype=torch.bfloat16) * 6.4)(D, N))
        A_im = torch.pi * (lambda *s: torch.randn(*s, dtype=torch.bfloat16) * 0.05)(D, N)
        B_re = (lambda *s: torch.randn(*s, dtype=torch.bfloat16) * 0.05)(D, N)
        B_im = (lambda *s: torch.randn(*s, dtype=torch.bfloat16) * 0.05)(D, N)
        C_re = (lambda *s: torch.randn(*s, dtype=torch.bfloat16) * 0.05)(D, N)
        C_im = (lambda *s: torch.randn(*s, dtype=torch.bfloat16) * 0.05)(D, N)
        log_dt = (lambda *s: torch.randn(*s, dtype=torch.bfloat16) * 0.05)(D) * 0.5 - 4.0
        Dskip = (lambda *s: torch.randn(*s, dtype=torch.bfloat16) * 0.05)(D)
        return {
            "u": _w((lambda *s: torch.randn(*s, dtype=torch.bfloat16) * 0.05)(B, L, D)),
            "A_re": _w(A_re),
            "A_im": _w(A_im),
            "B_re": _w(B_re),
            "B_im": _w(B_im),
            "C_re": _w(C_re),
            "C_im": _w(C_im),
            "log_dt": _w(log_dt),
            "Dskip": _w(Dskip),
        }
    _A_in = _A_setup()

    def _B_setup():
        B, S, D, F = 1, 2048, 576, 4608
        return {
            "x": _w((lambda *s: torch.randn(*s, dtype=torch.bfloat16) * 0.05)(B, S, D)),
            "w1": _w((lambda *s: torch.randn(*s, dtype=torch.bfloat16) * 0.4)(D, F) * (2.0 / D) ** 0.5),
            "w3": _w((lambda *s: torch.randn(*s, dtype=torch.bfloat16) * 0.4)(D, F) * (2.0 / D) ** 0.5),
            "w2": _w((lambda *s: torch.randn(*s, dtype=torch.bfloat16) * 0.4)(F, D) * (2.0 / F) ** 0.5),
        }
    _B_in = _B_setup()

    return {
        "A_u": _A_in["u"],
        "A_A_re": _A_in["A_re"],
        "A_A_im": _A_in["A_im"],
        "A_B_re": _A_in["B_re"],
        "A_B_im": _A_in["B_im"],
        "A_C_re": _A_in["C_re"],
        "A_C_im": _A_in["C_im"],
        "A_log_dt": _A_in["log_dt"],
        "A_Dskip": _A_in["Dskip"],
        "B_x": _B_in["x"],
        "B_w1": _B_in["w1"],
        "B_w3": _B_in["w3"],
        "B_w2": _B_in["w2"],
    }

def reference(A_u, A_A_re, A_A_im, A_B_re, A_B_im, A_C_re, A_C_im, A_log_dt, A_Dskip, B_x, B_w1, B_w3, B_w2):
    def _A_ref(u, A_re, A_im, B_re, B_im, C_re, C_im, log_dt, Dskip):
        Bsz, L, D = u.shape
        dt = torch.exp(log_dt)[:, None]
        A = A_re + 1j * A_im
        Bc = B_re + 1j * B_im
        Cc = C_re + 1j * C_im
        logdA = dt * A
        dB = dt * Bc
        l = (lambda x, dt: x.to(dt))(torch.arange(L), A_re.dtype)
        P = torch.exp(logdA[:, :, None] * l[None, None, :])
        K = torch.einsum("dn,dnl,dn->dl", Cc, P, dB).real
        L2 = 2 * L
        Kp = _pad(K, ((0, 0), (0, L)))
        up = (lambda x, *d: x.permute(*d))(u, 0, 2, 1)
        up = _pad(up, ((0, 0), (0, 0), (0, L)))
        Kf = (lambda x, axes=(-2,-1): torch.fft.rfft2(x.float(), dim=axes))(Kp[:, None, :], axes=(-2, -1))
        Uf = (lambda x, axes=(-2,-1): torch.fft.rfft2(x.float(), dim=axes))(up[:, :, None, :], axes=(-2, -1))
        Yf = Uf * Kf[None, :, :, :]
        y = (lambda x, s, axes=(-2,-1): torch.fft.irfft2(x, s=s, dim=axes).to(torch.bfloat16))(Yf, (1, L2), axes=(-2, -1))[:, :, 0, :L]
        y = (lambda x, *d: x.permute(*d))(y, 0, 2, 1) + u * Dskip[None, None, :]
        return y

    def _B_ref(x, w1, w3, w2):
        gate = torch.einsum("bsd,df->bsf", x, w1)
        up = torch.einsum("bsd,df->bsf", x, w3)
        h = _silu(gate) * up
        out = torch.einsum("bsf,fd->bsd", h, w2)
        return out

    x = A_u
    h = x + _A_ref(_layernorm(x, axis=-1), A_A_re, A_A_im, A_B_re, A_B_im, A_C_re, A_C_im, A_log_dt, A_Dskip)
    h2 = h + _B_ref(_layernorm(h, axis=-1), B_w1, B_w3, B_w2)
    return h2
```

```asm
; @launch kernel=front_kernel grid=(720,1,1) block=(256,1,1) lds=40960
; @launch kernel=gemm1_kernel grid=(256,1,1) block=(512,1,1) lds=139264
; @launch kernel=gemm2_kernel grid=(256,1,1) block=(512,1,1) lds=163840
.amdgcn_target "amdgcn-amd-amdhsa--gfx950"
.text
.globl front_kernel
.p2align 8
.type front_kernel,@function
front_kernel:
    s_cmp_ge_u32 s2, 720
    s_cbranch_scc1 front_kernel_end
    s_cmp_ge_u32 s2, 704
    s_cbranch_scc1 front_kernel_wp
    s_cmp_ge_u32 s2, 128
    s_cbranch_scc1 front_kernel_ch
    s_load_dwordx2 s[44:45], s[0:1], 112
    s_mov_b32 s47, s2
    v_mov_b32 v140, v0
    v_lshrrev_b32 v1, 6, v0
    s_nop 0
    v_readfirstlane_b32 s46, v1
    v_and_b32 v0, 63, v0
    s_and_b32 s4, s2, 7
    s_lshr_b32 s2, s2, 3
    s_lshl_b32 s4, s4, 4
    s_add_u32 s2, s2, s4

    s_setprio 3
    s_load_dwordx2 s[4:5], s[0:1], 0
    s_load_dwordx2 s[6:7], s[0:1], 120
    v_lshrrev_b32 v1, 4, v0
    v_and_b32 v2, 15, v0
    s_lshl_b32 s3, s2, 4
    s_lshl_b32 s26, s46, 2
    s_add_u32 s3, s3, s26
    v_add_u32 v1, s3, v1
    v_mul_u32_u24 v3, 1152, v1
    v_lshl_add_u32 v3, v2, 3, v3
    s_waitcnt lgkmcnt(0)

    s_mov_b32 s8, s4
    s_mov_b32 s9, s5
    s_and_b32 s9, s9, 0xffff
    s_mov_b32 s10, 2359296
    s_mov_b32 s11, 0x00020000
    buffer_load_dwordx2 v[8:9], v3, s[8:11], 0 offen offset:0
    buffer_load_dwordx2 v[10:11], v3, s[8:11], 0 offen offset:128
    buffer_load_dwordx2 v[12:13], v3, s[8:11], 0 offen offset:256
    buffer_load_dwordx2 v[14:15], v3, s[8:11], 0 offen offset:384
    buffer_load_dwordx2 v[16:17], v3, s[8:11], 0 offen offset:512
    buffer_load_dwordx2 v[18:19], v3, s[8:11], 0 offen offset:640
    buffer_load_dwordx2 v[20:21], v3, s[8:11], 0 offen offset:768
    buffer_load_dwordx2 v[22:23], v3, s[8:11], 0 offen offset:896
    buffer_load_dwordx2 v[24:25], v3, s[8:11], 0 offen offset:1024
    s_mov_b32 s12, s6
    s_mov_b32 s13, s7
    s_and_b32 s13, s13, 0xffff
    s_mov_b32 s14, 16384
    s_mov_b32 s15, 0x00020000
    s_add_u32 s28, s6, 50331648
    s_addc_u32 s29, s7, 0
    s_and_b32 s29, s29, 0xffff
    s_mov_b32 s30, 2506752
    s_mov_b32 s31, 0x00020000
    s_mov_b32 s20, 0x3ae38e39
    s_mov_b32 s21, 0x44100000
    s_mov_b32 s22, 0xffff0000
    s_mov_b32 s23, 0x3727c5ac
    v_lshrrev_b32 v126, 4, v0
    v_add_u32 v126, s26, v126
    v_mul_u32_u24 v126, 1184, v126
    v_lshl_add_u32 v126, v2, 3, v126
    v_lshrrev_b32 v4, 4, v0
    v_and_b32 v5, 1, v4
    v_bfe_u32 v6, v0, 2, 2
    v_lshl_add_u32 v5, v5, 3, v6
    v_mul_u32_u24 v127, 1184, v5
    v_lshrrev_b32 v5, 1, v4
    v_lshl_add_u32 v127, v5, 5, v127
    v_and_b32 v6, 3, v0
    v_lshl_add_u32 v127, v6, 3, v127
    s_mul_i32 s27, s46, 288
    v_add_u32 v127, s27, v127
    v_lshl_add_u32 v6, v5, 4, v2
    s_mul_i32 s27, s46, 144
    v_add_u32 v6, s27, v6
    v_mul_u32_u24 v128, 4352, v6
    v_and_b32 v5, 1, v4
    v_lshl_add_u32 v128, v5, 4, v128
    s_lshl_b32 s27, s2, 5
    v_add_u32 v128, s27, v128

    s_waitcnt vmcnt(8)
    v_lshlrev_b32 v44, 16, v8
    v_and_b32 v45, s22, v8
    v_lshlrev_b32 v46, 16, v9
    v_and_b32 v47, s22, v9
    v_pk_add_f32 v[116:117], v[44:45], v[46:47]
    s_waitcnt vmcnt(7)
    v_lshlrev_b32 v48, 16, v10
    v_and_b32 v49, s22, v10
    v_lshlrev_b32 v50, 16, v11
    v_and_b32 v51, s22, v11
    v_pk_add_f32 v[118:119], v[48:49], v[50:51]
    s_waitcnt vmcnt(6)
    v_lshlrev_b32 v52, 16, v12
    v_and_b32 v53, s22, v12
    v_pk_add_f32 v[116:117], v[116:117], v[52:53]
    v_lshlrev_b32 v54, 16, v13
    v_and_b32 v55, s22, v13
    v_pk_add_f32 v[118:119], v[118:119], v[54:55]
    s_waitcnt vmcnt(5)
    v_lshlrev_b32 v56, 16, v14
    v_and_b32 v57, s22, v14
    v_pk_add_f32 v[116:117], v[116:117], v[56:57]
    v_lshlrev_b32 v58, 16, v15
    v_and_b32 v59, s22, v15
    v_pk_add_f32 v[118:119], v[118:119], v[58:59]
    s_waitcnt vmcnt(4)
    v_lshlrev_b32 v60, 16, v16
    v_and_b32 v61, s22, v16
    v_pk_add_f32 v[116:117], v[116:117], v[60:61]
    v_lshlrev_b32 v62, 16, v17
    v_and_b32 v63, s22, v17
    v_pk_add_f32 v[118:119], v[118:119], v[62:63]
    s_waitcnt vmcnt(3)
    v_lshlrev_b32 v64, 16, v18
    v_and_b32 v65, s22, v18
    v_pk_add_f32 v[116:117], v[116:117], v[64:65]
    v_lshlrev_b32 v66, 16, v19
    v_and_b32 v67, s22, v19
    v_pk_add_f32 v[118:119], v[118:119], v[66:67]
    s_waitcnt vmcnt(2)
    v_lshlrev_b32 v68, 16, v20
    v_and_b32 v69, s22, v20
    v_pk_add_f32 v[116:117], v[116:117], v[68:69]
    v_lshlrev_b32 v70, 16, v21
    v_and_b32 v71, s22, v21
    v_pk_add_f32 v[118:119], v[118:119], v[70:71]
    s_waitcnt vmcnt(1)
    v_lshlrev_b32 v72, 16, v22
    v_and_b32 v73, s22, v22
    v_pk_add_f32 v[116:117], v[116:117], v[72:73]
    v_lshlrev_b32 v74, 16, v23
    v_and_b32 v75, s22, v23
    v_pk_add_f32 v[118:119], v[118:119], v[74:75]
    s_waitcnt vmcnt(0)
    v_lshlrev_b32 v76, 16, v24
    v_and_b32 v77, s22, v24
    v_pk_add_f32 v[116:117], v[116:117], v[76:77]
    v_lshlrev_b32 v78, 16, v25
    v_and_b32 v79, s22, v25
    v_pk_add_f32 v[118:119], v[118:119], v[78:79]
    v_pk_add_f32 v[116:117], v[116:117], v[118:119]
    s_nop 0
    v_add_f32 v4, v116, v117
    s_nop 1
    v_add_f32_dpp v5, v4, v4 quad_perm:[1,0,3,2] row_mask:0xf bank_mask:0xf
    s_nop 1
    v_add_f32_dpp v4, v5, v5 quad_perm:[2,3,0,1] row_mask:0xf bank_mask:0xf
    s_nop 1
    v_add_f32_dpp v6, v4, v4 row_half_mirror row_mask:0xf bank_mask:0xf
    s_nop 1
    v_add_f32_dpp v5, v6, v6 row_mirror row_mask:0xf bank_mask:0xf
    v_mul_f32 v4, s20, v5
    v_fma_f32 v6, -v4, s21, v5
    v_fma_f32 v120, v6, s20, v4

    v_pk_add_f32 v[122:123], v[44:45], v[120:121] op_sel_hi:[1,0] neg_lo:[0,1] neg_hi:[0,1]
    v_pk_mul_f32 v[116:117], v[122:123], v[122:123]
    v_pk_add_f32 v[124:125], v[46:47], v[120:121] op_sel_hi:[1,0] neg_lo:[0,1] neg_hi:[0,1]
    v_pk_mul_f32 v[118:119], v[124:125], v[124:125]
    v_pk_add_f32 v[122:123], v[48:49], v[120:121] op_sel_hi:[1,0] neg_lo:[0,1] neg_hi:[0,1]
    v_pk_fma_f32 v[116:117], v[122:123], v[122:123], v[116:117]
    v_pk_add_f32 v[124:125], v[50:51], v[120:121] op_sel_hi:[1,0] neg_lo:[0,1] neg_hi:[0,1]
    v_pk_fma_f32 v[118:119], v[124:125], v[124:125], v[118:119]
    v_pk_add_f32 v[122:123], v[52:53], v[120:121] op_sel_hi:[1,0] neg_lo:[0,1] neg_hi:[0,1]
    v_pk_fma_f32 v[116:117], v[122:123], v[122:123], v[116:117]
    v_pk_add_f32 v[124:125], v[54:55], v[120:121] op_sel_hi:[1,0] neg_lo:[0,1] neg_hi:[0,1]
    v_pk_fma_f32 v[118:119], v[124:125], v[124:125], v[118:119]
    v_pk_add_f32 v[122:123], v[56:57], v[120:121] op_sel_hi:[1,0] neg_lo:[0,1] neg_hi:[0,1]
    v_pk_fma_f32 v[116:117], v[122:123], v[122:123], v[116:117]
    v_pk_add_f32 v[124:125], v[58:59], v[120:121] op_sel_hi:[1,0] neg_lo:[0,1] neg_hi:[0,1]
    v_pk_fma_f32 v[118:119], v[124:125], v[124:125], v[118:119]
    v_pk_add_f32 v[122:123], v[60:61], v[120:121] op_sel_hi:[1,0] neg_lo:[0,1] neg_hi:[0,1]
    v_pk_fma_f32 v[116:117], v[122:123], v[122:123], v[116:117]
    v_pk_add_f32 v[124:125], v[62:63], v[120:121] op_sel_hi:[1,0] neg_lo:[0,1] neg_hi:[0,1]
    v_pk_fma_f32 v[118:119], v[124:125], v[124:125], v[118:119]
    v_pk_add_f32 v[122:123], v[64:65], v[120:121] op_sel_hi:[1,0] neg_lo:[0,1] neg_hi:[0,1]
    v_pk_fma_f32 v[116:117], v[122:123], v[122:123], v[116:117]
    v_pk_add_f32 v[124:125], v[66:67], v[120:121] op_sel_hi:[1,0] neg_lo:[0,1] neg_hi:[0,1]
    v_pk_fma_f32 v[118:119], v[124:125], v[124:125], v[118:119]
    v_pk_add_f32 v[122:123], v[68:69], v[120:121] op_sel_hi:[1,0] neg_lo:[0,1] neg_hi:[0,1]
    v_pk_fma_f32 v[116:117], v[122:123], v[122:123], v[116:117]
    v_pk_add_f32 v[124:125], v[70:71], v[120:121] op_sel_hi:[1,0] neg_lo:[0,1] neg_hi:[0,1]
    v_pk_fma_f32 v[118:119], v[124:125], v[124:125], v[118:119]
    v_pk_add_f32 v[122:123], v[72:73], v[120:121] op_sel_hi:[1,0] neg_lo:[0,1] neg_hi:[0,1]
    v_pk_fma_f32 v[116:117], v[122:123], v[122:123], v[116:117]
    v_pk_add_f32 v[124:125], v[74:75], v[120:121] op_sel_hi:[1,0] neg_lo:[0,1] neg_hi:[0,1]
    v_pk_fma_f32 v[118:119], v[124:125], v[124:125], v[118:119]
    v_pk_add_f32 v[122:123], v[76:77], v[120:121] op_sel_hi:[1,0] neg_lo:[0,1] neg_hi:[0,1]
    v_pk_fma_f32 v[116:117], v[122:123], v[122:123], v[116:117]
    v_pk_add_f32 v[124:125], v[78:79], v[120:121] op_sel_hi:[1,0] neg_lo:[0,1] neg_hi:[0,1]
    v_pk_fma_f32 v[118:119], v[124:125], v[124:125], v[118:119]
    v_pk_add_f32 v[116:117], v[116:117], v[118:119]
    s_nop 0
    v_add_f32 v4, v116, v117
    s_nop 1
    v_add_f32_dpp v5, v4, v4 quad_perm:[1,0,3,2] row_mask:0xf bank_mask:0xf
    s_nop 1
    v_add_f32_dpp v4, v5, v5 quad_perm:[2,3,0,1] row_mask:0xf bank_mask:0xf
    s_nop 1
    v_add_f32_dpp v6, v4, v4 row_half_mirror row_mask:0xf bank_mask:0xf
    s_nop 1
    v_add_f32_dpp v5, v6, v6 row_mirror row_mask:0xf bank_mask:0xf
    v_mul_f32 v4, s20, v5
    v_fma_f32 v6, -v4, s21, v5
    v_fma_f32 v121, v6, s20, v4

    v_cvt_pk_bf16_f32 v4, v120, v121
    v_lshlrev_b32 v120, 16, v4
    v_and_b32 v121, s22, v4
    v_add_f32 v121, s23, v121
    v_cvt_pk_bf16_f32 v4, v121, v121
    v_lshlrev_b32 v121, 16, v4
    v_sqrt_f32 v121, v121
    s_nop 0
    v_cvt_pk_bf16_f32 v4, v121, v121
    v_lshlrev_b32 v121, 16, v4
    v_rcp_f32 v122, v121
    v_lshlrev_b32 v3, 3, v1
    v_cmp_eq_u32 vcc, 0, v2
    s_and_saveexec_b64 s[24:25], vcc
    buffer_store_dwordx2 v[120:121], v3, s[12:15], 0 offen
    s_mov_b64 exec, -1

    v_pk_add_f32 v[44:45], v[44:45], v[120:121] op_sel_hi:[1,0] neg_lo:[0,1] neg_hi:[0,1]
    v_cvt_pk_bf16_f32 v116, v44, v45
    v_lshlrev_b32 v44, 16, v116
    v_and_b32 v45, s22, v116
    v_pk_mul_f32 v[116:117], v[44:45], v[122:123] op_sel_hi:[1,0]
    v_pk_fma_f32 v[118:119], v[116:117], v[120:121], v[44:45] op_sel:[0,1,0] op_sel_hi:[1,1,1] neg_lo:[1,0,0] neg_hi:[1,0,0]
    v_pk_fma_f32 v[116:117], v[118:119], v[122:123], v[116:117] op_sel_hi:[1,0,1]
    v_cvt_pk_bf16_f32 v116, v116, v117
    v_lshlrev_b32 v117, 16, v116
    v_and_b32 v116, s22, v116
    v_cvt_pk_f16_f32 v8, v117, v116

    v_pk_add_f32 v[46:47], v[46:47], v[120:121] op_sel_hi:[1,0] neg_lo:[0,1] neg_hi:[0,1]
    v_cvt_pk_bf16_f32 v4, v46, v47
    v_lshlrev_b32 v46, 16, v4
    v_and_b32 v47, s22, v4
    v_pk_mul_f32 v[4:5], v[46:47], v[122:123] op_sel_hi:[1,0]
    v_pk_fma_f32 v[6:7], v[4:5], v[120:121], v[46:47] op_sel:[0,1,0] op_sel_hi:[1,1,1] neg_lo:[1,0,0] neg_hi:[1,0,0]
    v_pk_fma_f32 v[4:5], v[6:7], v[122:123], v[4:5] op_sel_hi:[1,0,1]
    v_cvt_pk_bf16_f32 v4, v4, v5
    v_lshlrev_b32 v5, 16, v4
    v_and_b32 v4, s22, v4
    v_cvt_pk_f16_f32 v9, v5, v4

    ds_write_b64 v126, v[8:9] offset:0
    v_pk_add_f32 v[48:49], v[48:49], v[120:121] op_sel_hi:[1,0] neg_lo:[0,1] neg_hi:[0,1]
    v_cvt_pk_bf16_f32 v116, v48, v49
    v_lshlrev_b32 v48, 16, v116
    v_and_b32 v49, s22, v116
    v_pk_mul_f32 v[116:117], v[48:49], v[122:123] op_sel_hi:[1,0]
    v_pk_fma_f32 v[118:119], v[116:117], v[120:121], v[48:49] op_sel:[0,1,0] op_sel_hi:[1,1,1] neg_lo:[1,0,0] neg_hi:[1,0,0]
    v_pk_fma_f32 v[116:117], v[118:119], v[122:123], v[116:117] op_sel_hi:[1,0,1]
    v_cvt_pk_bf16_f32 v116, v116, v117
    v_lshlrev_b32 v117, 16, v116
    v_and_b32 v116, s22, v116
    v_cvt_pk_f16_f32 v10, v117, v116

    v_pk_add_f32 v[50:51], v[50:51], v[120:121] op_sel_hi:[1,0] neg_lo:[0,1] neg_hi:[0,1]
    v_cvt_pk_bf16_f32 v4, v50, v51
    v_lshlrev_b32 v50, 16, v4
    v_and_b32 v51, s22, v4
    v_pk_mul_f32 v[4:5], v[50:51], v[122:123] op_sel_hi:[1,0]
    v_pk_fma_f32 v[6:7], v[4:5], v[120:121], v[50:51] op_sel:[0,1,0] op_sel_hi:[1,1,1] neg_lo:[1,0,0] neg_hi:[1,0,0]
    v_pk_fma_f32 v[4:5], v[6:7], v[122:123], v[4:5] op_sel_hi:[1,0,1]
    v_cvt_pk_bf16_f32 v4, v4, v5
    v_lshlrev_b32 v5, 16, v4
    v_and_b32 v4, s22, v4
    v_cvt_pk_f16_f32 v11, v5, v4

    ds_write_b64 v126, v[10:11] offset:128
    v_pk_add_f32 v[52:53], v[52:53], v[120:121] op_sel_hi:[1,0] neg_lo:[0,1] neg_hi:[0,1]
    v_cvt_pk_bf16_f32 v116, v52, v53
    v_lshlrev_b32 v52, 16, v116
    v_and_b32 v53, s22, v116
    v_pk_mul_f32 v[116:117], v[52:53], v[122:123] op_sel_hi:[1,0]
    v_pk_fma_f32 v[118:119], v[116:117], v[120:121], v[52:53] op_sel:[0,1,0] op_sel_hi:[1,1,1] neg_lo:[1,0,0] neg_hi:[1,0,0]
    v_pk_fma_f32 v[116:117], v[118:119], v[122:123], v[116:117] op_sel_hi:[1,0,1]
    v_cvt_pk_bf16_f32 v116, v116, v117
    v_lshlrev_b32 v117, 16, v116
    v_and_b32 v116, s22, v116
    v_cvt_pk_f16_f32 v12, v117, v116

    v_pk_add_f32 v[54:55], v[54:55], v[120:121] op_sel_hi:[1,0] neg_lo:[0,1] neg_hi:[0,1]
    v_cvt_pk_bf16_f32 v4, v54, v55
    v_lshlrev_b32 v54, 16, v4
    v_and_b32 v55, s22, v4
    v_pk_mul_f32 v[4:5], v[54:55], v[122:123] op_sel_hi:[1,0]
    v_pk_fma_f32 v[6:7], v[4:5], v[120:121], v[54:55] op_sel:[0,1,0] op_sel_hi:[1,1,1] neg_lo:[1,0,0] neg_hi:[1,0,0]
    v_pk_fma_f32 v[4:5], v[6:7], v[122:123], v[4:5] op_sel_hi:[1,0,1]
    v_cvt_pk_bf16_f32 v4, v4, v5
    v_lshlrev_b32 v5, 16, v4
    v_and_b32 v4, s22, v4
    v_cvt_pk_f16_f32 v13, v5, v4

    ds_write_b64 v126, v[12:13] offset:256
    v_pk_add_f32 v[56:57], v[56:57], v[120:121] op_sel_hi:[1,0] neg_lo:[0,1] neg_hi:[0,1]
    v_cvt_pk_bf16_f32 v116, v56, v57
    v_lshlrev_b32 v56, 16, v116
    v_and_b32 v57, s22, v116
    v_pk_mul_f32 v[116:117], v[56:57], v[122:123] op_sel_hi:[1,0]
    v_pk_fma_f32 v[118:119], v[116:117], v[120:121], v[56:57] op_sel:[0,1,0] op_sel_hi:[1,1,1] neg_lo:[1,0,0] neg_hi:[1,0,0]
    v_pk_fma_f32 v[116:117], v[118:119], v[122:123], v[116:117] op_sel_hi:[1,0,1]
    v_cvt_pk_bf16_f32 v116, v116, v117
    v_lshlrev_b32 v117, 16, v116
    v_and_b32 v116, s22, v116
    v_cvt_pk_f16_f32 v14, v117, v116

    v_pk_add_f32 v[58:59], v[58:59], v[120:121] op_sel_hi:[1,0] neg_lo:[0,1] neg_hi:[0,1]
    v_cvt_pk_bf16_f32 v4, v58, v59
    v_lshlrev_b32 v58, 16, v4
    v_and_b32 v59, s22, v4
    v_pk_mul_f32 v[4:5], v[58:59], v[122:123] op_sel_hi:[1,0]
    v_pk_fma_f32 v[6:7], v[4:5], v[120:121], v[58:59] op_sel:[0,1,0] op_sel_hi:[1,1,1] neg_lo:[1,0,0] neg_hi:[1,0,0]
    v_pk_fma_f32 v[4:5], v[6:7], v[122:123], v[4:5] op_sel_hi:[1,0,1]
    v_cvt_pk_bf16_f32 v4, v4, v5
    v_lshlrev_b32 v5, 16, v4
    v_and_b32 v4, s22, v4
    v_cvt_pk_f16_f32 v15, v5, v4

    ds_write_b64 v126, v[14:15] offset:384
    v_pk_add_f32 v[60:61], v[60:61], v[120:121] op_sel_hi:[1,0] neg_lo:[0,1] neg_hi:[0,1]
    v_cvt_pk_bf16_f32 v116, v60, v61
    v_lshlrev_b32 v60, 16, v116
    v_and_b32 v61, s22, v116
    v_pk_mul_f32 v[116:117], v[60:61], v[122:123] op_sel_hi:[1,0]
    v_pk_fma_f32 v[118:119], v[116:117], v[120:121], v[60:61] op_sel:[0,1,0] op_sel_hi:[1,1,1] neg_lo:[1,0,0] neg_hi:[1,0,0]
    v_pk_fma_f32 v[116:117], v[118:119], v[122:123], v[116:117] op_sel_hi:[1,0,1]
    v_cvt_pk_bf16_f32 v116, v116, v117
    v_lshlrev_b32 v117, 16, v116
    v_and_b32 v116, s22, v116
    v_cvt_pk_f16_f32 v16, v117, v116

    v_pk_add_f32 v[62:63], v[62:63], v[120:121] op_sel_hi:[1,0] neg_lo:[0,1] neg_hi:[0,1]
    v_cvt_pk_bf16_f32 v4, v62, v63
    v_lshlrev_b32 v62, 16, v4
    v_and_b32 v63, s22, v4
    v_pk_mul_f32 v[4:5], v[62:63], v[122:123] op_sel_hi:[1,0]
    v_pk_fma_f32 v[6:7], v[4:5], v[120:121], v[62:63] op_sel:[0,1,0] op_sel_hi:[1,1,1] neg_lo:[1,0,0] neg_hi:[1,0,0]
    v_pk_fma_f32 v[4:5], v[6:7], v[122:123], v[4:5] op_sel_hi:[1,0,1]
    v_cvt_pk_bf16_f32 v4, v4, v5
    v_lshlrev_b32 v5, 16, v4
    v_and_b32 v4, s22, v4
    v_cvt_pk_f16_f32 v17, v5, v4

    ds_write_b64 v126, v[16:17] offset:512
    v_pk_add_f32 v[64:65], v[64:65], v[120:121] op_sel_hi:[1,0] neg_lo:[0,1] neg_hi:[0,1]
    v_cvt_pk_bf16_f32 v116, v64, v65
    v_lshlrev_b32 v64, 16, v116
    v_and_b32 v65, s22, v116
    v_pk_mul_f32 v[116:117], v[64:65], v[122:123] op_sel_hi:[1,0]
    v_pk_fma_f32 v[118:119], v[116:117], v[120:121], v[64:65] op_sel:[0,1,0] op_sel_hi:[1,1,1] neg_lo:[1,0,0] neg_hi:[1,0,0]
    v_pk_fma_f32 v[116:117], v[118:119], v[122:123], v[116:117] op_sel_hi:[1,0,1]
    v_cvt_pk_bf16_f32 v116, v116, v117
    v_lshlrev_b32 v117, 16, v116
    v_and_b32 v116, s22, v116
    v_cvt_pk_f16_f32 v18, v117, v116

    v_pk_add_f32 v[66:67], v[66:67], v[120:121] op_sel_hi:[1,0] neg_lo:[0,1] neg_hi:[0,1]
    v_cvt_pk_bf16_f32 v4, v66, v67
    v_lshlrev_b32 v66, 16, v4
    v_and_b32 v67, s22, v4
    v_pk_mul_f32 v[4:5], v[66:67], v[122:123] op_sel_hi:[1,0]
    v_pk_fma_f32 v[6:7], v[4:5], v[120:121], v[66:67] op_sel:[0,1,0] op_sel_hi:[1,1,1] neg_lo:[1,0,0] neg_hi:[1,0,0]
    v_pk_fma_f32 v[4:5], v[6:7], v[122:123], v[4:5] op_sel_hi:[1,0,1]
    v_cvt_pk_bf16_f32 v4, v4, v5
    v_lshlrev_b32 v5, 16, v4
    v_and_b32 v4, s22, v4
    v_cvt_pk_f16_f32 v19, v5, v4

    ds_write_b64 v126, v[18:19] offset:640
    v_pk_add_f32 v[68:69], v[68:69], v[120:121] op_sel_hi:[1,0] neg_lo:[0,1] neg_hi:[0,1]
    v_cvt_pk_bf16_f32 v116, v68, v69
    v_lshlrev_b32 v68, 16, v116
    v_and_b32 v69, s22, v116
    v_pk_mul_f32 v[116:117], v[68:69], v[122:123] op_sel_hi:[1,0]
    v_pk_fma_f32 v[118:119], v[116:117], v[120:121], v[68:69] op_sel:[0,1,0] op_sel_hi:[1,1,1] neg_lo:[1,0,0] neg_hi:[1,0,0]
    v_pk_fma_f32 v[116:117], v[118:119], v[122:123], v[116:117] op_sel_hi:[1,0,1]
    v_cvt_pk_bf16_f32 v116, v116, v117
    v_lshlrev_b32 v117, 16, v116
    v_and_b32 v116, s22, v116
    v_cvt_pk_f16_f32 v20, v117, v116

    v_pk_add_f32 v[70:71], v[70:71], v[120:121] op_sel_hi:[1,0] neg_lo:[0,1] neg_hi:[0,1]
    v_cvt_pk_bf16_f32 v4, v70, v71
    v_lshlrev_b32 v70, 16, v4
    v_and_b32 v71, s22, v4
    v_pk_mul_f32 v[4:5], v[70:71], v[122:123] op_sel_hi:[1,0]
    v_pk_fma_f32 v[6:7], v[4:5], v[120:121], v[70:71] op_sel:[0,1,0] op_sel_hi:[1,1,1] neg_lo:[1,0,0] neg_hi:[1,0,0]
    v_pk_fma_f32 v[4:5], v[6:7], v[122:123], v[4:5] op_sel_hi:[1,0,1]
    v_cvt_pk_bf16_f32 v4, v4, v5
    v_lshlrev_b32 v5, 16, v4
    v_and_b32 v4, s22, v4
    v_cvt_pk_f16_f32 v21, v5, v4

    ds_write_b64 v126, v[20:21] offset:768
    v_pk_add_f32 v[72:73], v[72:73], v[120:121] op_sel_hi:[1,0] neg_lo:[0,1] neg_hi:[0,1]
    v_cvt_pk_bf16_f32 v116, v72, v73
    v_lshlrev_b32 v72, 16, v116
    v_and_b32 v73, s22, v116
    v_pk_mul_f32 v[116:117], v[72:73], v[122:123] op_sel_hi:[1,0]
    v_pk_fma_f32 v[118:119], v[116:117], v[120:121], v[72:73] op_sel:[0,1,0] op_sel_hi:[1,1,1] neg_lo:[1,0,0] neg_hi:[1,0,0]
    v_pk_fma_f32 v[116:117], v[118:119], v[122:123], v[116:117] op_sel_hi:[1,0,1]
    v_cvt_pk_bf16_f32 v116, v116, v117
    v_lshlrev_b32 v117, 16, v116
    v_and_b32 v116, s22, v116
    v_cvt_pk_f16_f32 v22, v117, v116

    v_pk_add_f32 v[74:75], v[74:75], v[120:121] op_sel_hi:[1,0] neg_lo:[0,1] neg_hi:[0,1]
    v_cvt_pk_bf16_f32 v4, v74, v75
    v_lshlrev_b32 v74, 16, v4
    v_and_b32 v75, s22, v4
    v_pk_mul_f32 v[4:5], v[74:75], v[122:123] op_sel_hi:[1,0]
    v_pk_fma_f32 v[6:7], v[4:5], v[120:121], v[74:75] op_sel:[0,1,0] op_sel_hi:[1,1,1] neg_lo:[1,0,0] neg_hi:[1,0,0]
    v_pk_fma_f32 v[4:5], v[6:7], v[122:123], v[4:5] op_sel_hi:[1,0,1]
    v_cvt_pk_bf16_f32 v4, v4, v5
    v_lshlrev_b32 v5, 16, v4
    v_and_b32 v4, s22, v4
    v_cvt_pk_f16_f32 v23, v5, v4

    ds_write_b64 v126, v[22:23] offset:896
    v_pk_add_f32 v[76:77], v[76:77], v[120:121] op_sel_hi:[1,0] neg_lo:[0,1] neg_hi:[0,1]
    v_cvt_pk_bf16_f32 v116, v76, v77
    v_lshlrev_b32 v76, 16, v116
    v_and_b32 v77, s22, v116
    v_pk_mul_f32 v[116:117], v[76:77], v[122:123] op_sel_hi:[1,0]
    v_pk_fma_f32 v[118:119], v[116:117], v[120:121], v[76:77] op_sel:[0,1,0] op_sel_hi:[1,1,1] neg_lo:[1,0,0] neg_hi:[1,0,0]
    v_pk_fma_f32 v[116:117], v[118:119], v[122:123], v[116:117] op_sel_hi:[1,0,1]
    v_cvt_pk_bf16_f32 v116, v116, v117
    v_lshlrev_b32 v117, 16, v116
    v_and_b32 v116, s22, v116
    v_cvt_pk_f16_f32 v24, v117, v116

    v_pk_add_f32 v[78:79], v[78:79], v[120:121] op_sel_hi:[1,0] neg_lo:[0,1] neg_hi:[0,1]
    v_cvt_pk_bf16_f32 v4, v78, v79
    v_lshlrev_b32 v78, 16, v4
    v_and_b32 v79, s22, v4
    v_pk_mul_f32 v[4:5], v[78:79], v[122:123] op_sel_hi:[1,0]
    v_pk_fma_f32 v[6:7], v[4:5], v[120:121], v[78:79] op_sel:[0,1,0] op_sel_hi:[1,1,1] neg_lo:[1,0,0] neg_hi:[1,0,0]
    v_pk_fma_f32 v[4:5], v[6:7], v[122:123], v[4:5] op_sel_hi:[1,0,1]
    v_cvt_pk_bf16_f32 v4, v4, v5
    v_lshlrev_b32 v5, 16, v4
    v_and_b32 v4, s22, v4
    v_cvt_pk_f16_f32 v25, v5, v4

    ds_write_b64 v126, v[24:25] offset:1024
    s_waitcnt lgkmcnt(0)
    s_barrier
    ds_read_b64_tr_b16 v[44:45], v127 offset:0
    ds_read_b64_tr_b16 v[46:47], v127 offset:4736
    ds_read_b64_tr_b16 v[48:49], v127 offset:64
    ds_read_b64_tr_b16 v[50:51], v127 offset:4800
    ds_read_b64_tr_b16 v[52:53], v127 offset:128
    ds_read_b64_tr_b16 v[54:55], v127 offset:4864
    ds_read_b64_tr_b16 v[56:57], v127 offset:192
    ds_read_b64_tr_b16 v[58:59], v127 offset:4928
    ds_read_b64_tr_b16 v[60:61], v127 offset:256
    ds_read_b64_tr_b16 v[62:63], v127 offset:4992
    s_waitcnt lgkmcnt(8)
    s_mov_b32 s27, 0
    buffer_store_dwordx4 v[44:47], v128, s[28:31], s27 offen sc1
    s_waitcnt lgkmcnt(6)
    s_mov_b32 s27, 139264
    buffer_store_dwordx4 v[48:51], v128, s[28:31], s27 offen sc1
    s_waitcnt lgkmcnt(4)
    s_mov_b32 s27, 278528
    buffer_store_dwordx4 v[52:55], v128, s[28:31], s27 offen sc1
    s_waitcnt lgkmcnt(2)
    s_mov_b32 s27, 417792
    buffer_store_dwordx4 v[56:59], v128, s[28:31], s27 offen sc1
    s_waitcnt lgkmcnt(0)
    s_mov_b32 s27, 557056
    s_mov_b64 exec, 0xffffffff
    buffer_store_dwordx4 v[60:63], v128, s[28:31], s27 offen sc1
    s_mov_b64 exec, -1
    s_waitcnt vmcnt(0)
    s_barrier
    s_cmp_lg_u32 s46, 0
    s_cbranch_scc1 front_kernel_lnx
    v_mov_b32 v1, 1
    v_mov_b32 v2, 0

    s_mov_b64 exec, 1
    global_atomic_add v3, v2, v1, s[44:45] sc0 sc1
    s_waitcnt vmcnt(0)
    v_readfirstlane_b32 s4, v3
    s_cmp_lg_u32 s4, 127
    s_cbranch_scc1 front_kernel_lnx
    global_store_dword v2, v1, s[44:45] offset:128 sc1

front_kernel_lnx:
    s_mov_b64 exec, -1
    s_setprio 0
    v_mov_b32 v0, v140
    s_mov_b32 s2, s47
    s_branch front_kernel_wp2
front_kernel_wp:
    s_sub_u32 s2, s2, 576
front_kernel_wp2:
    s_load_dwordx2 s[4:5], s[0:1], 96
    s_load_dwordx2 s[8:9], s[0:1], 120
    v_lshrrev_b32 v2, 6, v0
    v_and_b32 v1, 63, v0
    s_nop 0
    v_readfirstlane_b32 s3, v2
    v_lshlrev_b32 v8, 4, v1
    s_waitcnt lgkmcnt(0)

    s_mov_b32 s16, s4
    s_mov_b32 s17, s5
    s_and_b32 s17, s17, 0xffff
    s_mov_b32 s18, 5308416
    s_mov_b32 s19, 0x00020000
    s_add_u32 s20, s8, 41943040
    s_addc_u32 s21, s9, 0
    s_and_b32 s21, s21, 0xffff
    s_mov_b32 s22, 5308416
    s_mov_b32 s23, 0x00020000
    s_mul_i32 s30, s3, 9216
    s_mul_i32 s31, s2, 36864
    s_add_u32 s31, s31, s30

    s_add_u32 m0, s30, 0
    s_add_u32 s32, s31, 0
    buffer_load_dwordx4 v8, s[16:19], s32 offen lds
    s_add_u32 m0, s30, 1024
    s_add_u32 s32, s31, 1024
    buffer_load_dwordx4 v8, s[16:19], s32 offen lds
    s_add_u32 m0, s30, 2048
    s_add_u32 s32, s31, 2048
    buffer_load_dwordx4 v8, s[16:19], s32 offen lds
    s_add_u32 m0, s30, 3072
    s_add_u32 s32, s31, 3072
    buffer_load_dwordx4 v8, s[16:19], s32 offen lds
    s_add_u32 m0, s30, 4096
    s_add_u32 s32, s31, 4096
    buffer_load_dwordx4 v8, s[16:19], s32 offen lds
    s_add_u32 m0, s30, 5120
    s_add_u32 s32, s31, 5120
    buffer_load_dwordx4 v8, s[16:19], s32 offen lds
    s_add_u32 m0, s30, 6144
    s_add_u32 s32, s31, 6144
    buffer_load_dwordx4 v8, s[16:19], s32 offen lds
    s_add_u32 m0, s30, 7168
    s_add_u32 s32, s31, 7168
    buffer_load_dwordx4 v8, s[16:19], s32 offen lds
    s_add_u32 m0, s30, 8192
    s_add_u32 s32, s31, 8192
    buffer_load_dwordx4 v8, s[16:19], s32 offen lds
    s_add_u32 s24, s8, 56623104
    s_addc_u32 s25, s9, 0
    s_and_b32 s25, s25, 0xffff
    s_mov_b32 s26, 16384
    s_mov_b32 s27, 0x00020000
    v_mov_b32 v12, 0
    v_lshlrev_b32 v13, 2, v0
    s_lshl_b32 s33, s2, 10
    buffer_store_dword v12, v13, s[24:27], s33 offen
    v_lshrrev_b32 v4, 2, v1
    v_mul_u32_u24 v9, 1152, v4
    v_and_b32 v5, 3, v1
    v_lshl_add_u32 v9, v5, 3, v9
    s_mul_i32 s33, s3, 288
    v_add_u32 v9, s33, v9
    s_mul_i32 s34, s3, 1179648
    s_lshl_b32 s35, s2, 12
    s_add_u32 s34, s34, s35
    s_lshl_b32 s36, s3, 4
    s_and_b32 s35, s2, 7
    s_add_u32 s36, s36, s35
    s_mul_i32 s36, s36, 9
    s_lshr_b32 s35, s2, 4
    s_add_u32 s36, s36, s35
    s_lshl_b32 s36, s36, 10
    s_bfe_u32 s35, s2, 0x10003
    s_lshl_b32 s35, s35, 9
    s_add_u32 s36, s36, s35
    s_add_u32 s36, s36, 4718592
    v_and_b32 v3, 15, v1
    v_cmp_gt_u32 vcc, 8, v3
    s_waitcnt vmcnt(0)
    s_barrier

    ds_read_b64_tr_b16 v[16:17], v9 offset:0
    ds_read_b64_tr_b16 v[18:19], v9 offset:18432
    ds_read_b64_tr_b16 v[20:21], v9 offset:32
    ds_read_b64_tr_b16 v[22:23], v9 offset:18464
    ds_read_b64_tr_b16 v[24:25], v9 offset:64
    ds_read_b64_tr_b16 v[26:27], v9 offset:18496
    ds_read_b64_tr_b16 v[28:29], v9 offset:96
    ds_read_b64_tr_b16 v[30:31], v9 offset:18528
    ds_read_b64_tr_b16 v[32:33], v9 offset:128
    ds_read_b64_tr_b16 v[34:35], v9 offset:18560
    ds_read_b64_tr_b16 v[36:37], v9 offset:144
    ds_read_b64_tr_b16 v[38:39], v9 offset:18576
    ds_read_b64_tr_b16 v[40:41], v9 offset:176
    ds_read_b64_tr_b16 v[42:43], v9 offset:18608
    ds_read_b64_tr_b16 v[44:45], v9 offset:208
    ds_read_b64_tr_b16 v[46:47], v9 offset:18640
    ds_read_b64_tr_b16 v[48:49], v9 offset:240
    ds_read_b64_tr_b16 v[50:51], v9 offset:18672
    ds_read_b64_tr_b16 v[52:53], v9 offset:272
    ds_read_b64_tr_b16 v[54:55], v9 offset:18704
    s_waitcnt lgkmcnt(0)
    v_lshrrev_b32 v4, 4, v1
    v_lshl_add_u32 v7, v4, 3, v3
    v_lshlrev_b32 v7, 4, v7

    s_add_u32 s35, s34, 0
    buffer_store_dwordx4 v[16:19], v8, s[20:23], s35 offen offset:0
    s_add_u32 s35, s34, 0
    buffer_store_dwordx4 v[20:23], v8, s[20:23], s35 offen offset:1024
    s_add_u32 s35, s34, 0
    buffer_store_dwordx4 v[24:27], v8, s[20:23], s35 offen offset:2048
    s_add_u32 s35, s34, 0
    buffer_store_dwordx4 v[28:31], v8, s[20:23], s35 offen offset:3072
    s_add_u32 s35, s36, 0
    s_mov_b64 exec, vcc
    buffer_store_dwordx4 v[32:35], v7, s[20:23], s35 offen
    s_mov_b64 exec, -1
    s_add_u32 s35, s34, 589824
    buffer_store_dwordx4 v[36:39], v8, s[20:23], s35 offen offset:0
    s_add_u32 s35, s34, 589824
    buffer_store_dwordx4 v[40:43], v8, s[20:23], s35 offen offset:1024
    s_add_u32 s35, s34, 589824
    buffer_store_dwordx4 v[44:47], v8, s[20:23], s35 offen offset:2048
    s_add_u32 s35, s34, 589824
    buffer_store_dwordx4 v[48:51], v8, s[20:23], s35 offen offset:3072
    s_add_u32 s35, s36, 73728
    s_mov_b64 exec, vcc
    buffer_store_dwordx4 v[52:55], v7, s[20:23], s35 offen
    s_mov_b64 exec, -1
    s_branch front_kernel_end
front_kernel_ch:
    s_sub_u32 s2, s2, 128
    s_load_dwordx2 s[44:45], s[0:1], 112
    s_load_dwordx8 s[8:15], s[0:1], 8
    s_load_dwordx4 s[16:19], s[0:1], 40
    s_load_dwordx2 s[20:21], s[0:1], 56
    s_load_dwordx2 s[22:23], s[0:1], 120
    s_mov_b32 s30, 0x3fb8aa3b
    s_mov_b32 s31, 0x3e22f983
    s_mov_b32 s32, 0x45000000
    v_lshrrev_b32 v1, 6, v0
    v_and_b32 v2, 63, v0
    v_and_b32 v3, 15, v0
    v_bfe_u32 v4, v0, 4, 2
    s_lshl_b32 s3, s2, 8
    v_lshl_add_u32 v5, v0, 1, s3
    s_lshl_b32 s4, s2, 1
    v_mov_b32 v6, s4
    v_mov_b32 v28, 0
    v_mov_b32 v29, 0
    v_cmp_gt_u32 vcc, 128, v0
    s_and_saveexec_b64 s[24:25], vcc
    s_cbranch_execz front_kernel_p0a
    s_waitcnt lgkmcnt(0)
    global_load_ushort v10, v5, s[8:9]
    global_load_ushort v11, v5, s[10:11]
    global_load_ushort v12, v5, s[12:13]
    global_load_ushort v13, v5, s[14:15]
    global_load_ushort v14, v5, s[16:17]
    global_load_ushort v15, v5, s[18:19]
    global_load_ushort v16, v6, s[20:21]

front_kernel_p0a:
    s_mov_b64 exec, -1
    v_lshlrev_b32 v7, 3, v0
    v_sub_u32 v7, 2047, v7
    s_mov_b32 s33, 0xffffff80
    v_subrev_u32 v17, 0, v7
    v_cvt_f32_u32 v18, v17
    v_cvt_pk_bf16_f32 v18, v18, v18
    v_and_b32 v18, 0xffff, v18
    v_and_b32 v19, s33, v18
    v_add_u32 v18, v18, v19
    v_subrev_u32 v18, 34176, v18
    v_cmp_gt_u32 vcc, 256, v17
    s_nop 1
    v_cndmask_b32 v18, v18, v17, vcc
    v_lshlrev_b32 v72, 2, v18

    v_subrev_u32 v17, 1, v7
    v_cvt_f32_u32 v18, v17
    v_cvt_pk_bf16_f32 v18, v18, v18
    v_and_b32 v18, 0xffff, v18
    v_and_b32 v19, s33, v18
    v_add_u32 v18, v18, v19
    v_subrev_u32 v18, 34176, v18
    v_cmp_gt_u32 vcc, 256, v17
    s_nop 1
    v_cndmask_b32 v18, v18, v17, vcc
    v_lshlrev_b32 v73, 2, v18

    v_subrev_u32 v17, 2, v7
    v_cvt_f32_u32 v18, v17
    v_cvt_pk_bf16_f32 v18, v18, v18
    v_and_b32 v18, 0xffff, v18
    v_and_b32 v19, s33, v18
    v_add_u32 v18, v18, v19
    v_subrev_u32 v18, 34176, v18
    v_cmp_gt_u32 vcc, 256, v17
    s_nop 1
    v_cndmask_b32 v18, v18, v17, vcc
    v_lshlrev_b32 v74, 2, v18

    v_subrev_u32 v17, 3, v7
    v_cvt_f32_u32 v18, v17
    v_cvt_pk_bf16_f32 v18, v18, v18
    v_and_b32 v18, 0xffff, v18
    v_and_b32 v19, s33, v18
    v_add_u32 v18, v18, v19
    v_subrev_u32 v18, 34176, v18
    v_cmp_gt_u32 vcc, 256, v17
    s_nop 1
    v_cndmask_b32 v18, v18, v17, vcc
    v_lshlrev_b32 v75, 2, v18

    v_subrev_u32 v17, 4, v7
    v_cvt_f32_u32 v18, v17
    v_cvt_pk_bf16_f32 v18, v18, v18
    v_and_b32 v18, 0xffff, v18
    v_and_b32 v19, s33, v18
    v_add_u32 v18, v18, v19
    v_subrev_u32 v18, 34176, v18
    v_cmp_gt_u32 vcc, 256, v17
    s_nop 1
    v_cndmask_b32 v18, v18, v17, vcc
    v_lshlrev_b32 v76, 2, v18

    v_subrev_u32 v17, 5, v7
    v_cvt_f32_u32 v18, v17
    v_cvt_pk_bf16_f32 v18, v18, v18
    v_and_b32 v18, 0xffff, v18
    v_and_b32 v19, s33, v18
    v_add_u32 v18, v18, v19
    v_subrev_u32 v18, 34176, v18
    v_cmp_gt_u32 vcc, 256, v17
    s_nop 1
    v_cndmask_b32 v18, v18, v17, vcc
    v_lshlrev_b32 v77, 2, v18

    v_subrev_u32 v17, 6, v7
    v_cvt_f32_u32 v18, v17
    v_cvt_pk_bf16_f32 v18, v18, v18
    v_and_b32 v18, 0xffff, v18
    v_and_b32 v19, s33, v18
    v_add_u32 v18, v18, v19
    v_subrev_u32 v18, 34176, v18
    v_cmp_gt_u32 vcc, 256, v17
    s_nop 1
    v_cndmask_b32 v18, v18, v17, vcc
    v_lshlrev_b32 v78, 2, v18

    v_subrev_u32 v17, 7, v7
    v_cvt_f32_u32 v18, v17
    v_cvt_pk_bf16_f32 v18, v18, v18
    v_and_b32 v18, 0xffff, v18
    v_and_b32 v19, s33, v18
    v_add_u32 v18, v18, v19
    v_subrev_u32 v18, 34176, v18
    v_cmp_gt_u32 vcc, 256, v17
    s_nop 1
    v_cndmask_b32 v18, v18, v17, vcc
    v_lshlrev_b32 v79, 2, v18

    v_cmp_gt_u32 vcc, 128, v0
    s_and_saveexec_b64 s[24:25], vcc
    s_cbranch_execz front_kernel_p0skip
    s_waitcnt vmcnt(0)
    v_lshlrev_b32 v10, 16, v10
    v_lshlrev_b32 v11, 16, v11
    v_lshlrev_b32 v12, 16, v12
    v_lshlrev_b32 v13, 16, v13
    v_lshlrev_b32 v14, 16, v14
    v_lshlrev_b32 v15, 16, v15
    v_lshlrev_b32 v16, 16, v16
    v_mul_f32 v16, s30, v16
    v_exp_f32 v16, v16
    s_nop 0
    v_cvt_pk_bf16_f32 v16, v16, v16
    v_lshlrev_b32 v16, 16, v16
    v_mul_f32 v10, v16, v10
    v_mul_f32 v11, v16, v11
    v_mul_f32 v12, v16, v12
    v_mul_f32 v13, v16, v13
    v_mul_f32 v20, s30, v10
    v_mul_f32 v21, s31, v11
    v_mul_f32 v17, v15, v13
    v_fma_f32 v22, v14, v12, -v17
    v_mul_f32 v17, v15, v12
    v_fma_f32 v23, v14, v13, v17
    v_lshlrev_b32 v7, 4, v0
    ds_write_b128 v7, v[20:23]
    v_max_f32 v29, abs(v22), abs(v23)
    v_mul_f32 v24, s32, v20
    v_exp_f32 v24, v24
    v_mul_f32 v25, s32, v21
    v_fract_f32 v25, v25
    v_cos_f32 v26, v25
    v_sin_f32 v27, v25
    s_nop 0
    v_mul_f32 v27, v23, v27
    v_fma_f32 v26, v22, v26, -v27
    v_mul_f32 v28, v24, v26

front_kernel_p0skip:
    s_mov_b64 exec, -1
    s_nop 1
    v_add_f32_dpp v24, v28, v28 quad_perm:[1,0,3,2] row_mask:0xf bank_mask:0xf
    v_max_f32_dpp v25, v29, v29 quad_perm:[1,0,3,2] row_mask:0xf bank_mask:0xf
    s_nop 0
    v_add_f32_dpp v28, v24, v24 quad_perm:[2,3,0,1] row_mask:0xf bank_mask:0xf
    v_max_f32_dpp v29, v25, v25 quad_perm:[2,3,0,1] row_mask:0xf bank_mask:0xf
    s_nop 0
    v_add_f32_dpp v24, v28, v28 row_half_mirror row_mask:0xf bank_mask:0xf
    v_max_f32_dpp v25, v29, v29 row_half_mirror row_mask:0xf bank_mask:0xf
    s_nop 0
    v_add_f32_dpp v28, v24, v24 row_mirror row_mask:0xf bank_mask:0xf
    v_max_f32_dpp v29, v25, v25 row_mirror row_mask:0xf bank_mask:0xf
    v_lshrrev_b32 v14, 4, v0
    v_lshlrev_b32 v14, 2, v14
    ds_write_b32 v14, v29 offset:22528
    v_readlane_b32 s26, v28, 0
    v_readlane_b32 s27, v28, 16
    v_readlane_b32 s28, v28, 32
    v_readlane_b32 s29, v28, 48
    s_nop 3
    v_mov_b32 v28, s26
    v_add_f32 v28, s27, v28
    v_add_f32 v28, s28, v28
    v_add_f32 v28, s29, v28
    v_mul_u32_u24 v8, 5120, v1
    v_add_u32 v8, 2048, v8
    v_lshlrev_b32 v9, 9, v1
    v_lshl_add_u32 v9, v4, 6, v9
    v_cvt_f32_u32 v31, v3
    v_mul_f32 v30, 0x41800000, v31
    v_and_b32 v14, 7, v3
    v_lshlrev_b32 v14, 2, v14

    v_mov_b32 v112, 0
    v_mov_b32 v113, 0
    v_mov_b32 v114, 0
    v_mov_b32 v115, 0
    v_mov_b32 v116, 0
    v_mov_b32 v117, 0
    v_mov_b32 v118, 0
    v_mov_b32 v119, 0
    v_mov_b32 v120, 0
    v_mov_b32 v121, 0
    v_mov_b32 v122, 0
    v_mov_b32 v123, 0
    v_mov_b32 v124, 0
    v_mov_b32 v125, 0
    v_mov_b32 v126, 0
    v_mov_b32 v127, 0
    s_waitcnt lgkmcnt(0)
    s_barrier
    ds_read_b32 v29, v14 offset:22528
    ds_read_b128 v[80:83], v9 offset:0
    ds_read_b128 v[84:87], v9 offset:16
    ds_read_b128 v[88:91], v9 offset:32
    ds_read_b128 v[92:95], v9 offset:48
    ds_read_b128 v[96:99], v9 offset:256
    ds_read_b128 v[100:103], v9 offset:272
    ds_read_b128 v[104:107], v9 offset:288
    ds_read_b128 v[108:111], v9 offset:304
    s_waitcnt lgkmcnt(8)
    s_nop 1
    v_max_f32_dpp v25, v29, v29 quad_perm:[1,0,3,2] row_mask:0xf bank_mask:0xf
    s_nop 1
    v_max_f32_dpp v29, v25, v25 quad_perm:[2,3,0,1] row_mask:0xf bank_mask:0xf
    s_nop 1
    v_max_f32_dpp v25, v29, v29 row_half_mirror row_mask:0xf bank_mask:0xf
    v_lshrrev_b32 v25, 23, v25
    v_sub_u32 v25, 264, v25
    v_min_u32 v25, 253, v25
    v_max_u32 v15, 1, v25
    v_lshlrev_b32 v29, 23, v15
    v_mul_f32 v28, v29, v28
    ds_write_b32 v8, v28 offset:4608
    s_waitcnt lgkmcnt(1)

    v_pk_mul_f32 v[24:25], v[80:81], v[30:31] op_sel_hi:[0,1]
    v_pk_mul_f32 v[26:27], v[80:81], v[30:31] op_sel:[1,0] op_sel_hi:[1,1]
    v_pk_mul_f32 v[82:83], v[82:83], v[28:29] op_sel:[0,1] op_sel_hi:[1,1]
    v_exp_f32 v24, v24
    v_exp_f32 v25, v25
    v_fract_f32 v26, v26
    v_fract_f32 v27, v27
    v_cos_f32 v32, v26
    v_cos_f32 v33, v27
    v_sin_f32 v34, v26
    v_sin_f32 v35, v27
    s_nop 0
    v_pk_mul_f32 v[32:33], v[24:25], v[32:33]
    v_pk_mul_f32 v[34:35], v[24:25], v[34:35]

    v_mul_f32 v24, v83, v34
    v_mul_f32 v25, v83, v32
    v_cvt_pk_f16_f32 v40, v33, v35
    v_fma_f32 v36, v82, v32, -v24
    v_fma_f32 v37, -v82, v34, -v25
    v_cvt_pk_f16_f32 v56, v36, v37
    v_fma_mix_f32 v36, v56, -1.0, v36 op_sel_hi:[1,0,0]
    v_fma_mix_f32 v37, v56, -1.0, v37 op_sel:[1,0,0] op_sel_hi:[1,0,0]
    v_cvt_pk_f16_f32 v128, v36, v37

    v_pk_mul_f32 v[24:25], v[34:35], v[34:35]
    v_pk_add_f32 v[26:27], v[32:33], v[32:33]
    v_pk_fma_f32 v[32:33], v[32:33], v[32:33], v[24:25] neg_lo:[0,0,1] neg_hi:[0,0,1]
    v_pk_mul_f32 v[34:35], v[26:27], v[34:35]

    v_mul_f32 v24, v83, v34
    v_mul_f32 v25, v83, v32
    v_cvt_pk_f16_f32 v44, v33, v35
    v_fma_f32 v36, v82, v32, -v24
    v_fma_f32 v37, -v82, v34, -v25
    v_cvt_pk_f16_f32 v60, v36, v37
    v_fma_mix_f32 v36, v60, -1.0, v36 op_sel_hi:[1,0,0]
    v_fma_mix_f32 v37, v60, -1.0, v37 op_sel:[1,0,0] op_sel_hi:[1,0,0]
    v_cvt_pk_f16_f32 v132, v36, v37

    v_pk_mul_f32 v[24:25], v[34:35], v[34:35]
    v_pk_add_f32 v[26:27], v[32:33], v[32:33]
    v_pk_fma_f32 v[32:33], v[32:33], v[32:33], v[24:25] neg_lo:[0,0,1] neg_hi:[0,0,1]
    v_pk_mul_f32 v[34:35], v[26:27], v[34:35]

    v_mul_f32 v24, v83, v34
    v_mul_f32 v25, v83, v32
    v_cvt_pk_f16_f32 v48, v33, v35
    v_fma_f32 v36, v82, v32, -v24
    v_fma_f32 v37, -v82, v34, -v25
    v_cvt_pk_f16_f32 v64, v36, v37
    v_fma_mix_f32 v36, v64, -1.0, v36 op_sel_hi:[1,0,0]
    v_fma_mix_f32 v37, v64, -1.0, v37 op_sel:[1,0,0] op_sel_hi:[1,0,0]
    v_cvt_pk_f16_f32 v136, v36, v37

    v_pk_mul_f32 v[24:25], v[34:35], v[34:35]
    v_pk_add_f32 v[26:27], v[32:33], v[32:33]
    v_pk_fma_f32 v[32:33], v[32:33], v[32:33], v[24:25] neg_lo:[0,0,1] neg_hi:[0,0,1]
    v_pk_mul_f32 v[34:35], v[26:27], v[34:35]

    v_mul_f32 v24, v83, v34
    v_mul_f32 v25, v83, v32
    v_cvt_pk_f16_f32 v52, v33, v35
    v_fma_f32 v36, v82, v32, -v24
    v_fma_f32 v37, -v82, v34, -v25
    v_cvt_pk_f16_f32 v68, v36, v37
    v_fma_mix_f32 v36, v68, -1.0, v36 op_sel_hi:[1,0,0]
    v_fma_mix_f32 v37, v68, -1.0, v37 op_sel:[1,0,0] op_sel_hi:[1,0,0]
    v_cvt_pk_f16_f32 v140, v36, v37

    v_pk_mul_f32 v[24:25], v[84:85], v[30:31] op_sel_hi:[0,1]
    v_pk_mul_f32 v[26:27], v[84:85], v[30:31] op_sel:[1,0] op_sel_hi:[1,1]
    v_pk_mul_f32 v[86:87], v[86:87], v[28:29] op_sel:[0,1] op_sel_hi:[1,1]
    v_exp_f32 v24, v24
    v_exp_f32 v25, v25
    v_fract_f32 v26, v26
    v_fract_f32 v27, v27
    v_cos_f32 v32, v26
    v_cos_f32 v33, v27
    v_sin_f32 v34, v26
    v_sin_f32 v35, v27
    s_nop 0
    v_pk_mul_f32 v[32:33], v[24:25], v[32:33]
    v_pk_mul_f32 v[34:35], v[24:25], v[34:35]

    v_mul_f32 v24, v87, v34
    v_mul_f32 v25, v87, v32
    v_cvt_pk_f16_f32 v41, v33, v35
    v_fma_f32 v36, v86, v32, -v24
    v_fma_f32 v37, -v86, v34, -v25
    v_cvt_pk_f16_f32 v57, v36, v37
    v_fma_mix_f32 v36, v57, -1.0, v36 op_sel_hi:[1,0,0]
    v_fma_mix_f32 v37, v57, -1.0, v37 op_sel:[1,0,0] op_sel_hi:[1,0,0]
    v_cvt_pk_f16_f32 v129, v36, v37

    v_pk_mul_f32 v[24:25], v[34:35], v[34:35]
    v_pk_add_f32 v[26:27], v[32:33], v[32:33]
    v_pk_fma_f32 v[32:33], v[32:33], v[32:33], v[24:25] neg_lo:[0,0,1] neg_hi:[0,0,1]
    v_pk_mul_f32 v[34:35], v[26:27], v[34:35]

    v_mul_f32 v24, v87, v34
    v_mul_f32 v25, v87, v32
    v_cvt_pk_f16_f32 v45, v33, v35
    v_fma_f32 v36, v86, v32, -v24
    v_fma_f32 v37, -v86, v34, -v25
    v_cvt_pk_f16_f32 v61, v36, v37
    v_fma_mix_f32 v36, v61, -1.0, v36 op_sel_hi:[1,0,0]
    v_fma_mix_f32 v37, v61, -1.0, v37 op_sel:[1,0,0] op_sel_hi:[1,0,0]
    v_cvt_pk_f16_f32 v133, v36, v37

    v_pk_mul_f32 v[24:25], v[34:35], v[34:35]
    v_pk_add_f32 v[26:27], v[32:33], v[32:33]
    v_pk_fma_f32 v[32:33], v[32:33], v[32:33], v[24:25] neg_lo:[0,0,1] neg_hi:[0,0,1]
    v_pk_mul_f32 v[34:35], v[26:27], v[34:35]

    v_mul_f32 v24, v87, v34
    v_mul_f32 v25, v87, v32
    v_cvt_pk_f16_f32 v49, v33, v35
    v_fma_f32 v36, v86, v32, -v24
    v_fma_f32 v37, -v86, v34, -v25
    v_cvt_pk_f16_f32 v65, v36, v37
    v_fma_mix_f32 v36, v65, -1.0, v36 op_sel_hi:[1,0,0]
    v_fma_mix_f32 v37, v65, -1.0, v37 op_sel:[1,0,0] op_sel_hi:[1,0,0]
    v_cvt_pk_f16_f32 v137, v36, v37

    v_pk_mul_f32 v[24:25], v[34:35], v[34:35]
    v_pk_add_f32 v[26:27], v[32:33], v[32:33]
    v_pk_fma_f32 v[32:33], v[32:33], v[32:33], v[24:25] neg_lo:[0,0,1] neg_hi:[0,0,1]
    v_pk_mul_f32 v[34:35], v[26:27], v[34:35]

    v_mul_f32 v24, v87, v34
    v_mul_f32 v25, v87, v32
    v_cvt_pk_f16_f32 v53, v33, v35
    v_fma_f32 v36, v86, v32, -v24
    v_fma_f32 v37, -v86, v34, -v25
    v_cvt_pk_f16_f32 v69, v36, v37
    v_fma_mix_f32 v36, v69, -1.0, v36 op_sel_hi:[1,0,0]
    v_fma_mix_f32 v37, v69, -1.0, v37 op_sel:[1,0,0] op_sel_hi:[1,0,0]
    v_cvt_pk_f16_f32 v141, v36, v37

    v_pk_mul_f32 v[24:25], v[88:89], v[30:31] op_sel_hi:[0,1]
    v_pk_mul_f32 v[26:27], v[88:89], v[30:31] op_sel:[1,0] op_sel_hi:[1,1]
    v_pk_mul_f32 v[90:91], v[90:91], v[28:29] op_sel:[0,1] op_sel_hi:[1,1]
    v_exp_f32 v24, v24
    v_exp_f32 v25, v25
    v_fract_f32 v26, v26
    v_fract_f32 v27, v27
    v_cos_f32 v32, v26
    v_cos_f32 v33, v27
    v_sin_f32 v34, v26
    v_sin_f32 v35, v27
    s_nop 0
    v_pk_mul_f32 v[32:33], v[24:25], v[32:33]
    v_pk_mul_f32 v[34:35], v[24:25], v[34:35]

    v_mul_f32 v24, v91, v34
    v_mul_f32 v25, v91, v32
    v_cvt_pk_f16_f32 v42, v33, v35
    v_fma_f32 v36, v90, v32, -v24
    v_fma_f32 v37, -v90, v34, -v25
    v_cvt_pk_f16_f32 v58, v36, v37
    v_fma_mix_f32 v36, v58, -1.0, v36 op_sel_hi:[1,0,0]
    v_fma_mix_f32 v37, v58, -1.0, v37 op_sel:[1,0,0] op_sel_hi:[1,0,0]
    v_cvt_pk_f16_f32 v130, v36, v37

    v_pk_mul_f32 v[24:25], v[34:35], v[34:35]
    v_pk_add_f32 v[26:27], v[32:33], v[32:33]
    v_pk_fma_f32 v[32:33], v[32:33], v[32:33], v[24:25] neg_lo:[0,0,1] neg_hi:[0,0,1]
    v_pk_mul_f32 v[34:35], v[26:27], v[34:35]

    v_mul_f32 v24, v91, v34
    v_mul_f32 v25, v91, v32
    v_cvt_pk_f16_f32 v46, v33, v35
    v_fma_f32 v36, v90, v32, -v24
    v_fma_f32 v37, -v90, v34, -v25
    v_cvt_pk_f16_f32 v62, v36, v37
    v_fma_mix_f32 v36, v62, -1.0, v36 op_sel_hi:[1,0,0]
    v_fma_mix_f32 v37, v62, -1.0, v37 op_sel:[1,0,0] op_sel_hi:[1,0,0]
    v_cvt_pk_f16_f32 v134, v36, v37

    v_pk_mul_f32 v[24:25], v[34:35], v[34:35]
    v_pk_add_f32 v[26:27], v[32:33], v[32:33]
    v_pk_fma_f32 v[32:33], v[32:33], v[32:33], v[24:25] neg_lo:[0,0,1] neg_hi:[0,0,1]
    v_pk_mul_f32 v[34:35], v[26:27], v[34:35]

    v_mul_f32 v24, v91, v34
    v_mul_f32 v25, v91, v32
    v_cvt_pk_f16_f32 v50, v33, v35
    v_fma_f32 v36, v90, v32, -v24
    v_fma_f32 v37, -v90, v34, -v25
    v_cvt_pk_f16_f32 v66, v36, v37
    v_fma_mix_f32 v36, v66, -1.0, v36 op_sel_hi:[1,0,0]
    v_fma_mix_f32 v37, v66, -1.0, v37 op_sel:[1,0,0] op_sel_hi:[1,0,0]
    v_cvt_pk_f16_f32 v138, v36, v37

    v_pk_mul_f32 v[24:25], v[34:35], v[34:35]
    v_pk_add_f32 v[26:27], v[32:33], v[32:33]
    v_pk_fma_f32 v[32:33], v[32:33], v[32:33], v[24:25] neg_lo:[0,0,1] neg_hi:[0,0,1]
    v_pk_mul_f32 v[34:35], v[26:27], v[34:35]

    v_mul_f32 v24, v91, v34
    v_mul_f32 v25, v91, v32
    v_cvt_pk_f16_f32 v54, v33, v35
    v_fma_f32 v36, v90, v32, -v24
    v_fma_f32 v37, -v90, v34, -v25
    v_cvt_pk_f16_f32 v70, v36, v37
    v_fma_mix_f32 v36, v70, -1.0, v36 op_sel_hi:[1,0,0]
    v_fma_mix_f32 v37, v70, -1.0, v37 op_sel:[1,0,0] op_sel_hi:[1,0,0]
    v_cvt_pk_f16_f32 v142, v36, v37

    v_pk_mul_f32 v[24:25], v[92:93], v[30:31] op_sel_hi:[0,1]
    v_pk_mul_f32 v[26:27], v[92:93], v[30:31] op_sel:[1,0] op_sel_hi:[1,1]
    v_pk_mul_f32 v[94:95], v[94:95], v[28:29] op_sel:[0,1] op_sel_hi:[1,1]
    v_exp_f32 v24, v24
    v_exp_f32 v25, v25
    v_fract_f32 v26, v26
    v_fract_f32 v27, v27
    v_cos_f32 v32, v26
    v_cos_f32 v33, v27
    v_sin_f32 v34, v26
    v_sin_f32 v35, v27
    s_nop 0
    v_pk_mul_f32 v[32:33], v[24:25], v[32:33]
    v_pk_mul_f32 v[34:35], v[24:25], v[34:35]

    v_mul_f32 v24, v95, v34
    v_mul_f32 v25, v95, v32
    v_cvt_pk_f16_f32 v43, v33, v35
    v_fma_f32 v36, v94, v32, -v24
    v_fma_f32 v37, -v94, v34, -v25
    v_cvt_pk_f16_f32 v59, v36, v37
    v_fma_mix_f32 v36, v59, -1.0, v36 op_sel_hi:[1,0,0]
    v_fma_mix_f32 v37, v59, -1.0, v37 op_sel:[1,0,0] op_sel_hi:[1,0,0]
    v_cvt_pk_f16_f32 v131, v36, v37

    v_pk_mul_f32 v[24:25], v[34:35], v[34:35]
    v_pk_add_f32 v[26:27], v[32:33], v[32:33]
    v_pk_fma_f32 v[32:33], v[32:33], v[32:33], v[24:25] neg_lo:[0,0,1] neg_hi:[0,0,1]
    v_pk_mul_f32 v[34:35], v[26:27], v[34:35]

    v_mul_f32 v24, v95, v34
    v_mul_f32 v25, v95, v32
    v_cvt_pk_f16_f32 v47, v33, v35
    v_fma_f32 v36, v94, v32, -v24
    v_fma_f32 v37, -v94, v34, -v25
    v_cvt_pk_f16_f32 v63, v36, v37
    v_fma_mix_f32 v36, v63, -1.0, v36 op_sel_hi:[1,0,0]
    v_fma_mix_f32 v37, v63, -1.0, v37 op_sel:[1,0,0] op_sel_hi:[1,0,0]
    v_cvt_pk_f16_f32 v135, v36, v37

    v_pk_mul_f32 v[24:25], v[34:35], v[34:35]
    v_pk_add_f32 v[26:27], v[32:33], v[32:33]
    v_pk_fma_f32 v[32:33], v[32:33], v[32:33], v[24:25] neg_lo:[0,0,1] neg_hi:[0,0,1]
    v_pk_mul_f32 v[34:35], v[26:27], v[34:35]

    v_mul_f32 v24, v95, v34
    v_mul_f32 v25, v95, v32
    v_cvt_pk_f16_f32 v51, v33, v35
    v_fma_f32 v36, v94, v32, -v24
    v_fma_f32 v37, -v94, v34, -v25
    v_cvt_pk_f16_f32 v67, v36, v37
    v_fma_mix_f32 v36, v67, -1.0, v36 op_sel_hi:[1,0,0]
    v_fma_mix_f32 v37, v67, -1.0, v37 op_sel:[1,0,0] op_sel_hi:[1,0,0]
    v_cvt_pk_f16_f32 v139, v36, v37

    v_pk_mul_f32 v[24:25], v[34:35], v[34:35]
    v_pk_add_f32 v[26:27], v[32:33], v[32:33]
    v_pk_fma_f32 v[32:33], v[32:33], v[32:33], v[24:25] neg_lo:[0,0,1] neg_hi:[0,0,1]
    v_pk_mul_f32 v[34:35], v[26:27], v[34:35]

    v_mul_f32 v24, v95, v34
    v_mul_f32 v25, v95, v32
    v_cvt_pk_f16_f32 v55, v33, v35
    v_fma_f32 v36, v94, v32, -v24
    v_fma_f32 v37, -v94, v34, -v25
    v_cvt_pk_f16_f32 v71, v36, v37
    v_fma_mix_f32 v36, v71, -1.0, v36 op_sel_hi:[1,0,0]
    v_fma_mix_f32 v37, v71, -1.0, v37 op_sel:[1,0,0] op_sel_hi:[1,0,0]
    v_cvt_pk_f16_f32 v143, v36, v37

    s_nop 1
    v_mfma_f32_16x16x32_f16 v[112:115], v[40:43], v[56:59], v[112:115]
    v_mfma_f32_16x16x32_f16 v[116:119], v[44:47], v[60:63], v[116:119]
    v_mfma_f32_16x16x32_f16 v[120:123], v[48:51], v[64:67], v[120:123]
    v_mfma_f32_16x16x32_f16 v[124:127], v[52:55], v[68:71], v[124:127]
    v_mfma_f32_16x16x32_f16 v[112:115], v[40:43], v[128:131], v[112:115]
    v_mfma_f32_16x16x32_f16 v[116:119], v[44:47], v[132:135], v[116:119]
    v_mfma_f32_16x16x32_f16 v[120:123], v[48:51], v[136:139], v[120:123]
    v_mfma_f32_16x16x32_f16 v[124:127], v[52:55], v[140:143], v[124:127]
    v_pk_mul_f32 v[24:25], v[96:97], v[30:31] op_sel_hi:[0,1]
    v_pk_mul_f32 v[26:27], v[96:97], v[30:31] op_sel:[1,0] op_sel_hi:[1,1]
    v_pk_mul_f32 v[98:99], v[98:99], v[28:29] op_sel:[0,1] op_sel_hi:[1,1]
    v_exp_f32 v24, v24
    v_exp_f32 v25, v25
    v_fract_f32 v26, v26
    v_fract_f32 v27, v27
    v_cos_f32 v32, v26
    v_cos_f32 v33, v27
    v_sin_f32 v34, v26
    v_sin_f32 v35, v27
    s_nop 0
    v_pk_mul_f32 v[32:33], v[24:25], v[32:33]
    v_pk_mul_f32 v[34:35], v[24:25], v[34:35]

    v_mul_f32 v24, v99, v34
    v_mul_f32 v25, v99, v32
    v_cvt_pk_f16_f32 v40, v33, v35
    v_fma_f32 v36, v98, v32, -v24
    v_fma_f32 v37, -v98, v34, -v25
    v_cvt_pk_f16_f32 v56, v36, v37
    v_fma_mix_f32 v36, v56, -1.0, v36 op_sel_hi:[1,0,0]
    v_fma_mix_f32 v37, v56, -1.0, v37 op_sel:[1,0,0] op_sel_hi:[1,0,0]
    v_cvt_pk_f16_f32 v128, v36, v37

    v_pk_mul_f32 v[24:25], v[34:35], v[34:35]
    v_pk_add_f32 v[26:27], v[32:33], v[32:33]
    v_pk_fma_f32 v[32:33], v[32:33], v[32:33], v[24:25] neg_lo:[0,0,1] neg_hi:[0,0,1]
    v_pk_mul_f32 v[34:35], v[26:27], v[34:35]

    v_mul_f32 v24, v99, v34
    v_mul_f32 v25, v99, v32
    v_cvt_pk_f16_f32 v44, v33, v35
    v_fma_f32 v36, v98, v32, -v24
    v_fma_f32 v37, -v98, v34, -v25
    v_cvt_pk_f16_f32 v60, v36, v37
    v_fma_mix_f32 v36, v60, -1.0, v36 op_sel_hi:[1,0,0]
    v_fma_mix_f32 v37, v60, -1.0, v37 op_sel:[1,0,0] op_sel_hi:[1,0,0]
    v_cvt_pk_f16_f32 v132, v36, v37

    v_pk_mul_f32 v[24:25], v[34:35], v[34:35]
    v_pk_add_f32 v[26:27], v[32:33], v[32:33]
    v_pk_fma_f32 v[32:33], v[32:33], v[32:33], v[24:25] neg_lo:[0,0,1] neg_hi:[0,0,1]
    v_pk_mul_f32 v[34:35], v[26:27], v[34:35]

    v_mul_f32 v24, v99, v34
    v_mul_f32 v25, v99, v32
    v_cvt_pk_f16_f32 v48, v33, v35
    v_fma_f32 v36, v98, v32, -v24
    v_fma_f32 v37, -v98, v34, -v25
    v_cvt_pk_f16_f32 v64, v36, v37
    v_fma_mix_f32 v36, v64, -1.0, v36 op_sel_hi:[1,0,0]
    v_fma_mix_f32 v37, v64, -1.0, v37 op_sel:[1,0,0] op_sel_hi:[1,0,0]
    v_cvt_pk_f16_f32 v136, v36, v37

    v_pk_mul_f32 v[24:25], v[34:35], v[34:35]
    v_pk_add_f32 v[26:27], v[32:33], v[32:33]
    v_pk_fma_f32 v[32:33], v[32:33], v[32:33], v[24:25] neg_lo:[0,0,1] neg_hi:[0,0,1]
    v_pk_mul_f32 v[34:35], v[26:27], v[34:35]

    v_mul_f32 v24, v99, v34
    v_mul_f32 v25, v99, v32
    v_cvt_pk_f16_f32 v52, v33, v35
    v_fma_f32 v36, v98, v32, -v24
    v_fma_f32 v37, -v98, v34, -v25
    v_cvt_pk_f16_f32 v68, v36, v37
    v_fma_mix_f32 v36, v68, -1.0, v36 op_sel_hi:[1,0,0]
    v_fma_mix_f32 v37, v68, -1.0, v37 op_sel:[1,0,0] op_sel_hi:[1,0,0]
    v_cvt_pk_f16_f32 v140, v36, v37

    v_pk_mul_f32 v[24:25], v[100:101], v[30:31] op_sel_hi:[0,1]
    v_pk_mul_f32 v[26:27], v[100:101], v[30:31] op_sel:[1,0] op_sel_hi:[1,1]
    v_pk_mul_f32 v[102:103], v[102:103], v[28:29] op_sel:[0,1] op_sel_hi:[1,1]
    v_exp_f32 v24, v24
    v_exp_f32 v25, v25
    v_fract_f32 v26, v26
    v_fract_f32 v27, v27
    v_cos_f32 v32, v26
    v_cos_f32 v33, v27
    v_sin_f32 v34, v26
    v_sin_f32 v35, v27
    s_nop 0
    v_pk_mul_f32 v[32:33], v[24:25], v[32:33]
    v_pk_mul_f32 v[34:35], v[24:25], v[34:35]

    v_mul_f32 v24, v103, v34
    v_mul_f32 v25, v103, v32
    v_cvt_pk_f16_f32 v41, v33, v35
    v_fma_f32 v36, v102, v32, -v24
    v_fma_f32 v37, -v102, v34, -v25
    v_cvt_pk_f16_f32 v57, v36, v37
    v_fma_mix_f32 v36, v57, -1.0, v36 op_sel_hi:[1,0,0]
    v_fma_mix_f32 v37, v57, -1.0, v37 op_sel:[1,0,0] op_sel_hi:[1,0,0]
    v_cvt_pk_f16_f32 v129, v36, v37

    v_pk_mul_f32 v[24:25], v[34:35], v[34:35]
    v_pk_add_f32 v[26:27], v[32:33], v[32:33]
    v_pk_fma_f32 v[32:33], v[32:33], v[32:33], v[24:25] neg_lo:[0,0,1] neg_hi:[0,0,1]
    v_pk_mul_f32 v[34:35], v[26:27], v[34:35]

    v_mul_f32 v24, v103, v34
    v_mul_f32 v25, v103, v32
    v_cvt_pk_f16_f32 v45, v33, v35
    v_fma_f32 v36, v102, v32, -v24
    v_fma_f32 v37, -v102, v34, -v25
    v_cvt_pk_f16_f32 v61, v36, v37
    v_fma_mix_f32 v36, v61, -1.0, v36 op_sel_hi:[1,0,0]
    v_fma_mix_f32 v37, v61, -1.0, v37 op_sel:[1,0,0] op_sel_hi:[1,0,0]
    v_cvt_pk_f16_f32 v133, v36, v37

    v_pk_mul_f32 v[24:25], v[34:35], v[34:35]
    v_pk_add_f32 v[26:27], v[32:33], v[32:33]
    v_pk_fma_f32 v[32:33], v[32:33], v[32:33], v[24:25] neg_lo:[0,0,1] neg_hi:[0,0,1]
    v_pk_mul_f32 v[34:35], v[26:27], v[34:35]

    v_mul_f32 v24, v103, v34
    v_mul_f32 v25, v103, v32
    v_cvt_pk_f16_f32 v49, v33, v35
    v_fma_f32 v36, v102, v32, -v24
    v_fma_f32 v37, -v102, v34, -v25
    v_cvt_pk_f16_f32 v65, v36, v37
    v_fma_mix_f32 v36, v65, -1.0, v36 op_sel_hi:[1,0,0]
    v_fma_mix_f32 v37, v65, -1.0, v37 op_sel:[1,0,0] op_sel_hi:[1,0,0]
    v_cvt_pk_f16_f32 v137, v36, v37

    v_pk_mul_f32 v[24:25], v[34:35], v[34:35]
    v_pk_add_f32 v[26:27], v[32:33], v[32:33]
    v_pk_fma_f32 v[32:33], v[32:33], v[32:33], v[24:25] neg_lo:[0,0,1] neg_hi:[0,0,1]
    v_pk_mul_f32 v[34:35], v[26:27], v[34:35]

    v_mul_f32 v24, v103, v34
    v_mul_f32 v25, v103, v32
    v_cvt_pk_f16_f32 v53, v33, v35
    v_fma_f32 v36, v102, v32, -v24
    v_fma_f32 v37, -v102, v34, -v25
    v_cvt_pk_f16_f32 v69, v36, v37
    v_fma_mix_f32 v36, v69, -1.0, v36 op_sel_hi:[1,0,0]
    v_fma_mix_f32 v37, v69, -1.0, v37 op_sel:[1,0,0] op_sel_hi:[1,0,0]
    v_cvt_pk_f16_f32 v141, v36, v37

    v_pk_mul_f32 v[24:25], v[104:105], v[30:31] op_sel_hi:[0,1]
    v_pk_mul_f32 v[26:27], v[104:105], v[30:31] op_sel:[1,0] op_sel_hi:[1,1]
    v_pk_mul_f32 v[106:107], v[106:107], v[28:29] op_sel:[0,1] op_sel_hi:[1,1]
    v_exp_f32 v24, v24
    v_exp_f32 v25, v25
    v_fract_f32 v26, v26
    v_fract_f32 v27, v27
    v_cos_f32 v32, v26
    v_cos_f32 v33, v27
    v_sin_f32 v34, v26
    v_sin_f32 v35, v27
    s_nop 0
    v_pk_mul_f32 v[32:33], v[24:25], v[32:33]
    v_pk_mul_f32 v[34:35], v[24:25], v[34:35]

    v_mul_f32 v24, v107, v34
    v_mul_f32 v25, v107, v32
    v_cvt_pk_f16_f32 v42, v33, v35
    v_fma_f32 v36, v106, v32, -v24
    v_fma_f32 v37, -v106, v34, -v25
    v_cvt_pk_f16_f32 v58, v36, v37
    v_fma_mix_f32 v36, v58, -1.0, v36 op_sel_hi:[1,0,0]
    v_fma_mix_f32 v37, v58, -1.0, v37 op_sel:[1,0,0] op_sel_hi:[1,0,0]
    v_cvt_pk_f16_f32 v130, v36, v37

    v_pk_mul_f32 v[24:25], v[34:35], v[34:35]
    v_pk_add_f32 v[26:27], v[32:33], v[32:33]
    v_pk_fma_f32 v[32:33], v[32:33], v[32:33], v[24:25] neg_lo:[0,0,1] neg_hi:[0,0,1]
    v_pk_mul_f32 v[34:35], v[26:27], v[34:35]

    v_mul_f32 v24, v107, v34
    v_mul_f32 v25, v107, v32
    v_cvt_pk_f16_f32 v46, v33, v35
    v_fma_f32 v36, v106, v32, -v24
    v_fma_f32 v37, -v106, v34, -v25
    v_cvt_pk_f16_f32 v62, v36, v37
    v_fma_mix_f32 v36, v62, -1.0, v36 op_sel_hi:[1,0,0]
    v_fma_mix_f32 v37, v62, -1.0, v37 op_sel:[1,0,0] op_sel_hi:[1,0,0]
    v_cvt_pk_f16_f32 v134, v36, v37

    v_pk_mul_f32 v[24:25], v[34:35], v[34:35]
    v_pk_add_f32 v[26:27], v[32:33], v[32:33]
    v_pk_fma_f32 v[32:33], v[32:33], v[32:33], v[24:25] neg_lo:[0,0,1] neg_hi:[0,0,1]
    v_pk_mul_f32 v[34:35], v[26:27], v[34:35]

    v_mul_f32 v24, v107, v34
    v_mul_f32 v25, v107, v32
    v_cvt_pk_f16_f32 v50, v33, v35
    v_fma_f32 v36, v106, v32, -v24
    v_fma_f32 v37, -v106, v34, -v25
    v_cvt_pk_f16_f32 v66, v36, v37
    v_fma_mix_f32 v36, v66, -1.0, v36 op_sel_hi:[1,0,0]
    v_fma_mix_f32 v37, v66, -1.0, v37 op_sel:[1,0,0] op_sel_hi:[1,0,0]
    v_cvt_pk_f16_f32 v138, v36, v37

    v_pk_mul_f32 v[24:25], v[34:35], v[34:35]
    v_pk_add_f32 v[26:27], v[32:33], v[32:33]
    v_pk_fma_f32 v[32:33], v[32:33], v[32:33], v[24:25] neg_lo:[0,0,1] neg_hi:[0,0,1]
    v_pk_mul_f32 v[34:35], v[26:27], v[34:35]

    v_mul_f32 v24, v107, v34
    v_mul_f32 v25, v107, v32
    v_cvt_pk_f16_f32 v54, v33, v35
    v_fma_f32 v36, v106, v32, -v24
    v_fma_f32 v37, -v106, v34, -v25
    v_cvt_pk_f16_f32 v70, v36, v37
    v_fma_mix_f32 v36, v70, -1.0, v36 op_sel_hi:[1,0,0]
    v_fma_mix_f32 v37, v70, -1.0, v37 op_sel:[1,0,0] op_sel_hi:[1,0,0]
    v_cvt_pk_f16_f32 v142, v36, v37

    v_pk_mul_f32 v[24:25], v[108:109], v[30:31] op_sel_hi:[0,1]
    v_pk_mul_f32 v[26:27], v[108:109], v[30:31] op_sel:[1,0] op_sel_hi:[1,1]
    v_pk_mul_f32 v[110:111], v[110:111], v[28:29] op_sel:[0,1] op_sel_hi:[1,1]
    v_exp_f32 v24, v24
    v_exp_f32 v25, v25
    v_fract_f32 v26, v26
    v_fract_f32 v27, v27
    v_cos_f32 v32, v26
    v_cos_f32 v33, v27
    v_sin_f32 v34, v26
    v_sin_f32 v35, v27
    s_nop 0
    v_pk_mul_f32 v[32:33], v[24:25], v[32:33]
    v_pk_mul_f32 v[34:35], v[24:25], v[34:35]

    v_mul_f32 v24, v111, v34
    v_mul_f32 v25, v111, v32
    v_cvt_pk_f16_f32 v43, v33, v35
    v_fma_f32 v36, v110, v32, -v24
    v_fma_f32 v37, -v110, v34, -v25
    v_cvt_pk_f16_f32 v59, v36, v37
    v_fma_mix_f32 v36, v59, -1.0, v36 op_sel_hi:[1,0,0]
    v_fma_mix_f32 v37, v59, -1.0, v37 op_sel:[1,0,0] op_sel_hi:[1,0,0]
    v_cvt_pk_f16_f32 v131, v36, v37

    v_pk_mul_f32 v[24:25], v[34:35], v[34:35]
    v_pk_add_f32 v[26:27], v[32:33], v[32:33]
    v_pk_fma_f32 v[32:33], v[32:33], v[32:33], v[24:25] neg_lo:[0,0,1] neg_hi:[0,0,1]
    v_pk_mul_f32 v[34:35], v[26:27], v[34:35]

    v_mul_f32 v24, v111, v34
    v_mul_f32 v25, v111, v32
    v_cvt_pk_f16_f32 v47, v33, v35
    v_fma_f32 v36, v110, v32, -v24
    v_fma_f32 v37, -v110, v34, -v25
    v_cvt_pk_f16_f32 v63, v36, v37
    v_fma_mix_f32 v36, v63, -1.0, v36 op_sel_hi:[1,0,0]
    v_fma_mix_f32 v37, v63, -1.0, v37 op_sel:[1,0,0] op_sel_hi:[1,0,0]
    v_cvt_pk_f16_f32 v135, v36, v37

    v_pk_mul_f32 v[24:25], v[34:35], v[34:35]
    v_pk_add_f32 v[26:27], v[32:33], v[32:33]
    v_pk_fma_f32 v[32:33], v[32:33], v[32:33], v[24:25] neg_lo:[0,0,1] neg_hi:[0,0,1]
    v_pk_mul_f32 v[34:35], v[26:27], v[34:35]

    v_mul_f32 v24, v111, v34
    v_mul_f32 v25, v111, v32
    v_cvt_pk_f16_f32 v51, v33, v35
    v_fma_f32 v36, v110, v32, -v24
    v_fma_f32 v37, -v110, v34, -v25
    v_cvt_pk_f16_f32 v67, v36, v37
    v_fma_mix_f32 v36, v67, -1.0, v36 op_sel_hi:[1,0,0]
    v_fma_mix_f32 v37, v67, -1.0, v37 op_sel:[1,0,0] op_sel_hi:[1,0,0]
    v_cvt_pk_f16_f32 v139, v36, v37

    v_pk_mul_f32 v[24:25], v[34:35], v[34:35]
    v_pk_add_f32 v[26:27], v[32:33], v[32:33]
    v_pk_fma_f32 v[32:33], v[32:33], v[32:33], v[24:25] neg_lo:[0,0,1] neg_hi:[0,0,1]
    v_pk_mul_f32 v[34:35], v[26:27], v[34:35]

    v_mul_f32 v24, v111, v34
    v_mul_f32 v25, v111, v32
    v_cvt_pk_f16_f32 v55, v33, v35
    v_fma_f32 v36, v110, v32, -v24
    v_fma_f32 v37, -v110, v34, -v25
    v_cvt_pk_f16_f32 v71, v36, v37
    v_fma_mix_f32 v36, v71, -1.0, v36 op_sel_hi:[1,0,0]
    v_fma_mix_f32 v37, v71, -1.0, v37 op_sel:[1,0,0] op_sel_hi:[1,0,0]
    v_cvt_pk_f16_f32 v143, v36, v37

    s_nop 1
    v_mfma_f32_16x16x32_f16 v[112:115], v[40:43], v[56:59], v[112:115]
    v_mfma_f32_16x16x32_f16 v[116:119], v[44:47], v[60:63], v[116:119]
    v_mfma_f32_16x16x32_f16 v[120:123], v[48:51], v[64:67], v[120:123]
    v_mfma_f32_16x16x32_f16 v[124:127], v[52:55], v[68:71], v[124:127]
    v_mfma_f32_16x16x32_f16 v[112:115], v[40:43], v[128:131], v[112:115]
    v_mfma_f32_16x16x32_f16 v[116:119], v[44:47], v[132:135], v[116:119]
    v_mfma_f32_16x16x32_f16 v[120:123], v[48:51], v[136:139], v[120:123]
    v_mfma_f32_16x16x32_f16 v[124:127], v[52:55], v[140:143], v[124:127]
    v_lshlrev_b32 v10, 6, v3
    v_lshl_add_u32 v10, v4, 4, v10
    v_add_u32 v10, v10, v8
    s_nop 7

    ds_write_b128 v10, v[112:115] offset:0
    ds_write_b128 v10, v[116:119] offset:1024
    ds_write_b128 v10, v[120:123] offset:2048
    ds_write_b128 v10, v[124:127] offset:3072
    s_waitcnt lgkmcnt(0)
    s_barrier
    ds_read_b32 v32, v72 offset:2048
    ds_read_b32 v33, v72 offset:7168
    ds_read_b32 v34, v72 offset:12288
    ds_read_b32 v35, v72 offset:17408

    ds_read_b32 v36, v73 offset:2048
    ds_read_b32 v37, v73 offset:7168
    ds_read_b32 v38, v73 offset:12288
    ds_read_b32 v39, v73 offset:17408

    ds_read_b32 v40, v74 offset:2048
    ds_read_b32 v41, v74 offset:7168
    ds_read_b32 v42, v74 offset:12288
    ds_read_b32 v43, v74 offset:17408

    ds_read_b32 v44, v75 offset:2048
    ds_read_b32 v45, v75 offset:7168
    ds_read_b32 v46, v75 offset:12288
    ds_read_b32 v47, v75 offset:17408

    ds_read_b32 v48, v76 offset:2048
    ds_read_b32 v49, v76 offset:7168
    ds_read_b32 v50, v76 offset:12288
    ds_read_b32 v51, v76 offset:17408

    ds_read_b32 v52, v77 offset:2048
    ds_read_b32 v53, v77 offset:7168
    ds_read_b32 v54, v77 offset:12288
    ds_read_b32 v55, v77 offset:17408

    ds_read_b32 v56, v78 offset:2048
    ds_read_b32 v57, v78 offset:7168
    ds_read_b32 v58, v78 offset:12288
    ds_read_b32 v59, v78 offset:17408

    ds_read_b32 v60, v79 offset:2048
    ds_read_b32 v61, v79 offset:7168
    ds_read_b32 v62, v79 offset:12288
    ds_read_b32 v63, v79 offset:17408

    s_waitcnt lgkmcnt(0)
    v_add_f32 v32, v32, v33
    v_add_f32 v34, v34, v35
    v_add_f32 v20, v32, v34
    v_add_f32 v36, v36, v37
    v_add_f32 v38, v38, v39
    v_add_f32 v21, v36, v38
    v_add_f32 v40, v40, v41
    v_add_f32 v42, v42, v43
    v_add_f32 v22, v40, v42
    v_add_f32 v44, v44, v45
    v_add_f32 v46, v46, v47
    v_add_f32 v23, v44, v46
    v_add_f32 v48, v48, v49
    v_add_f32 v50, v50, v51
    v_add_f32 v24, v48, v50
    v_add_f32 v52, v52, v53
    v_add_f32 v54, v54, v55
    v_add_f32 v25, v52, v54
    v_add_f32 v56, v56, v57
    v_add_f32 v58, v58, v59
    v_add_f32 v26, v56, v58
    v_add_f32 v60, v60, v61
    v_add_f32 v62, v62, v63
    v_add_f32 v27, v60, v62
    v_max_f32 v12, abs(v20), abs(v21)
    v_max3_f32 v12, abs(v22), abs(v23), v12
    v_max3_f32 v12, abs(v24), abs(v25), v12
    v_max3_f32 v12, abs(v26), abs(v27), v12
    s_nop 1
    v_max_f32_dpp v13, v12, v12 quad_perm:[1,0,3,2] row_mask:0xf bank_mask:0xf
    s_nop 1
    v_max_f32_dpp v12, v13, v13 quad_perm:[2,3,0,1] row_mask:0xf bank_mask:0xf
    s_nop 1
    v_max_f32_dpp v13, v12, v12 row_half_mirror row_mask:0xf bank_mask:0xf
    s_nop 1
    v_max_f32_dpp v12, v13, v13 row_mirror row_mask:0xf bank_mask:0xf
    v_lshrrev_b32 v14, 4, v0
    v_lshlrev_b32 v14, 2, v14
    ds_write_b32 v14, v12 offset:22592
    s_waitcnt lgkmcnt(0)
    s_barrier
    v_lshlrev_b32 v14, 2, v3
    ds_read_b32 v12, v14 offset:22592
    s_waitcnt lgkmcnt(0)
    s_nop 1
    v_max_f32_dpp v13, v12, v12 quad_perm:[1,0,3,2] row_mask:0xf bank_mask:0xf
    s_nop 1
    v_max_f32_dpp v12, v13, v13 quad_perm:[2,3,0,1] row_mask:0xf bank_mask:0xf
    s_nop 1
    v_max_f32_dpp v13, v12, v12 row_half_mirror row_mask:0xf bank_mask:0xf
    s_nop 1
    v_max_f32_dpp v12, v13, v13 row_mirror row_mask:0xf bank_mask:0xf
    v_lshrrev_b32 v13, 23, v12
    v_sub_u32 v13, 267, v13
    v_min_u32 v13, 253, v13
    v_max_u32 v13, 1, v13
    v_add_u32 v14, v13, v15
    v_sub_u32 v14, 381, v14
    v_max_i32 v14, 1, v14
    v_min_i32 v14, 254, v14
    v_lshlrev_b32 v13, 23, v13
    v_lshlrev_b32 v14, 23, v14

    v_mul_f32 v20, v13, v20
    v_mul_f32 v21, v13, v21
    v_mul_f32 v22, v13, v22
    v_mul_f32 v23, v13, v23
    v_mul_f32 v24, v13, v24
    v_mul_f32 v25, v13, v25
    v_mul_f32 v26, v13, v26
    v_mul_f32 v27, v13, v27
    v_cvt_pk_f16_f32 v32, v20, v21
    v_cvt_pk_f16_f32 v33, v22, v23
    v_cvt_pk_f16_f32 v34, v24, v25
    v_cvt_pk_f16_f32 v35, v26, v27
    v_lshlrev_b32 v6, 4, v0
    v_readfirstlane_b32 s32, v14
    v_readfirstlane_b32 s3, v1
    ds_write_b128 v6, v[32:35] offset:35072
    v_mov_b32 v36, 0
    v_mov_b32 v37, 0
    v_mov_b32 v38, 0
    v_mov_b32 v39, 0
    v_cmp_gt_u32 vcc, 16, v0
    s_and_saveexec_b64 s[24:25], vcc
    ds_write_b128 v6, v[36:39] offset:39168
    s_mov_b64 exec, -1

    s_add_u32 s8, s22, 50331648
    s_addc_u32 s9, s23, 0
    s_and_b32 s9, s9, 0xffff
    s_mov_b32 s10, 2506752
    s_mov_b32 s11, 0x00020000
    s_add_u32 s16, s22, 53477376
    s_addc_u32 s17, s23, 0
    s_and_b32 s17, s17, 0xffff
    s_mov_b32 s18, 2506752
    s_mov_b32 s19, 0x00020000
    s_mul_i32 s28, s2, 4352
    v_mov_b32 v2, 0
    s_mov_b32 s5, 0
    s_cmp_lg_u32 s3, 0
    s_cbranch_scc1 front_kernel_go
front_kernel_poll:
    global_load_dword v3, v2, s[44:45] offset:128 sc1
    s_waitcnt vmcnt(0)
    v_readfirstlane_b32 s4, v3
    s_add_u32 s5, s5, 1
    s_cmp_ge_u32 s5, 0x40000
    s_cbranch_scc1 front_kernel_go
    s_cmp_ge_u32 s4, 1
    s_cbranch_scc1 front_kernel_go
    s_sleep 8
    s_branch front_kernel_poll

front_kernel_go:
    s_waitcnt lgkmcnt(0)
    s_barrier
    buffer_load_dwordx4 v[8:11], v6, s[8:11], s28 offen sc1

    v_cmp_gt_u32 vcc, 18, v0
    s_and_saveexec_b64 s[24:25], vcc
    ds_write_b128 v6, v[36:39] offset:30656
    s_mov_b64 exec, -1
    s_waitcnt vmcnt(0)
    ds_write_b128 v6, v[8:11] offset:30944
    v_and_b32 v2, 63, v0
    v_and_b32 v40, 15, v2
    v_lshrrev_b32 v41, 4, v2
    v_sub_u32 v42, v41, v40
    v_lshlrev_b32 v42, 4, v42
    v_add_u32 v42, 35312, v42
    v_and_b32 v43, 3, v40
    v_lshrrev_b32 v44, 3, v40
    v_lshl_add_u32 v43, v44, 2, v43
    v_lshrrev_b32 v45, 2, v40
    v_xor_b32 v45, v45, v44
    v_and_b32 v45, 1, v45
    v_mul_u32_u24 v43, 4384, v43
    v_lshl_add_u32 v43, v45, 8, v43
    v_lshl_add_u32 v43, v41, 4, v43
    v_lshrrev_b32 v44, 1, v41
    v_xor_b32 v45, v41, v44
    v_and_b32 v45, 1, v45
    v_lshlrev_b32 v46, 4, v40
    v_lshl_add_u32 v46, v45, 8, v46
    v_lshl_add_u32 v46, v44, 3, v46
    s_waitcnt lgkmcnt(0)
    s_barrier

    ds_read_b128 v[48:51], v6 offset:30672
    ds_read_b128 v[52:55], v6 offset:30688
    s_waitcnt lgkmcnt(0)
    v_alignbit_b32 v8, v49, v48, 16
    v_alignbit_b32 v9, v50, v49, 16
    v_alignbit_b32 v10, v51, v50, 16
    v_alignbit_b32 v11, v52, v51, 16
    ds_write_b128 v6, v[8:11] offset:0
    v_mov_b32 v12, v49
    v_mov_b32 v13, v50
    v_mov_b32 v14, v51
    v_mov_b32 v15, v52
    ds_write_b128 v6, v[12:15] offset:4384
    v_alignbit_b32 v16, v50, v49, 16
    v_alignbit_b32 v17, v51, v50, 16
    v_alignbit_b32 v18, v52, v51, 16
    v_alignbit_b32 v19, v53, v52, 16
    ds_write_b128 v6, v[16:19] offset:8768
    ds_write_b128 v6, v[50:53] offset:13152
    v_alignbit_b32 v24, v51, v50, 16
    v_alignbit_b32 v25, v52, v51, 16
    v_alignbit_b32 v26, v53, v52, 16
    v_alignbit_b32 v27, v54, v53, 16
    ds_write_b128 v6, v[24:27] offset:17536
    v_mov_b32 v28, v51
    v_mov_b32 v29, v52
    v_mov_b32 v30, v53
    v_mov_b32 v31, v54
    ds_write_b128 v6, v[28:31] offset:21920
    v_alignbit_b32 v32, v52, v51, 16
    v_alignbit_b32 v33, v53, v52, 16
    v_alignbit_b32 v34, v54, v53, 16
    v_alignbit_b32 v35, v55, v54, 16
    ds_write_b128 v6, v[32:35] offset:26304
    v_cmp_gt_u32 vcc, 16, v0
    s_and_saveexec_b64 s[24:25], vcc
    s_cbranch_execz front_kernel_bdone
    ds_read_b128 v[56:59], v6 offset:34768
    ds_read_b128 v[60:63], v6 offset:34784
    s_waitcnt lgkmcnt(0)
    v_alignbit_b32 v8, v57, v56, 16
    v_alignbit_b32 v9, v58, v57, 16
    v_alignbit_b32 v10, v59, v58, 16
    v_alignbit_b32 v11, v60, v59, 16
    ds_write_b128 v6, v[8:11] offset:4096
    v_mov_b32 v12, v57
    v_mov_b32 v13, v58
    v_mov_b32 v14, v59
    v_mov_b32 v15, v60
    ds_write_b128 v6, v[12:15] offset:8480
    v_alignbit_b32 v16, v58, v57, 16
    v_alignbit_b32 v17, v59, v58, 16
    v_alignbit_b32 v18, v60, v59, 16
    v_alignbit_b32 v19, v61, v60, 16
    ds_write_b128 v6, v[16:19] offset:12864
    ds_write_b128 v6, v[58:61] offset:17248
    v_alignbit_b32 v24, v59, v58, 16
    v_alignbit_b32 v25, v60, v59, 16
    v_alignbit_b32 v26, v61, v60, 16
    v_alignbit_b32 v27, v62, v61, 16
    ds_write_b128 v6, v[24:27] offset:21632
    v_mov_b32 v28, v59
    v_mov_b32 v29, v60
    v_mov_b32 v30, v61
    v_mov_b32 v31, v62
    ds_write_b128 v6, v[28:31] offset:26016
    v_alignbit_b32 v32, v60, v59, 16
    v_alignbit_b32 v33, v61, v60, 16
    v_alignbit_b32 v34, v62, v61, 16
    v_alignbit_b32 v35, v63, v62, 16
    ds_write_b128 v6, v[32:35] offset:30400
front_kernel_bdone:
    s_mov_b64 exec, -1
    s_waitcnt lgkmcnt(0)
    s_barrier

    v_mov_b32 v4, v42
    v_mov_b32 v5, v43
    v_mov_b32 v7, v46
    s_lshr_b32 s4, s3, 1
    s_and_b32 s5, s2, 1
    s_cmp_lg_u32 s4, s5
    s_cbranch_scc1 front_kernel_fin
    s_and_b32 s4, s3, 1
    s_cmp_eq_u32 s4, 1
    s_cbranch_scc1 front_kernel_mB

    v_mov_b32 v16, 0
    v_mov_b32 v17, 0
    v_mov_b32 v18, 0
    v_mov_b32 v19, 0
    v_mov_b32 v20, 0
    v_mov_b32 v21, 0
    v_mov_b32 v22, 0
    v_mov_b32 v23, 0
    v_mov_b32 v24, 0
    v_mov_b32 v25, 0
    v_mov_b32 v26, 0
    v_mov_b32 v27, 0
    v_mov_b32 v28, 0
    v_mov_b32 v29, 0
    v_mov_b32 v30, 0
    v_mov_b32 v31, 0
    ds_read_b128 v[32:35], v4 offset:4032
    ds_read_b128 v[64:67], v5 offset:448
    ds_read_b128 v[36:39], v4 offset:3520
    ds_read_b128 v[68:71], v5 offset:960
    ds_read_b128 v[40:43], v4 offset:3008
    ds_read_b128 v[72:75], v5 offset:1472
    ds_read_b128 v[44:47], v4 offset:2496
    ds_read_b128 v[76:79], v5 offset:1984
    ds_read_b128 v[48:51], v4 offset:1984
    ds_read_b128 v[80:83], v5 offset:2496
    ds_read_b128 v[52:55], v4 offset:1472
    ds_read_b128 v[84:87], v5 offset:3008
    ds_read_b128 v[56:59], v4 offset:960
    ds_read_b128 v[88:91], v5 offset:3520
    ds_read_b128 v[60:63], v4 offset:448
    ds_read_b128 v[92:95], v5 offset:4032
    s_waitcnt lgkmcnt(14)
    v_mfma_f32_16x16x32_f16 v[16:19], v[64:67], v[32:35], v[16:19]
    ds_read_b128 v[96:99], v4 offset:3968
    s_waitcnt lgkmcnt(9)
    v_mfma_f32_16x16x32_f16 v[20:23], v[76:79], v[32:35], v[20:23]
    ds_read_b128 v[128:131], v5 offset:384
    v_mfma_f32_16x16x32_f16 v[20:23], v[72:75], v[36:39], v[20:23]
    ds_read_b128 v[100:103], v4 offset:3456
    v_mfma_f32_16x16x32_f16 v[20:23], v[68:71], v[40:43], v[20:23]
    ds_read_b128 v[132:135], v5 offset:896
    v_mfma_f32_16x16x32_f16 v[20:23], v[64:67], v[44:47], v[20:23]
    ds_read_b128 v[104:107], v4 offset:2944
    s_waitcnt lgkmcnt(11)
    v_mfma_f32_16x16x32_f16 v[24:27], v[80:83], v[32:35], v[24:27]
    ds_read_b128 v[136:139], v5 offset:1408
    v_mfma_f32_16x16x32_f16 v[24:27], v[76:79], v[36:39], v[24:27]
    ds_read_b128 v[108:111], v4 offset:2432
    v_mfma_f32_16x16x32_f16 v[24:27], v[72:75], v[40:43], v[24:27]
    ds_read_b128 v[140:143], v5 offset:1920
    v_mfma_f32_16x16x32_f16 v[24:27], v[68:71], v[44:47], v[24:27]
    ds_read_b128 v[112:115], v4 offset:1920
    v_mfma_f32_16x16x32_f16 v[24:27], v[64:67], v[48:51], v[24:27]
    ds_read_b128 v[144:147], v5 offset:2432
    s_waitcnt lgkmcnt(10)
    v_mfma_f32_16x16x32_f16 v[28:31], v[92:95], v[32:35], v[28:31]
    ds_read_b128 v[116:119], v4 offset:1408
    v_mfma_f32_16x16x32_f16 v[28:31], v[88:91], v[36:39], v[28:31]
    ds_read_b128 v[148:151], v5 offset:2944
    v_mfma_f32_16x16x32_f16 v[28:31], v[84:87], v[40:43], v[28:31]
    ds_read_b128 v[120:123], v4 offset:896
    v_mfma_f32_16x16x32_f16 v[28:31], v[80:83], v[44:47], v[28:31]
    ds_read_b128 v[152:155], v5 offset:3456
    v_mfma_f32_16x16x32_f16 v[28:31], v[76:79], v[48:51], v[28:31]
    ds_read_b128 v[124:127], v4 offset:384
    v_mfma_f32_16x16x32_f16 v[28:31], v[72:75], v[52:55], v[28:31]
    ds_read_b128 v[156:159], v5 offset:3968
    v_mfma_f32_16x16x32_f16 v[28:31], v[68:71], v[56:59], v[28:31]
    v_mfma_f32_16x16x32_f16 v[28:31], v[64:67], v[60:63], v[28:31]
    s_waitcnt lgkmcnt(14)
    v_mfma_f32_16x16x32_f16 v[16:19], v[128:131], v[96:99], v[16:19]
    ds_read_b128 v[32:35], v4 offset:3904
    s_waitcnt lgkmcnt(9)
    v_mfma_f32_16x16x32_f16 v[20:23], v[140:143], v[96:99], v[20:23]
    ds_read_b128 v[64:67], v5 offset:320
    v_mfma_f32_16x16x32_f16 v[20:23], v[136:139], v[100:103], v[20:23]
    ds_read_b128 v[36:39], v4 offset:3392
    v_mfma_f32_16x16x32_f16 v[20:23], v[132:135], v[104:107], v[20:23]
    ds_read_b128 v[68:71], v5 offset:832
    v_mfma_f32_16x16x32_f16 v[20:23], v[128:131], v[108:111], v[20:23]
    ds_read_b128 v[40:43], v4 offset:2880
    s_waitcnt lgkmcnt(11)
    v_mfma_f32_16x16x32_f16 v[24:27], v[144:147], v[96:99], v[24:27]
    ds_read_b128 v[72:75], v5 offset:1344
    v_mfma_f32_16x16x32_f16 v[24:27], v[140:143], v[100:103], v[24:27]
    ds_read_b128 v[44:47], v4 offset:2368
    v_mfma_f32_16x16x32_f16 v[24:27], v[136:139], v[104:107], v[24:27]
    ds_read_b128 v[76:79], v5 offset:1856
    v_mfma_f32_16x16x32_f16 v[24:27], v[132:135], v[108:111], v[24:27]
    ds_read_b128 v[48:51], v4 offset:1856
    v_mfma_f32_16x16x32_f16 v[24:27], v[128:131], v[112:115], v[24:27]
    ds_read_b128 v[80:83], v5 offset:2368
    s_waitcnt lgkmcnt(10)
    v_mfma_f32_16x16x32_f16 v[28:31], v[156:159], v[96:99], v[28:31]
    ds_read_b128 v[52:55], v4 offset:1344
    v_mfma_f32_16x16x32_f16 v[28:31], v[152:155], v[100:103], v[28:31]
    ds_read_b128 v[84:87], v5 offset:2880
    v_mfma_f32_16x16x32_f16 v[28:31], v[148:151], v[104:107], v[28:31]
    ds_read_b128 v[56:59], v4 offset:832
    v_mfma_f32_16x16x32_f16 v[28:31], v[144:147], v[108:111], v[28:31]
    ds_read_b128 v[88:91], v5 offset:3392
    v_mfma_f32_16x16x32_f16 v[28:31], v[140:143], v[112:115], v[28:31]
    ds_read_b128 v[60:63], v4 offset:320
    v_mfma_f32_16x16x32_f16 v[28:31], v[136:139], v[116:119], v[28:31]
    ds_read_b128 v[92:95], v5 offset:3904
    v_mfma_f32_16x16x32_f16 v[28:31], v[132:135], v[120:123], v[28:31]
    v_mfma_f32_16x16x32_f16 v[28:31], v[128:131], v[124:127], v[28:31]
    s_waitcnt lgkmcnt(14)
    v_mfma_f32_16x16x32_f16 v[16:19], v[64:67], v[32:35], v[16:19]
    ds_read_b128 v[96:99], v4 offset:3840
    s_waitcnt lgkmcnt(9)
    v_mfma_f32_16x16x32_f16 v[20:23], v[76:79], v[32:35], v[20:23]
    ds_read_b128 v[128:131], v5 offset:256
    v_mfma_f32_16x16x32_f16 v[20:23], v[72:75], v[36:39], v[20:23]
    ds_read_b128 v[100:103], v4 offset:3328
    v_mfma_f32_16x16x32_f16 v[20:23], v[68:71], v[40:43], v[20:23]
    ds_read_b128 v[132:135], v5 offset:768
    v_mfma_f32_16x16x32_f16 v[20:23], v[64:67], v[44:47], v[20:23]
    ds_read_b128 v[104:107], v4 offset:2816
    s_waitcnt lgkmcnt(11)
    v_mfma_f32_16x16x32_f16 v[24:27], v[80:83], v[32:35], v[24:27]
    ds_read_b128 v[136:139], v5 offset:1280
    v_mfma_f32_16x16x32_f16 v[24:27], v[76:79], v[36:39], v[24:27]
    ds_read_b128 v[108:111], v4 offset:2304
    v_mfma_f32_16x16x32_f16 v[24:27], v[72:75], v[40:43], v[24:27]
    ds_read_b128 v[140:143], v5 offset:1792
    v_mfma_f32_16x16x32_f16 v[24:27], v[68:71], v[44:47], v[24:27]
    ds_read_b128 v[112:115], v4 offset:1792
    v_mfma_f32_16x16x32_f16 v[24:27], v[64:67], v[48:51], v[24:27]
    ds_read_b128 v[144:147], v5 offset:2304
    s_waitcnt lgkmcnt(10)
    v_mfma_f32_16x16x32_f16 v[28:31], v[92:95], v[32:35], v[28:31]
    ds_read_b128 v[116:119], v4 offset:1280
    v_mfma_f32_16x16x32_f16 v[28:31], v[88:91], v[36:39], v[28:31]
    ds_read_b128 v[148:151], v5 offset:2816
    v_mfma_f32_16x16x32_f16 v[28:31], v[84:87], v[40:43], v[28:31]
    ds_read_b128 v[120:123], v4 offset:768
    v_mfma_f32_16x16x32_f16 v[28:31], v[80:83], v[44:47], v[28:31]
    ds_read_b128 v[152:155], v5 offset:3328
    v_mfma_f32_16x16x32_f16 v[28:31], v[76:79], v[48:51], v[28:31]
    ds_read_b128 v[124:127], v4 offset:256
    v_mfma_f32_16x16x32_f16 v[28:31], v[72:75], v[52:55], v[28:31]
    ds_read_b128 v[156:159], v5 offset:3840
    v_mfma_f32_16x16x32_f16 v[28:31], v[68:71], v[56:59], v[28:31]
    v_mfma_f32_16x16x32_f16 v[28:31], v[64:67], v[60:63], v[28:31]
    s_waitcnt lgkmcnt(14)
    v_mfma_f32_16x16x32_f16 v[16:19], v[128:131], v[96:99], v[16:19]
    ds_read_b128 v[32:35], v4 offset:3776
    s_waitcnt lgkmcnt(9)
    v_mfma_f32_16x16x32_f16 v[20:23], v[140:143], v[96:99], v[20:23]
    ds_read_b128 v[64:67], v5 offset:192
    v_mfma_f32_16x16x32_f16 v[20:23], v[136:139], v[100:103], v[20:23]
    ds_read_b128 v[36:39], v4 offset:3264
    v_mfma_f32_16x16x32_f16 v[20:23], v[132:135], v[104:107], v[20:23]
    ds_read_b128 v[68:71], v5 offset:704
    v_mfma_f32_16x16x32_f16 v[20:23], v[128:131], v[108:111], v[20:23]
    ds_read_b128 v[40:43], v4 offset:2752
    s_waitcnt lgkmcnt(11)
    v_mfma_f32_16x16x32_f16 v[24:27], v[144:147], v[96:99], v[24:27]
    ds_read_b128 v[72:75], v5 offset:1216
    v_mfma_f32_16x16x32_f16 v[24:27], v[140:143], v[100:103], v[24:27]
    ds_read_b128 v[44:47], v4 offset:2240
    v_mfma_f32_16x16x32_f16 v[24:27], v[136:139], v[104:107], v[24:27]
    ds_read_b128 v[76:79], v5 offset:1728
    v_mfma_f32_16x16x32_f16 v[24:27], v[132:135], v[108:111], v[24:27]
    ds_read_b128 v[48:51], v4 offset:1728
    v_mfma_f32_16x16x32_f16 v[24:27], v[128:131], v[112:115], v[24:27]
    ds_read_b128 v[80:83], v5 offset:2240
    s_waitcnt lgkmcnt(10)
    v_mfma_f32_16x16x32_f16 v[28:31], v[156:159], v[96:99], v[28:31]
    ds_read_b128 v[52:55], v4 offset:1216
    v_mfma_f32_16x16x32_f16 v[28:31], v[152:155], v[100:103], v[28:31]
    ds_read_b128 v[84:87], v5 offset:2752
    v_mfma_f32_16x16x32_f16 v[28:31], v[148:151], v[104:107], v[28:31]
    ds_read_b128 v[56:59], v4 offset:704
    v_mfma_f32_16x16x32_f16 v[28:31], v[144:147], v[108:111], v[28:31]
    ds_read_b128 v[88:91], v5 offset:3264
    v_mfma_f32_16x16x32_f16 v[28:31], v[140:143], v[112:115], v[28:31]
    ds_read_b128 v[60:63], v4 offset:192
    v_mfma_f32_16x16x32_f16 v[28:31], v[136:139], v[116:119], v[28:31]
    ds_read_b128 v[92:95], v5 offset:3776
    v_mfma_f32_16x16x32_f16 v[28:31], v[132:135], v[120:123], v[28:31]
    v_mfma_f32_16x16x32_f16 v[28:31], v[128:131], v[124:127], v[28:31]
    s_waitcnt lgkmcnt(14)
    v_mfma_f32_16x16x32_f16 v[16:19], v[64:67], v[32:35], v[16:19]
    ds_read_b128 v[96:99], v4 offset:3712
    s_waitcnt lgkmcnt(9)
    v_mfma_f32_16x16x32_f16 v[20:23], v[76:79], v[32:35], v[20:23]
    ds_read_b128 v[128:131], v5 offset:128
    v_mfma_f32_16x16x32_f16 v[20:23], v[72:75], v[36:39], v[20:23]
    ds_read_b128 v[100:103], v4 offset:3200
    v_mfma_f32_16x16x32_f16 v[20:23], v[68:71], v[40:43], v[20:23]
    ds_read_b128 v[132:135], v5 offset:640
    v_mfma_f32_16x16x32_f16 v[20:23], v[64:67], v[44:47], v[20:23]
    ds_read_b128 v[104:107], v4 offset:2688
    s_waitcnt lgkmcnt(11)
    v_mfma_f32_16x16x32_f16 v[24:27], v[80:83], v[32:35], v[24:27]
    ds_read_b128 v[136:139], v5 offset:1152
    v_mfma_f32_16x16x32_f16 v[24:27], v[76:79], v[36:39], v[24:27]
    ds_read_b128 v[108:111], v4 offset:2176
    v_mfma_f32_16x16x32_f16 v[24:27], v[72:75], v[40:43], v[24:27]
    ds_read_b128 v[140:143], v5 offset:1664
    v_mfma_f32_16x16x32_f16 v[24:27], v[68:71], v[44:47], v[24:27]
    ds_read_b128 v[112:115], v4 offset:1664
    v_mfma_f32_16x16x32_f16 v[24:27], v[64:67], v[48:51], v[24:27]
    ds_read_b128 v[144:147], v5 offset:2176
    s_waitcnt lgkmcnt(10)
    v_mfma_f32_16x16x32_f16 v[28:31], v[92:95], v[32:35], v[28:31]
    ds_read_b128 v[116:119], v4 offset:1152
    v_mfma_f32_16x16x32_f16 v[28:31], v[88:91], v[36:39], v[28:31]
    ds_read_b128 v[148:151], v5 offset:2688
    v_mfma_f32_16x16x32_f16 v[28:31], v[84:87], v[40:43], v[28:31]
    ds_read_b128 v[120:123], v4 offset:640
    v_mfma_f32_16x16x32_f16 v[28:31], v[80:83], v[44:47], v[28:31]
    ds_read_b128 v[152:155], v5 offset:3200
    v_mfma_f32_16x16x32_f16 v[28:31], v[76:79], v[48:51], v[28:31]
    ds_read_b128 v[124:127], v4 offset:128
    v_mfma_f32_16x16x32_f16 v[28:31], v[72:75], v[52:55], v[28:31]
    ds_read_b128 v[156:159], v5 offset:3712
    v_mfma_f32_16x16x32_f16 v[28:31], v[68:71], v[56:59], v[28:31]
    v_mfma_f32_16x16x32_f16 v[28:31], v[64:67], v[60:63], v[28:31]
    s_waitcnt lgkmcnt(14)
    v_mfma_f32_16x16x32_f16 v[16:19], v[128:131], v[96:99], v[16:19]
    ds_read_b128 v[32:35], v4 offset:3648
    s_waitcnt lgkmcnt(9)
    v_mfma_f32_16x16x32_f16 v[20:23], v[140:143], v[96:99], v[20:23]
    ds_read_b128 v[64:67], v5 offset:64
    v_mfma_f32_16x16x32_f16 v[20:23], v[136:139], v[100:103], v[20:23]
    ds_read_b128 v[36:39], v4 offset:3136
    v_mfma_f32_16x16x32_f16 v[20:23], v[132:135], v[104:107], v[20:23]
    ds_read_b128 v[68:71], v5 offset:576
    v_mfma_f32_16x16x32_f16 v[20:23], v[128:131], v[108:111], v[20:23]
    ds_read_b128 v[40:43], v4 offset:2624
    s_waitcnt lgkmcnt(11)
    v_mfma_f32_16x16x32_f16 v[24:27], v[144:147], v[96:99], v[24:27]
    ds_read_b128 v[72:75], v5 offset:1088
    v_mfma_f32_16x16x32_f16 v[24:27], v[140:143], v[100:103], v[24:27]
    ds_read_b128 v[44:47], v4 offset:2112
    v_mfma_f32_16x16x32_f16 v[24:27], v[136:139], v[104:107], v[24:27]
    ds_read_b128 v[76:79], v5 offset:1600
    v_mfma_f32_16x16x32_f16 v[24:27], v[132:135], v[108:111], v[24:27]
    ds_read_b128 v[48:51], v4 offset:1600
    v_mfma_f32_16x16x32_f16 v[24:27], v[128:131], v[112:115], v[24:27]
    ds_read_b128 v[80:83], v5 offset:2112
    s_waitcnt lgkmcnt(10)
    v_mfma_f32_16x16x32_f16 v[28:31], v[156:159], v[96:99], v[28:31]
    ds_read_b128 v[52:55], v4 offset:1088
    v_mfma_f32_16x16x32_f16 v[28:31], v[152:155], v[100:103], v[28:31]
    ds_read_b128 v[84:87], v5 offset:2624
    v_mfma_f32_16x16x32_f16 v[28:31], v[148:151], v[104:107], v[28:31]
    ds_read_b128 v[56:59], v4 offset:576
    v_mfma_f32_16x16x32_f16 v[28:31], v[144:147], v[108:111], v[28:31]
    ds_read_b128 v[88:91], v5 offset:3136
    v_mfma_f32_16x16x32_f16 v[28:31], v[140:143], v[112:115], v[28:31]
    ds_read_b128 v[60:63], v4 offset:64
    v_mfma_f32_16x16x32_f16 v[28:31], v[136:139], v[116:119], v[28:31]
    ds_read_b128 v[92:95], v5 offset:3648
    v_mfma_f32_16x16x32_f16 v[28:31], v[132:135], v[120:123], v[28:31]
    v_mfma_f32_16x16x32_f16 v[28:31], v[128:131], v[124:127], v[28:31]
    s_waitcnt lgkmcnt(14)
    v_mfma_f32_16x16x32_f16 v[16:19], v[64:67], v[32:35], v[16:19]
    ds_read_b128 v[96:99], v4 offset:3584
    s_waitcnt lgkmcnt(9)
    v_mfma_f32_16x16x32_f16 v[20:23], v[76:79], v[32:35], v[20:23]
    ds_read_b128 v[128:131], v5 offset:0
    v_mfma_f32_16x16x32_f16 v[20:23], v[72:75], v[36:39], v[20:23]
    ds_read_b128 v[100:103], v4 offset:3072
    v_mfma_f32_16x16x32_f16 v[20:23], v[68:71], v[40:43], v[20:23]
    ds_read_b128 v[132:135], v5 offset:512
    v_mfma_f32_16x16x32_f16 v[20:23], v[64:67], v[44:47], v[20:23]
    ds_read_b128 v[104:107], v4 offset:2560
    s_waitcnt lgkmcnt(11)
    v_mfma_f32_16x16x32_f16 v[24:27], v[80:83], v[32:35], v[24:27]
    ds_read_b128 v[136:139], v5 offset:1024
    v_mfma_f32_16x16x32_f16 v[24:27], v[76:79], v[36:39], v[24:27]
    ds_read_b128 v[108:111], v4 offset:2048
    v_mfma_f32_16x16x32_f16 v[24:27], v[72:75], v[40:43], v[24:27]
    ds_read_b128 v[140:143], v5 offset:1536
    v_mfma_f32_16x16x32_f16 v[24:27], v[68:71], v[44:47], v[24:27]
    ds_read_b128 v[112:115], v4 offset:1536
    v_mfma_f32_16x16x32_f16 v[24:27], v[64:67], v[48:51], v[24:27]
    ds_read_b128 v[144:147], v5 offset:2048
    s_waitcnt lgkmcnt(10)
    v_mfma_f32_16x16x32_f16 v[28:31], v[92:95], v[32:35], v[28:31]
    ds_read_b128 v[116:119], v4 offset:1024
    v_mfma_f32_16x16x32_f16 v[28:31], v[88:91], v[36:39], v[28:31]
    ds_read_b128 v[148:151], v5 offset:2560
    v_mfma_f32_16x16x32_f16 v[28:31], v[84:87], v[40:43], v[28:31]
    ds_read_b128 v[120:123], v4 offset:512
    v_mfma_f32_16x16x32_f16 v[28:31], v[80:83], v[44:47], v[28:31]
    ds_read_b128 v[152:155], v5 offset:3072
    v_mfma_f32_16x16x32_f16 v[28:31], v[76:79], v[48:51], v[28:31]
    ds_read_b128 v[124:127], v4 offset:0
    v_mfma_f32_16x16x32_f16 v[28:31], v[72:75], v[52:55], v[28:31]
    ds_read_b128 v[156:159], v5 offset:3584
    v_mfma_f32_16x16x32_f16 v[28:31], v[68:71], v[56:59], v[28:31]
    v_mfma_f32_16x16x32_f16 v[28:31], v[64:67], v[60:63], v[28:31]
    s_waitcnt lgkmcnt(14)
    v_mfma_f32_16x16x32_f16 v[16:19], v[128:131], v[96:99], v[16:19]
    s_waitcnt lgkmcnt(8)
    v_mfma_f32_16x16x32_f16 v[20:23], v[140:143], v[96:99], v[20:23]
    v_mfma_f32_16x16x32_f16 v[20:23], v[136:139], v[100:103], v[20:23]
    v_mfma_f32_16x16x32_f16 v[20:23], v[132:135], v[104:107], v[20:23]
    v_mfma_f32_16x16x32_f16 v[20:23], v[128:131], v[108:111], v[20:23]
    s_waitcnt lgkmcnt(6)
    v_mfma_f32_16x16x32_f16 v[24:27], v[144:147], v[96:99], v[24:27]
    v_mfma_f32_16x16x32_f16 v[24:27], v[140:143], v[100:103], v[24:27]
    v_mfma_f32_16x16x32_f16 v[24:27], v[136:139], v[104:107], v[24:27]
    v_mfma_f32_16x16x32_f16 v[24:27], v[132:135], v[108:111], v[24:27]
    v_mfma_f32_16x16x32_f16 v[24:27], v[128:131], v[112:115], v[24:27]
    s_waitcnt lgkmcnt(0)
    v_mfma_f32_16x16x32_f16 v[28:31], v[156:159], v[96:99], v[28:31]
    v_mfma_f32_16x16x32_f16 v[28:31], v[152:155], v[100:103], v[28:31]
    v_mfma_f32_16x16x32_f16 v[28:31], v[148:151], v[104:107], v[28:31]
    v_mfma_f32_16x16x32_f16 v[28:31], v[144:147], v[108:111], v[28:31]
    v_mfma_f32_16x16x32_f16 v[28:31], v[140:143], v[112:115], v[28:31]
    v_mfma_f32_16x16x32_f16 v[28:31], v[136:139], v[116:119], v[28:31]
    v_mfma_f32_16x16x32_f16 v[28:31], v[132:135], v[120:123], v[28:31]
    v_mfma_f32_16x16x32_f16 v[28:31], v[128:131], v[124:127], v[28:31]
    s_nop 7
    v_mul_f32 v16, s32, v16
    v_mul_f32 v17, s32, v17
    v_mul_f32 v18, s32, v18
    v_mul_f32 v19, s32, v19
    v_cvt_pk_bf16_f32 v8, v16, v17
    v_cvt_pk_bf16_f32 v9, v18, v19
    buffer_store_dwordx2 v[8:9], v7, s[16:19], s28 offen offset:0
    v_mul_f32 v20, s32, v20
    v_mul_f32 v21, s32, v21
    v_mul_f32 v22, s32, v22
    v_mul_f32 v23, s32, v23
    v_cvt_pk_bf16_f32 v10, v20, v21
    v_cvt_pk_bf16_f32 v11, v22, v23
    buffer_store_dwordx2 v[10:11], v7, s[16:19], s28 offen offset:1536
    v_mul_f32 v24, s32, v24
    v_mul_f32 v25, s32, v25
    v_mul_f32 v26, s32, v26
    v_mul_f32 v27, s32, v27
    v_cvt_pk_bf16_f32 v12, v24, v25
    v_cvt_pk_bf16_f32 v13, v26, v27
    buffer_store_dwordx2 v[12:13], v7, s[16:19], s28 offen offset:2048
    v_mul_f32 v28, s32, v28
    v_mul_f32 v29, s32, v29
    v_mul_f32 v30, s32, v30
    v_mul_f32 v31, s32, v31
    v_cvt_pk_bf16_f32 v14, v28, v29
    v_cvt_pk_bf16_f32 v15, v30, v31
    buffer_store_dwordx2 v[14:15], v7, s[16:19], s28 offen offset:3584
    s_branch front_kernel_fin
front_kernel_mB:
    v_mov_b32 v16, 0
    v_mov_b32 v17, 0
    v_mov_b32 v18, 0
    v_mov_b32 v19, 0
    v_mov_b32 v20, 0
    v_mov_b32 v21, 0
    v_mov_b32 v22, 0
    v_mov_b32 v23, 0
    v_mov_b32 v24, 0
    v_mov_b32 v25, 0
    v_mov_b32 v26, 0
    v_mov_b32 v27, 0
    v_mov_b32 v28, 0
    v_mov_b32 v29, 0
    v_mov_b32 v30, 0
    v_mov_b32 v31, 0
    ds_read_b128 v[32:35], v4 offset:4032
    ds_read_b128 v[64:67], v5 offset:448
    ds_read_b128 v[36:39], v4 offset:3520
    ds_read_b128 v[68:71], v5 offset:960
    ds_read_b128 v[40:43], v4 offset:3008
    ds_read_b128 v[72:75], v5 offset:1472
    ds_read_b128 v[44:47], v4 offset:2496
    ds_read_b128 v[76:79], v5 offset:1984
    ds_read_b128 v[48:51], v4 offset:1984
    ds_read_b128 v[80:83], v5 offset:2496
    ds_read_b128 v[52:55], v4 offset:1472
    ds_read_b128 v[84:87], v5 offset:3008
    ds_read_b128 v[56:59], v4 offset:960
    ds_read_b128 v[88:91], v5 offset:3520
    s_waitcnt lgkmcnt(10)
    v_mfma_f32_16x16x32_f16 v[16:19], v[68:71], v[32:35], v[16:19]
    ds_read_b128 v[96:99], v4 offset:3968
    v_mfma_f32_16x16x32_f16 v[16:19], v[64:67], v[36:39], v[16:19]
    ds_read_b128 v[128:131], v5 offset:384
    s_waitcnt lgkmcnt(10)
    v_mfma_f32_16x16x32_f16 v[20:23], v[72:75], v[32:35], v[20:23]
    ds_read_b128 v[100:103], v4 offset:3456
    v_mfma_f32_16x16x32_f16 v[20:23], v[68:71], v[36:39], v[20:23]
    ds_read_b128 v[132:135], v5 offset:896
    v_mfma_f32_16x16x32_f16 v[20:23], v[64:67], v[40:43], v[20:23]
    ds_read_b128 v[104:107], v4 offset:2944
    s_waitcnt lgkmcnt(7)
    v_mfma_f32_16x16x32_f16 v[24:27], v[84:87], v[32:35], v[24:27]
    ds_read_b128 v[136:139], v5 offset:1408
    v_mfma_f32_16x16x32_f16 v[24:27], v[80:83], v[36:39], v[24:27]
    ds_read_b128 v[108:111], v4 offset:2432
    v_mfma_f32_16x16x32_f16 v[24:27], v[76:79], v[40:43], v[24:27]
    ds_read_b128 v[140:143], v5 offset:1920
    v_mfma_f32_16x16x32_f16 v[24:27], v[72:75], v[44:47], v[24:27]
    ds_read_b128 v[112:115], v4 offset:1920
    v_mfma_f32_16x16x32_f16 v[24:27], v[68:71], v[48:51], v[24:27]
    ds_read_b128 v[144:147], v5 offset:2432
    v_mfma_f32_16x16x32_f16 v[24:27], v[64:67], v[52:55], v[24:27]
    ds_read_b128 v[116:119], v4 offset:1408
    s_waitcnt lgkmcnt(11)
    v_mfma_f32_16x16x32_f16 v[28:31], v[88:91], v[32:35], v[28:31]
    ds_read_b128 v[148:151], v5 offset:2944
    v_mfma_f32_16x16x32_f16 v[28:31], v[84:87], v[36:39], v[28:31]
    ds_read_b128 v[120:123], v4 offset:896
    v_mfma_f32_16x16x32_f16 v[28:31], v[80:83], v[40:43], v[28:31]
    ds_read_b128 v[152:155], v5 offset:3456
    v_mfma_f32_16x16x32_f16 v[28:31], v[76:79], v[44:47], v[28:31]
    v_mfma_f32_16x16x32_f16 v[28:31], v[72:75], v[48:51], v[28:31]
    v_mfma_f32_16x16x32_f16 v[28:31], v[68:71], v[52:55], v[28:31]
    v_mfma_f32_16x16x32_f16 v[28:31], v[64:67], v[56:59], v[28:31]
    s_waitcnt lgkmcnt(10)
    v_mfma_f32_16x16x32_f16 v[16:19], v[132:135], v[96:99], v[16:19]
    ds_read_b128 v[32:35], v4 offset:3904
    v_mfma_f32_16x16x32_f16 v[16:19], v[128:131], v[100:103], v[16:19]
    ds_read_b128 v[64:67], v5 offset:320
    s_waitcnt lgkmcnt(10)
    v_mfma_f32_16x16x32_f16 v[20:23], v[136:139], v[96:99], v[20:23]
    ds_read_b128 v[36:39], v4 offset:3392
    v_mfma_f32_16x16x32_f16 v[20:23], v[132:135], v[100:103], v[20:23]
    ds_read_b128 v[68:71], v5 offset:832
    v_mfma_f32_16x16x32_f16 v[20:23], v[128:131], v[104:107], v[20:23]
    ds_read_b128 v[40:43], v4 offset:2880
    s_waitcnt lgkmcnt(7)
    v_mfma_f32_16x16x32_f16 v[24:27], v[148:151], v[96:99], v[24:27]
    ds_read_b128 v[72:75], v5 offset:1344
    v_mfma_f32_16x16x32_f16 v[24:27], v[144:147], v[100:103], v[24:27]
    ds_read_b128 v[44:47], v4 offset:2368
    v_mfma_f32_16x16x32_f16 v[24:27], v[140:143], v[104:107], v[24:27]
    ds_read_b128 v[76:79], v5 offset:1856
    v_mfma_f32_16x16x32_f16 v[24:27], v[136:139], v[108:111], v[24:27]
    ds_read_b128 v[48:51], v4 offset:1856
    v_mfma_f32_16x16x32_f16 v[24:27], v[132:135], v[112:115], v[24:27]
    ds_read_b128 v[80:83], v5 offset:2368
    v_mfma_f32_16x16x32_f16 v[24:27], v[128:131], v[116:119], v[24:27]
    ds_read_b128 v[52:55], v4 offset:1344
    s_waitcnt lgkmcnt(11)
    v_mfma_f32_16x16x32_f16 v[28:31], v[152:155], v[96:99], v[28:31]
    ds_read_b128 v[84:87], v5 offset:2880
    v_mfma_f32_16x16x32_f16 v[28:31], v[148:151], v[100:103], v[28:31]
    ds_read_b128 v[56:59], v4 offset:832
    v_mfma_f32_16x16x32_f16 v[28:31], v[144:147], v[104:107], v[28:31]
    ds_read_b128 v[88:91], v5 offset:3392
    v_mfma_f32_16x16x32_f16 v[28:31], v[140:143], v[108:111], v[28:31]
    v_mfma_f32_16x16x32_f16 v[28:31], v[136:139], v[112:115], v[28:31]
    v_mfma_f32_16x16x32_f16 v[28:31], v[132:135], v[116:119], v[28:31]
    v_mfma_f32_16x16x32_f16 v[28:31], v[128:131], v[120:123], v[28:31]
    s_waitcnt lgkmcnt(10)
    v_mfma_f32_16x16x32_f16 v[16:19], v[68:71], v[32:35], v[16:19]
    ds_read_b128 v[96:99], v4 offset:3840
    v_mfma_f32_16x16x32_f16 v[16:19], v[64:67], v[36:39], v[16:19]
    ds_read_b128 v[128:131], v5 offset:256
    s_waitcnt lgkmcnt(10)
    v_mfma_f32_16x16x32_f16 v[20:23], v[72:75], v[32:35], v[20:23]
    ds_read_b128 v[100:103], v4 offset:3328
    v_mfma_f32_16x16x32_f16 v[20:23], v[68:71], v[36:39], v[20:23]
    ds_read_b128 v[132:135], v5 offset:768
    v_mfma_f32_16x16x32_f16 v[20:23], v[64:67], v[40:43], v[20:23]
    ds_read_b128 v[104:107], v4 offset:2816
    s_waitcnt lgkmcnt(7)
    v_mfma_f32_16x16x32_f16 v[24:27], v[84:87], v[32:35], v[24:27]
    ds_read_b128 v[136:139], v5 offset:1280
    v_mfma_f32_16x16x32_f16 v[24:27], v[80:83], v[36:39], v[24:27]
    ds_read_b128 v[108:111], v4 offset:2304
    v_mfma_f32_16x16x32_f16 v[24:27], v[76:79], v[40:43], v[24:27]
    ds_read_b128 v[140:143], v5 offset:1792
    v_mfma_f32_16x16x32_f16 v[24:27], v[72:75], v[44:47], v[24:27]
    ds_read_b128 v[112:115], v4 offset:1792
    v_mfma_f32_16x16x32_f16 v[24:27], v[68:71], v[48:51], v[24:27]
    ds_read_b128 v[144:147], v5 offset:2304
    v_mfma_f32_16x16x32_f16 v[24:27], v[64:67], v[52:55], v[24:27]
    ds_read_b128 v[116:119], v4 offset:1280
    s_waitcnt lgkmcnt(11)
    v_mfma_f32_16x16x32_f16 v[28:31], v[88:91], v[32:35], v[28:31]
    ds_read_b128 v[148:151], v5 offset:2816
    v_mfma_f32_16x16x32_f16 v[28:31], v[84:87], v[36:39], v[28:31]
    ds_read_b128 v[120:123], v4 offset:768
    v_mfma_f32_16x16x32_f16 v[28:31], v[80:83], v[40:43], v[28:31]
    ds_read_b128 v[152:155], v5 offset:3328
    v_mfma_f32_16x16x32_f16 v[28:31], v[76:79], v[44:47], v[28:31]
    v_mfma_f32_16x16x32_f16 v[28:31], v[72:75], v[48:51], v[28:31]
    v_mfma_f32_16x16x32_f16 v[28:31], v[68:71], v[52:55], v[28:31]
    v_mfma_f32_16x16x32_f16 v[28:31], v[64:67], v[56:59], v[28:31]
    s_waitcnt lgkmcnt(10)
    v_mfma_f32_16x16x32_f16 v[16:19], v[132:135], v[96:99], v[16:19]
    ds_read_b128 v[32:35], v4 offset:3776
    v_mfma_f32_16x16x32_f16 v[16:19], v[128:131], v[100:103], v[16:19]
    ds_read_b128 v[64:67], v5 offset:192
    s_waitcnt lgkmcnt(10)
    v_mfma_f32_16x16x32_f16 v[20:23], v[136:139], v[96:99], v[20:23]
    ds_read_b128 v[36:39], v4 offset:3264
    v_mfma_f32_16x16x32_f16 v[20:23], v[132:135], v[100:103], v[20:23]
    ds_read_b128 v[68:71], v5 offset:704
    v_mfma_f32_16x16x32_f16 v[20:23], v[128:131], v[104:107], v[20:23]
    ds_read_b128 v[40:43], v4 offset:2752
    s_waitcnt lgkmcnt(7)
    v_mfma_f32_16x16x32_f16 v[24:27], v[148:151], v[96:99], v[24:27]
    ds_read_b128 v[72:75], v5 offset:1216
    v_mfma_f32_16x16x32_f16 v[24:27], v[144:147], v[100:103], v[24:27]
    ds_read_b128 v[44:47], v4 offset:2240
    v_mfma_f32_16x16x32_f16 v[24:27], v[140:143], v[104:107], v[24:27]
    ds_read_b128 v[76:79], v5 offset:1728
    v_mfma_f32_16x16x32_f16 v[24:27], v[136:139], v[108:111], v[24:27]
    ds_read_b128 v[48:51], v4 offset:1728
    v_mfma_f32_16x16x32_f16 v[24:27], v[132:135], v[112:115], v[24:27]
    ds_read_b128 v[80:83], v5 offset:2240
    v_mfma_f32_16x16x32_f16 v[24:27], v[128:131], v[116:119], v[24:27]
    ds_read_b128 v[52:55], v4 offset:1216
    s_waitcnt lgkmcnt(11)
    v_mfma_f32_16x16x32_f16 v[28:31], v[152:155], v[96:99], v[28:31]
    ds_read_b128 v[84:87], v5 offset:2752
    v_mfma_f32_16x16x32_f16 v[28:31], v[148:151], v[100:103], v[28:31]
    ds_read_b128 v[56:59], v4 offset:704
    v_mfma_f32_16x16x32_f16 v[28:31], v[144:147], v[104:107], v[28:31]
    ds_read_b128 v[88:91], v5 offset:3264
    v_mfma_f32_16x16x32_f16 v[28:31], v[140:143], v[108:111], v[28:31]
    v_mfma_f32_16x16x32_f16 v[28:31], v[136:139], v[112:115], v[28:31]
    v_mfma_f32_16x16x32_f16 v[28:31], v[132:135], v[116:119], v[28:31]
    v_mfma_f32_16x16x32_f16 v[28:31], v[128:131], v[120:123], v[28:31]
    s_waitcnt lgkmcnt(10)
    v_mfma_f32_16x16x32_f16 v[16:19], v[68:71], v[32:35], v[16:19]
    ds_read_b128 v[96:99], v4 offset:3712
    v_mfma_f32_16x16x32_f16 v[16:19], v[64:67], v[36:39], v[16:19]
    ds_read_b128 v[128:131], v5 offset:128
    s_waitcnt lgkmcnt(10)
    v_mfma_f32_16x16x32_f16 v[20:23], v[72:75], v[32:35], v[20:23]
    ds_read_b128 v[100:103], v4 offset:3200
    v_mfma_f32_16x16x32_f16 v[20:23], v[68:71], v[36:39], v[20:23]
    ds_read_b128 v[132:135], v5 offset:640
    v_mfma_f32_16x16x32_f16 v[20:23], v[64:67], v[40:43], v[20:23]
    ds_read_b128 v[104:107], v4 offset:2688
    s_waitcnt lgkmcnt(7)
    v_mfma_f32_16x16x32_f16 v[24:27], v[84:87], v[32:35], v[24:27]
    ds_read_b128 v[136:139], v5 offset:1152
    v_mfma_f32_16x16x32_f16 v[24:27], v[80:83], v[36:39], v[24:27]
    ds_read_b128 v[108:111], v4 offset:2176
    v_mfma_f32_16x16x32_f16 v[24:27], v[76:79], v[40:43], v[24:27]
    ds_read_b128 v[140:143], v5 offset:1664
    v_mfma_f32_16x16x32_f16 v[24:27], v[72:75], v[44:47], v[24:27]
    ds_read_b128 v[112:115], v4 offset:1664
    v_mfma_f32_16x16x32_f16 v[24:27], v[68:71], v[48:51], v[24:27]
    ds_read_b128 v[144:147], v5 offset:2176
    v_mfma_f32_16x16x32_f16 v[24:27], v[64:67], v[52:55], v[24:27]
    ds_read_b128 v[116:119], v4 offset:1152
    s_waitcnt lgkmcnt(11)
    v_mfma_f32_16x16x32_f16 v[28:31], v[88:91], v[32:35], v[28:31]
    ds_read_b128 v[148:151], v5 offset:2688
    v_mfma_f32_16x16x32_f16 v[28:31], v[84:87], v[36:39], v[28:31]
    ds_read_b128 v[120:123], v4 offset:640
    v_mfma_f32_16x16x32_f16 v[28:31], v[80:83], v[40:43], v[28:31]
    ds_read_b128 v[152:155], v5 offset:3200
    v_mfma_f32_16x16x32_f16 v[28:31], v[76:79], v[44:47], v[28:31]
    v_mfma_f32_16x16x32_f16 v[28:31], v[72:75], v[48:51], v[28:31]
    v_mfma_f32_16x16x32_f16 v[28:31], v[68:71], v[52:55], v[28:31]
    v_mfma_f32_16x16x32_f16 v[28:31], v[64:67], v[56:59], v[28:31]
    s_waitcnt lgkmcnt(10)
    v_mfma_f32_16x16x32_f16 v[16:19], v[132:135], v[96:99], v[16:19]
    ds_read_b128 v[32:35], v4 offset:3648
    v_mfma_f32_16x16x32_f16 v[16:19], v[128:131], v[100:103], v[16:19]
    ds_read_b128 v[64:67], v5 offset:64
    s_waitcnt lgkmcnt(10)
    v_mfma_f32_16x16x32_f16 v[20:23], v[136:139], v[96:99], v[20:23]
    ds_read_b128 v[36:39], v4 offset:3136
    v_mfma_f32_16x16x32_f16 v[20:23], v[132:135], v[100:103], v[20:23]
    ds_read_b128 v[68:71], v5 offset:576
    v_mfma_f32_16x16x32_f16 v[20:23], v[128:131], v[104:107], v[20:23]
    ds_read_b128 v[40:43], v4 offset:2624
    s_waitcnt lgkmcnt(7)
    v_mfma_f32_16x16x32_f16 v[24:27], v[148:151], v[96:99], v[24:27]
    ds_read_b128 v[72:75], v5 offset:1088
    v_mfma_f32_16x16x32_f16 v[24:27], v[144:147], v[100:103], v[24:27]
    ds_read_b128 v[44:47], v4 offset:2112
    v_mfma_f32_16x16x32_f16 v[24:27], v[140:143], v[104:107], v[24:27]
    ds_read_b128 v[76:79], v5 offset:1600
    v_mfma_f32_16x16x32_f16 v[24:27], v[136:139], v[108:111], v[24:27]
    ds_read_b128 v[48:51], v4 offset:1600
    v_mfma_f32_16x16x32_f16 v[24:27], v[132:135], v[112:115], v[24:27]
    ds_read_b128 v[80:83], v5 offset:2112
    v_mfma_f32_16x16x32_f16 v[24:27], v[128:131], v[116:119], v[24:27]
    ds_read_b128 v[52:55], v4 offset:1088
    s_waitcnt lgkmcnt(11)
    v_mfma_f32_16x16x32_f16 v[28:31], v[152:155], v[96:99], v[28:31]
    ds_read_b128 v[84:87], v5 offset:2624
    v_mfma_f32_16x16x32_f16 v[28:31], v[148:151], v[100:103], v[28:31]
    ds_read_b128 v[56:59], v4 offset:576
    v_mfma_f32_16x16x32_f16 v[28:31], v[144:147], v[104:107], v[28:31]
    ds_read_b128 v[88:91], v5 offset:3136
    v_mfma_f32_16x16x32_f16 v[28:31], v[140:143], v[108:111], v[28:31]
    v_mfma_f32_16x16x32_f16 v[28:31], v[136:139], v[112:115], v[28:31]
    v_mfma_f32_16x16x32_f16 v[28:31], v[132:135], v[116:119], v[28:31]
    v_mfma_f32_16x16x32_f16 v[28:31], v[128:131], v[120:123], v[28:31]
    s_waitcnt lgkmcnt(10)
    v_mfma_f32_16x16x32_f16 v[16:19], v[68:71], v[32:35], v[16:19]
    ds_read_b128 v[96:99], v4 offset:3584
    v_mfma_f32_16x16x32_f16 v[16:19], v[64:67], v[36:39], v[16:19]
    ds_read_b128 v[128:131], v5 offset:0
    s_waitcnt lgkmcnt(10)
    v_mfma_f32_16x16x32_f16 v[20:23], v[72:75], v[32:35], v[20:23]
    ds_read_b128 v[100:103], v4 offset:3072
    v_mfma_f32_16x16x32_f16 v[20:23], v[68:71], v[36:39], v[20:23]
    ds_read_b128 v[132:135], v5 offset:512
    v_mfma_f32_16x16x32_f16 v[20:23], v[64:67], v[40:43], v[20:23]
    ds_read_b128 v[104:107], v4 offset:2560
    s_waitcnt lgkmcnt(7)
    v_mfma_f32_16x16x32_f16 v[24:27], v[84:87], v[32:35], v[24:27]
    ds_read_b128 v[136:139], v5 offset:1024
    v_mfma_f32_16x16x32_f16 v[24:27], v[80:83], v[36:39], v[24:27]
    ds_read_b128 v[108:111], v4 offset:2048
    v_mfma_f32_16x16x32_f16 v[24:27], v[76:79], v[40:43], v[24:27]
    ds_read_b128 v[140:143], v5 offset:1536
    v_mfma_f32_16x16x32_f16 v[24:27], v[72:75], v[44:47], v[24:27]
    ds_read_b128 v[112:115], v4 offset:1536
    v_mfma_f32_16x16x32_f16 v[24:27], v[68:71], v[48:51], v[24:27]
    ds_read_b128 v[144:147], v5 offset:2048
    v_mfma_f32_16x16x32_f16 v[24:27], v[64:67], v[52:55], v[24:27]
    ds_read_b128 v[116:119], v4 offset:1024
    s_waitcnt lgkmcnt(11)
    v_mfma_f32_16x16x32_f16 v[28:31], v[88:91], v[32:35], v[28:31]
    ds_read_b128 v[148:151], v5 offset:2560
    v_mfma_f32_16x16x32_f16 v[28:31], v[84:87], v[36:39], v[28:31]
    ds_read_b128 v[120:123], v4 offset:512
    v_mfma_f32_16x16x32_f16 v[28:31], v[80:83], v[40:43], v[28:31]
    ds_read_b128 v[152:155], v5 offset:3072
    v_mfma_f32_16x16x32_f16 v[28:31], v[76:79], v[44:47], v[28:31]
    v_mfma_f32_16x16x32_f16 v[28:31], v[72:75], v[48:51], v[28:31]
    v_mfma_f32_16x16x32_f16 v[28:31], v[68:71], v[52:55], v[28:31]
    v_mfma_f32_16x16x32_f16 v[28:31], v[64:67], v[56:59], v[28:31]
    s_waitcnt lgkmcnt(10)
    v_mfma_f32_16x16x32_f16 v[16:19], v[132:135], v[96:99], v[16:19]
    v_mfma_f32_16x16x32_f16 v[16:19], v[128:131], v[100:103], v[16:19]
    s_waitcnt lgkmcnt(8)
    v_mfma_f32_16x16x32_f16 v[20:23], v[136:139], v[96:99], v[20:23]
    v_mfma_f32_16x16x32_f16 v[20:23], v[132:135], v[100:103], v[20:23]
    v_mfma_f32_16x16x32_f16 v[20:23], v[128:131], v[104:107], v[20:23]
    s_waitcnt lgkmcnt(2)
    v_mfma_f32_16x16x32_f16 v[24:27], v[148:151], v[96:99], v[24:27]
    v_mfma_f32_16x16x32_f16 v[24:27], v[144:147], v[100:103], v[24:27]
    v_mfma_f32_16x16x32_f16 v[24:27], v[140:143], v[104:107], v[24:27]
    v_mfma_f32_16x16x32_f16 v[24:27], v[136:139], v[108:111], v[24:27]
    v_mfma_f32_16x16x32_f16 v[24:27], v[132:135], v[112:115], v[24:27]
    v_mfma_f32_16x16x32_f16 v[24:27], v[128:131], v[116:119], v[24:27]
    s_waitcnt lgkmcnt(0)
    v_mfma_f32_16x16x32_f16 v[28:31], v[152:155], v[96:99], v[28:31]
    v_mfma_f32_16x16x32_f16 v[28:31], v[148:151], v[100:103], v[28:31]
    v_mfma_f32_16x16x32_f16 v[28:31], v[144:147], v[104:107], v[28:31]
    v_mfma_f32_16x16x32_f16 v[28:31], v[140:143], v[108:111], v[28:31]
    v_mfma_f32_16x16x32_f16 v[28:31], v[136:139], v[112:115], v[28:31]
    v_mfma_f32_16x16x32_f16 v[28:31], v[132:135], v[116:119], v[28:31]
    v_mfma_f32_16x16x32_f16 v[28:31], v[128:131], v[120:123], v[28:31]
    s_nop 7
    v_mul_f32 v16, s32, v16
    v_mul_f32 v17, s32, v17
    v_mul_f32 v18, s32, v18
    v_mul_f32 v19, s32, v19
    v_cvt_pk_bf16_f32 v8, v16, v17
    v_cvt_pk_bf16_f32 v9, v18, v19
    buffer_store_dwordx2 v[8:9], v7, s[16:19], s28 offen offset:512
    v_mul_f32 v20, s32, v20
    v_mul_f32 v21, s32, v21
    v_mul_f32 v22, s32, v22
    v_mul_f32 v23, s32, v23
    v_cvt_pk_bf16_f32 v10, v20, v21
    v_cvt_pk_bf16_f32 v11, v22, v23
    buffer_store_dwordx2 v[10:11], v7, s[16:19], s28 offen offset:1024
    v_mul_f32 v24, s32, v24
    v_mul_f32 v25, s32, v25
    v_mul_f32 v26, s32, v26
    v_mul_f32 v27, s32, v27
    v_cvt_pk_bf16_f32 v12, v24, v25
    v_cvt_pk_bf16_f32 v13, v26, v27
    buffer_store_dwordx2 v[12:13], v7, s[16:19], s28 offen offset:2560
    v_mul_f32 v28, s32, v28
    v_mul_f32 v29, s32, v29
    v_mul_f32 v30, s32, v30
    v_mul_f32 v31, s32, v31
    v_cvt_pk_bf16_f32 v14, v28, v29
    v_cvt_pk_bf16_f32 v15, v30, v31
    buffer_store_dwordx2 v[14:15], v7, s[16:19], s28 offen offset:3072
front_kernel_fin:
front_kernel_end:
    s_endpgm
.globl gemm1_kernel
.p2align 8
.type gemm1_kernel,@function
gemm1_kernel:
    s_cmp_ge_u32 s2, 256
    s_cbranch_scc1 gemm1_kernel_end
    s_load_dwordx4 s[4:7], s[0:1], 80
    s_load_dwordx2 s[8:9], s[0:1], 120
    v_lshrrev_b32 v2, 6, v0
    v_and_b32 v1, 63, v0
    s_nop 0
    v_readfirstlane_b32 s3, v2
    s_and_b32 s10, s2, 7
    s_lshr_b32 s11, s2, 3
    s_and_b32 s12, s11, 3
    s_lshl_b32 s10, s10, 2
    s_add_u32 s10, s10, s12
    s_lshr_b32 s11, s11, 2
    s_and_b32 s13, s3, 3

    s_lshl_b32 s54, s11, 5
    s_add_u32 s54, s54, s10
    s_cmp_ge_u32 s3, 6
    s_cbranch_scc1 gemm1_kernel_lnskip
    s_load_dwordx2 s[56:57], s[0:1], 0
    s_load_dwordx2 s[58:59], s[0:1], 120
    s_load_dwordx2 s[92:93], s[0:1], 64
    v_lshrrev_b32 v101, 6, v0
    v_and_b32 v102, 63, v0
    s_nop 0
    v_readfirstlane_b32 s55, v101
    v_and_b32 v103, 7, v102
    v_lshrrev_b32 v104, 3, v102
    s_waitcnt lgkmcnt(0)

    s_mov_b32 s60, s56
    s_mov_b32 s61, s57
    s_and_b32 s61, s61, 0xffff
    s_mov_b32 s62, 2359296
    s_mov_b32 s63, 0x00020000
    s_mov_b32 s64, s58
    s_mov_b32 s65, s59
    s_and_b32 s65, s65, 0xffff
    s_mov_b32 s66, 16384
    s_mov_b32 s67, 0x00020000
    s_add_u32 s68, s58, 53477376
    s_addc_u32 s69, s59, 0
    s_and_b32 s69, s69, 0xffff
    s_mov_b32 s70, 2506752
    s_mov_b32 s71, 0x00020000
    s_add_u32 s72, s58, 3145728
    s_addc_u32 s73, s59, 0
    s_and_b32 s73, s73, 0xffff
    s_mov_b32 s74, 2359296
    s_mov_b32 s75, 0x00020000
    s_add_u32 s76, s58, 6291456
    s_addc_u32 s77, s59, 0
    s_and_b32 s77, s77, 0xffff
    s_mov_b32 s78, 2359296
    s_mov_b32 s79, 0x00020000
    s_mov_b32 s80, s92
    s_mov_b32 s81, s93
    s_and_b32 s81, s81, 0xffff
    s_mov_b32 s82, 1152
    s_mov_b32 s83, 0x00020000
    s_mul_i32 s84, s55, 1536
    s_add_u32 s84, s84, 104448
    s_mul_i32 s85, s55, 417792
    s_lshl_b32 s86, s54, 4
    s_add_u32 s85, s85, s86
    v_and_b32 v105, 0x38, v102
    v_and_b32 v106, 1, v102
    v_lshl_add_u32 v105, v106, 2, v105
    v_bfe_u32 v106, v102, 1, 2
    v_add_u32 v105, v105, v106
    v_mul_u32_u24 v105, 4352, v105

    s_add_u32 m0, s84, 0
    s_add_u32 s87, s85, 0
    buffer_load_dwordx4 v105, s[68:71], s87 offen lds
    s_mov_b64 exec, 0xffffffff
    s_add_u32 m0, s84, 1024
    s_add_u32 s87, s85, 278528
    buffer_load_dwordx4 v105, s[68:71], s87 offen lds
    s_mov_b64 exec, -1
    s_lshl_b32 s86, s54, 3
    v_add_u32 v106, s86, v103
    v_mul_u32_u24 v107, 1152, v106
    s_mul_i32 s87, s55, 192
    v_lshl_add_u32 v108, v104, 3, s87
    v_add_u32 v107, v107, v108
    v_lshlrev_b32 v109, 3, v106
    buffer_load_dwordx2 v[110:111], v109, s[64:67], 0 offen

    buffer_load_dwordx2 v[116:117], v107, s[60:63], 0 offen offset:0
    buffer_load_dwordx2 v[118:119], v107, s[60:63], 0 offen offset:64
    buffer_load_dwordx2 v[120:121], v107, s[60:63], 0 offen offset:128
    buffer_load_dwordx2 v[132:133], v108, s[80:83], 0 offen offset:0
    buffer_load_dwordx2 v[134:135], v108, s[80:83], 0 offen offset:64
    buffer_load_dwordx2 v[136:137], v108, s[80:83], 0 offen offset:128
    v_lshlrev_b32 v112, 3, v102
    v_add_u32 v112, s84, v112
    s_mov_b32 s88, 0xffff0000
    s_mov_b32 s89, 0x3ae38e39
    s_mov_b32 s90, 0x44100000
    s_mov_b32 s91, 0x3727c5ac
    v_lshlrev_b32 v115, 5, v103
    v_lshl_add_u32 v114, v101, 2, v115
    s_waitcnt vmcnt(7)

    ds_read_b64_tr_b16 v[124:125], v112 offset:0
    ds_read_b64_tr_b16 v[126:127], v112 offset:512
    ds_read_b64_tr_b16 v[128:129], v112 offset:1024
    s_waitcnt vmcnt(6)
    v_rcp_f32 v113, v111
    s_waitcnt vmcnt(0) lgkmcnt(0)
    v_lshlrev_b32 v148, 16, v116
    v_and_b32 v149, s88, v116
    v_pk_add_f32 v[184:185], v[148:149], v[110:111] op_sel_hi:[1,0] neg_lo:[0,1] neg_hi:[0,1]
    v_cvt_pk_bf16_f32 v186, v184, v185
    v_lshlrev_b32 v184, 16, v186
    v_and_b32 v185, s88, v186
    v_pk_mul_f32 v[186:187], v[184:185], v[112:113] op_sel:[0,1] op_sel_hi:[1,1]
    v_pk_fma_f32 v[188:189], v[186:187], v[110:111], v[184:185] op_sel:[0,1,0] op_sel_hi:[1,1,1] neg_lo:[1,0,0] neg_hi:[1,0,0]
    v_pk_fma_f32 v[186:187], v[188:189], v[112:113], v[186:187] op_sel:[0,1,0] op_sel_hi:[1,1,1]
    v_cvt_pk_bf16_f32 v186, v186, v187
    v_lshlrev_b32 v184, 16, v186
    v_and_b32 v185, s88, v186
    v_lshlrev_b32 v186, 16, v132
    v_and_b32 v187, s88, v132
    v_pk_mul_f32 v[184:185], v[184:185], v[186:187]
    v_cvt_pk_bf16_f32 v186, v184, v185
    v_lshlrev_b32 v184, 16, v186
    v_and_b32 v185, s88, v186
    v_lshlrev_b32 v186, 16, v124
    v_and_b32 v187, s88, v124
    v_pk_add_f32 v[184:185], v[184:185], v[186:187]
    v_cvt_pk_bf16_f32 v186, v184, v185
    v_lshlrev_b32 v184, 16, v186
    v_and_b32 v185, s88, v186
    v_pk_add_f32 v[184:185], v[184:185], v[148:149]
    v_cvt_pk_bf16_f32 v116, v184, v185
    v_lshlrev_b32 v148, 16, v116
    v_and_b32 v149, s88, v116

    v_pk_mul_f32 v[142:143], v[148:149], v[148:149]
    v_mov_b32 v140, v148
    v_mov_b32 v141, v149
    v_lshlrev_b32 v150, 16, v117
    v_and_b32 v151, s88, v117
    v_pk_add_f32 v[190:191], v[150:151], v[110:111] op_sel_hi:[1,0] neg_lo:[0,1] neg_hi:[0,1]
    v_cvt_pk_bf16_f32 v192, v190, v191
    v_lshlrev_b32 v190, 16, v192
    v_and_b32 v191, s88, v192
    v_pk_mul_f32 v[192:193], v[190:191], v[112:113] op_sel:[0,1] op_sel_hi:[1,1]
    v_pk_fma_f32 v[194:195], v[192:193], v[110:111], v[190:191] op_sel:[0,1,0] op_sel_hi:[1,1,1] neg_lo:[1,0,0] neg_hi:[1,0,0]
    v_pk_fma_f32 v[192:193], v[194:195], v[112:113], v[192:193] op_sel:[0,1,0] op_sel_hi:[1,1,1]
    v_cvt_pk_bf16_f32 v192, v192, v193
    v_lshlrev_b32 v190, 16, v192
    v_and_b32 v191, s88, v192
    v_lshlrev_b32 v192, 16, v133
    v_and_b32 v193, s88, v133
    v_pk_mul_f32 v[190:191], v[190:191], v[192:193]
    v_cvt_pk_bf16_f32 v192, v190, v191
    v_lshlrev_b32 v190, 16, v192
    v_and_b32 v191, s88, v192
    v_lshlrev_b32 v192, 16, v125
    v_and_b32 v193, s88, v125
    v_pk_add_f32 v[190:191], v[190:191], v[192:193]
    v_cvt_pk_bf16_f32 v192, v190, v191
    v_lshlrev_b32 v190, 16, v192
    v_and_b32 v191, s88, v192
    v_pk_add_f32 v[190:191], v[190:191], v[150:151]
    v_cvt_pk_bf16_f32 v117, v190, v191
    v_lshlrev_b32 v150, 16, v117
    v_and_b32 v151, s88, v117

    v_pk_add_f32 v[140:141], v[140:141], v[150:151]
    v_pk_fma_f32 v[142:143], v[150:151], v[150:151], v[142:143]
    buffer_store_dwordx2 v[116:117], v107, s[72:75], 0 offen offset:0
    v_lshlrev_b32 v152, 16, v118
    v_and_b32 v153, s88, v118
    v_pk_add_f32 v[184:185], v[152:153], v[110:111] op_sel_hi:[1,0] neg_lo:[0,1] neg_hi:[0,1]
    v_cvt_pk_bf16_f32 v186, v184, v185
    v_lshlrev_b32 v184, 16, v186
    v_and_b32 v185, s88, v186
    v_pk_mul_f32 v[186:187], v[184:185], v[112:113] op_sel:[0,1] op_sel_hi:[1,1]
    v_pk_fma_f32 v[188:189], v[186:187], v[110:111], v[184:185] op_sel:[0,1,0] op_sel_hi:[1,1,1] neg_lo:[1,0,0] neg_hi:[1,0,0]
    v_pk_fma_f32 v[186:187], v[188:189], v[112:113], v[186:187] op_sel:[0,1,0] op_sel_hi:[1,1,1]
    v_cvt_pk_bf16_f32 v186, v186, v187
    v_lshlrev_b32 v184, 16, v186
    v_and_b32 v185, s88, v186
    v_lshlrev_b32 v186, 16, v134
    v_and_b32 v187, s88, v134
    v_pk_mul_f32 v[184:185], v[184:185], v[186:187]
    v_cvt_pk_bf16_f32 v186, v184, v185
    v_lshlrev_b32 v184, 16, v186
    v_and_b32 v185, s88, v186
    v_lshlrev_b32 v186, 16, v126
    v_and_b32 v187, s88, v126
    v_pk_add_f32 v[184:185], v[184:185], v[186:187]
    v_cvt_pk_bf16_f32 v186, v184, v185
    v_lshlrev_b32 v184, 16, v186
    v_and_b32 v185, s88, v186
    v_pk_add_f32 v[184:185], v[184:185], v[152:153]
    v_cvt_pk_bf16_f32 v118, v184, v185
    v_lshlrev_b32 v152, 16, v118
    v_and_b32 v153, s88, v118

    v_pk_add_f32 v[140:141], v[140:141], v[152:153]
    v_pk_fma_f32 v[142:143], v[152:153], v[152:153], v[142:143]
    v_lshlrev_b32 v154, 16, v119
    v_and_b32 v155, s88, v119
    v_pk_add_f32 v[190:191], v[154:155], v[110:111] op_sel_hi:[1,0] neg_lo:[0,1] neg_hi:[0,1]
    v_cvt_pk_bf16_f32 v192, v190, v191
    v_lshlrev_b32 v190, 16, v192
    v_and_b32 v191, s88, v192
    v_pk_mul_f32 v[192:193], v[190:191], v[112:113] op_sel:[0,1] op_sel_hi:[1,1]
    v_pk_fma_f32 v[194:195], v[192:193], v[110:111], v[190:191] op_sel:[0,1,0] op_sel_hi:[1,1,1] neg_lo:[1,0,0] neg_hi:[1,0,0]
    v_pk_fma_f32 v[192:193], v[194:195], v[112:113], v[192:193] op_sel:[0,1,0] op_sel_hi:[1,1,1]
    v_cvt_pk_bf16_f32 v192, v192, v193
    v_lshlrev_b32 v190, 16, v192
    v_and_b32 v191, s88, v192
    v_lshlrev_b32 v192, 16, v135
    v_and_b32 v193, s88, v135
    v_pk_mul_f32 v[190:191], v[190:191], v[192:193]
    v_cvt_pk_bf16_f32 v192, v190, v191
    v_lshlrev_b32 v190, 16, v192
    v_and_b32 v191, s88, v192
    v_lshlrev_b32 v192, 16, v127
    v_and_b32 v193, s88, v127
    v_pk_add_f32 v[190:191], v[190:191], v[192:193]
    v_cvt_pk_bf16_f32 v192, v190, v191
    v_lshlrev_b32 v190, 16, v192
    v_and_b32 v191, s88, v192
    v_pk_add_f32 v[190:191], v[190:191], v[154:155]
    v_cvt_pk_bf16_f32 v119, v190, v191
    v_lshlrev_b32 v154, 16, v119
    v_and_b32 v155, s88, v119

    v_pk_add_f32 v[140:141], v[140:141], v[154:155]
    v_pk_fma_f32 v[142:143], v[154:155], v[154:155], v[142:143]
    buffer_store_dwordx2 v[118:119], v107, s[72:75], 0 offen offset:64
    v_lshlrev_b32 v156, 16, v120
    v_and_b32 v157, s88, v120
    v_pk_add_f32 v[184:185], v[156:157], v[110:111] op_sel_hi:[1,0] neg_lo:[0,1] neg_hi:[0,1]
    v_cvt_pk_bf16_f32 v186, v184, v185
    v_lshlrev_b32 v184, 16, v186
    v_and_b32 v185, s88, v186
    v_pk_mul_f32 v[186:187], v[184:185], v[112:113] op_sel:[0,1] op_sel_hi:[1,1]
    v_pk_fma_f32 v[188:189], v[186:187], v[110:111], v[184:185] op_sel:[0,1,0] op_sel_hi:[1,1,1] neg_lo:[1,0,0] neg_hi:[1,0,0]
    v_pk_fma_f32 v[186:187], v[188:189], v[112:113], v[186:187] op_sel:[0,1,0] op_sel_hi:[1,1,1]
    v_cvt_pk_bf16_f32 v186, v186, v187
    v_lshlrev_b32 v184, 16, v186
    v_and_b32 v185, s88, v186
    v_lshlrev_b32 v186, 16, v136
    v_and_b32 v187, s88, v136
    v_pk_mul_f32 v[184:185], v[184:185], v[186:187]
    v_cvt_pk_bf16_f32 v186, v184, v185
    v_lshlrev_b32 v184, 16, v186
    v_and_b32 v185, s88, v186
    v_lshlrev_b32 v186, 16, v128
    v_and_b32 v187, s88, v128
    v_pk_add_f32 v[184:185], v[184:185], v[186:187]
    v_cvt_pk_bf16_f32 v186, v184, v185
    v_lshlrev_b32 v184, 16, v186
    v_and_b32 v185, s88, v186
    v_pk_add_f32 v[184:185], v[184:185], v[156:157]
    v_cvt_pk_bf16_f32 v120, v184, v185
    v_lshlrev_b32 v156, 16, v120
    v_and_b32 v157, s88, v120

    v_pk_add_f32 v[140:141], v[140:141], v[156:157]
    v_pk_fma_f32 v[142:143], v[156:157], v[156:157], v[142:143]
    v_lshlrev_b32 v158, 16, v121
    v_and_b32 v159, s88, v121
    v_pk_add_f32 v[190:191], v[158:159], v[110:111] op_sel_hi:[1,0] neg_lo:[0,1] neg_hi:[0,1]
    v_cvt_pk_bf16_f32 v192, v190, v191
    v_lshlrev_b32 v190, 16, v192
    v_and_b32 v191, s88, v192
    v_pk_mul_f32 v[192:193], v[190:191], v[112:113] op_sel:[0,1] op_sel_hi:[1,1]
    v_pk_fma_f32 v[194:195], v[192:193], v[110:111], v[190:191] op_sel:[0,1,0] op_sel_hi:[1,1,1] neg_lo:[1,0,0] neg_hi:[1,0,0]
    v_pk_fma_f32 v[192:193], v[194:195], v[112:113], v[192:193] op_sel:[0,1,0] op_sel_hi:[1,1,1]
    v_cvt_pk_bf16_f32 v192, v192, v193
    v_lshlrev_b32 v190, 16, v192
    v_and_b32 v191, s88, v192
    v_lshlrev_b32 v192, 16, v137
    v_and_b32 v193, s88, v137
    v_pk_mul_f32 v[190:191], v[190:191], v[192:193]
    v_cvt_pk_bf16_f32 v192, v190, v191
    v_lshlrev_b32 v190, 16, v192
    v_and_b32 v191, s88, v192
    v_lshlrev_b32 v192, 16, v129
    v_and_b32 v193, s88, v129
    v_pk_add_f32 v[190:191], v[190:191], v[192:193]
    v_cvt_pk_bf16_f32 v192, v190, v191
    v_lshlrev_b32 v190, 16, v192
    v_and_b32 v191, s88, v192
    v_pk_add_f32 v[190:191], v[190:191], v[158:159]
    v_cvt_pk_bf16_f32 v121, v190, v191
    v_lshlrev_b32 v158, 16, v121
    v_and_b32 v159, s88, v121

    v_pk_add_f32 v[140:141], v[140:141], v[158:159]
    v_pk_fma_f32 v[142:143], v[158:159], v[158:159], v[142:143]
    buffer_store_dwordx2 v[120:121], v107, s[72:75], 0 offen offset:128
    v_add_f32 v184, v140, v141
    v_add_f32 v185, v142, v143
    v_lshlrev_b32 v115, 6, v103
    v_add_u32 v115, 113664, v115
    v_lshl_add_u32 v114, v101, 3, v115
    v_add_f32_dpp v186, v184, v184 row_ror:8 row_mask:0xf bank_mask:0xf
    v_add_f32_dpp v187, v185, v185 row_ror:8 row_mask:0xf bank_mask:0xf
    v_mov_b32 v184, v186
    v_mov_b32 v185, v187
    s_nop 0
    v_permlane32_swap_b32 v184, v186
    v_permlane32_swap_b32 v185, v187
    s_nop 0
    v_pk_add_f32 v[184:185], v[184:185], v[186:187]
    s_nop 0
    v_mov_b32 v186, v184
    v_mov_b32 v187, v185
    s_nop 0
    v_permlane16_swap_b32 v184, v186
    v_permlane16_swap_b32 v185, v187
    s_nop 0
    v_pk_add_f32 v[184:185], v[184:185], v[186:187]
    ds_write_b64 v114, v[184:185]
    s_waitcnt lgkmcnt(0)
    s_barrier
    ds_read_b128 v[184:187], v115
    ds_read_b128 v[188:191], v115 offset:16
    ds_read_b128 v[192:195], v115 offset:32
    s_waitcnt lgkmcnt(0)
    v_pk_add_f32 v[184:185], v[184:185], v[186:187]
    v_pk_add_f32 v[188:189], v[188:189], v[190:191]
    v_pk_add_f32 v[192:193], v[192:193], v[194:195]
    v_pk_add_f32 v[184:185], v[184:185], v[188:189]
    v_pk_add_f32 v[184:185], v[184:185], v[192:193]
    v_mul_f32 v186, s89, v184
    v_fma_f32 v187, -v186, s90, v184
    v_fma_f32 v190, v187, s89, v186
    v_mul_f32 v186, s89, v185
    v_fma_f32 v187, -v186, s90, v185
    v_fma_f32 v186, v187, s89, v186
    v_fma_f32 v191, -v190, v190, v186
    v_max_f32 v191, 0, v191

    v_cvt_pk_bf16_f32 v184, v190, v191
    v_lshlrev_b32 v190, 16, v184
    v_and_b32 v191, s88, v184
    v_add_f32 v191, s91, v191
    v_cvt_pk_bf16_f32 v184, v191, v191
    v_lshlrev_b32 v191, 16, v184
    v_sqrt_f32 v191, v191
    s_nop 0
    v_cvt_pk_bf16_f32 v184, v191, v191
    v_lshlrev_b32 v191, 16, v184
    v_rcp_f32 v192, v191
    v_and_b32 v185, 15, v106
    v_lshrrev_b32 v184, 2, v185
    v_sub_u32 v184, 4, v184
    v_and_b32 v184, 3, v184
    v_and_b32 v186, 3, v104
    v_xor_b32 v184, v184, v186
    v_lshlrev_b32 v184, 4, v184
    v_lshl_add_u32 v194, v185, 6, v184
    v_lshrrev_b32 v186, 2, v104
    v_lshl_add_u32 v194, v186, 3, v194
    s_lshr_b32 s94, s54, 1
    s_mul_i32 s94, s94, 18432
    s_mul_i32 s95, s55, 3072
    s_add_u32 s94, s94, s95

    v_pk_add_f32 v[148:149], v[148:149], v[190:191] op_sel_hi:[1,0] neg_lo:[0,1] neg_hi:[0,1]
    v_cvt_pk_bf16_f32 v140, v148, v149
    v_lshlrev_b32 v148, 16, v140
    v_and_b32 v149, s88, v140
    v_pk_mul_f32 v[140:141], v[148:149], v[192:193] op_sel_hi:[1,0]
    v_pk_fma_f32 v[142:143], v[140:141], v[190:191], v[148:149] op_sel:[0,1,0] op_sel_hi:[1,1,1] neg_lo:[1,0,0] neg_hi:[1,0,0]
    v_pk_fma_f32 v[140:141], v[142:143], v[192:193], v[140:141] op_sel_hi:[1,0,1]
    v_cvt_pk_bf16_f32 v124, v140, v141

    v_pk_add_f32 v[150:151], v[150:151], v[190:191] op_sel_hi:[1,0] neg_lo:[0,1] neg_hi:[0,1]
    v_cvt_pk_bf16_f32 v144, v150, v151
    v_lshlrev_b32 v150, 16, v144
    v_and_b32 v151, s88, v144
    v_pk_mul_f32 v[144:145], v[150:151], v[192:193] op_sel_hi:[1,0]
    v_pk_fma_f32 v[146:147], v[144:145], v[190:191], v[150:151] op_sel:[0,1,0] op_sel_hi:[1,1,1] neg_lo:[1,0,0] neg_hi:[1,0,0]
    v_pk_fma_f32 v[144:145], v[146:147], v[192:193], v[144:145] op_sel_hi:[1,0,1]
    v_cvt_pk_bf16_f32 v125, v144, v145

    buffer_store_dwordx2 v[124:125], v194, s[76:79], s94 offen offset:0 sc1
    v_pk_add_f32 v[152:153], v[152:153], v[190:191] op_sel_hi:[1,0] neg_lo:[0,1] neg_hi:[0,1]
    v_cvt_pk_bf16_f32 v140, v152, v153
    v_lshlrev_b32 v152, 16, v140
    v_and_b32 v153, s88, v140
    v_pk_mul_f32 v[140:141], v[152:153], v[192:193] op_sel_hi:[1,0]
    v_pk_fma_f32 v[142:143], v[140:141], v[190:191], v[152:153] op_sel:[0,1,0] op_sel_hi:[1,1,1] neg_lo:[1,0,0] neg_hi:[1,0,0]
    v_pk_fma_f32 v[140:141], v[142:143], v[192:193], v[140:141] op_sel_hi:[1,0,1]
    v_cvt_pk_bf16_f32 v126, v140, v141

    v_pk_add_f32 v[154:155], v[154:155], v[190:191] op_sel_hi:[1,0] neg_lo:[0,1] neg_hi:[0,1]
    v_cvt_pk_bf16_f32 v144, v154, v155
    v_lshlrev_b32 v154, 16, v144
    v_and_b32 v155, s88, v144
    v_pk_mul_f32 v[144:145], v[154:155], v[192:193] op_sel_hi:[1,0]
    v_pk_fma_f32 v[146:147], v[144:145], v[190:191], v[154:155] op_sel:[0,1,0] op_sel_hi:[1,1,1] neg_lo:[1,0,0] neg_hi:[1,0,0]
    v_pk_fma_f32 v[144:145], v[146:147], v[192:193], v[144:145] op_sel_hi:[1,0,1]
    v_cvt_pk_bf16_f32 v127, v144, v145

    buffer_store_dwordx2 v[126:127], v194, s[76:79], s94 offen offset:1024 sc1
    v_pk_add_f32 v[156:157], v[156:157], v[190:191] op_sel_hi:[1,0] neg_lo:[0,1] neg_hi:[0,1]
    v_cvt_pk_bf16_f32 v140, v156, v157
    v_lshlrev_b32 v156, 16, v140
    v_and_b32 v157, s88, v140
    v_pk_mul_f32 v[140:141], v[156:157], v[192:193] op_sel_hi:[1,0]
    v_pk_fma_f32 v[142:143], v[140:141], v[190:191], v[156:157] op_sel:[0,1,0] op_sel_hi:[1,1,1] neg_lo:[1,0,0] neg_hi:[1,0,0]
    v_pk_fma_f32 v[140:141], v[142:143], v[192:193], v[140:141] op_sel_hi:[1,0,1]
    v_cvt_pk_bf16_f32 v128, v140, v141

    v_pk_add_f32 v[158:159], v[158:159], v[190:191] op_sel_hi:[1,0] neg_lo:[0,1] neg_hi:[0,1]
    v_cvt_pk_bf16_f32 v144, v158, v159
    v_lshlrev_b32 v158, 16, v144
    v_and_b32 v159, s88, v144
    v_pk_mul_f32 v[144:145], v[158:159], v[192:193] op_sel_hi:[1,0]
    v_pk_fma_f32 v[146:147], v[144:145], v[190:191], v[158:159] op_sel:[0,1,0] op_sel_hi:[1,1,1] neg_lo:[1,0,0] neg_hi:[1,0,0]
    v_pk_fma_f32 v[144:145], v[146:147], v[192:193], v[144:145] op_sel_hi:[1,0,1]
    v_cvt_pk_bf16_f32 v129, v144, v145

    buffer_store_dwordx2 v[128:129], v194, s[76:79], s94 offen offset:2048 sc1
    s_branch gemm1_kernel_lndone
gemm1_kernel_lnskip:
    s_barrier
gemm1_kernel_lndone:
    s_waitcnt lgkmcnt(0)
    s_add_u32 s16, s8, 6291456
    s_addc_u32 s17, s9, 0
    s_and_b32 s17, s17, 0xffff
    s_mov_b32 s18, 2359296
    s_mov_b32 s19, 0x00020000
    s_add_u32 s24, s8, 9437184
    s_addc_u32 s25, s9, 0
    s_and_b32 s25, s25, 0xffff
    s_mov_b32 s26, 18874368
    s_mov_b32 s27, 0x00020000
    s_cmp_ge_u32 s3, 6
    s_cselect_b32 s20, s6, s4
    s_cselect_b32 s21, s7, s5
    s_and_b32 s21, s21, 0xffff

    s_mov_b32 s22, 5308416
    s_mov_b32 s23, 0x00020000
    v_and_b32 v3, 15, v1
    v_lshrrev_b32 v4, 4, v1
    v_bfe_u32 v5, v1, 2, 2
    v_sub_u32 v5, 4, v5
    v_and_b32 v5, 3, v5
    v_xor_b32 v5, v5, v4
    v_lshlrev_b32 v5, 4, v5
    v_lshl_add_u32 v2, v3, 6, v5
    s_lshl_b32 s14, s13, 12
    v_add_u32 v6, s14, v2
    v_add_u32 v7, 69632, v6
    v_lshrrev_b32 v4, 2, v1
    v_mul_u32_u24 v8, 288, v4
    v_and_b32 v5, 3, v1
    v_lshl_add_u32 v8, v5, 3, v8
    s_and_b32 s44, s10, 1
    s_xor_b32 s45, s44, 1
    s_lshl_b32 s45, s45, 8
    v_add_u32 v252, s45, v8
    v_add_u32 v253, 69632, v252
    s_lshl_b32 s45, s44, 5
    s_lshr_b32 s46, s3, 2
    s_lshl_b32 s46, s46, 7
    s_add_u32 s45, s45, s46
    v_add_u32 v8, s45, v8
    v_add_u32 v9, 69632, v8

    s_cmp_ge_u32 s3, 4
    s_cbranch_scc1 gemm1_kernel_p1
    v_lshlrev_b32 v10, 4, v1
    s_lshl_b32 s14, s11, 4
    s_lshl_b32 s15, s13, 2
    s_add_u32 s14, s14, s15
    s_mul_i32 s31, s14, 18432
    s_lshl_b32 s30, s13, 12

    s_waitcnt vmcnt(0) lgkmcnt(0)
    s_barrier
    s_cmp_lg_u32 s3, 0
    s_cbranch_scc1 gemm1_kernel_go
    s_add_u32 s48, s8, 56623104
    s_addc_u32 s49, s9, 0
    s_and_b32 s49, s49, 0xffff
    s_mov_b32 s50, 16384
    s_mov_b32 s51, 0x00020000
    s_lshl_b32 s52, s11, 7
    s_lshl_b32 s53, s10, 2
    s_add_u32 s53, s53, s52
    v_mov_b32 v100, 0
    v_mov_b32 v101, 1
    v_lshlrev_b32 v103, 2, v1
    s_mov_b64 exec, 1
    buffer_store_dword v101, v100, s[48:51], s53 offen sc1
    s_mov_b64 exec, 0xffffffff
    s_mov_b32 s53, 0

gemm1_kernel_poll:
    buffer_load_dword v102, v103, s[48:51], s52 offen sc1
    s_waitcnt vmcnt(0)
    v_cmp_ne_u32 vcc, 0, v102
    s_add_u32 s53, s53, 1
    s_cmp_ge_u32 s53, 0x40000
    s_cbranch_scc1 gemm1_kernel_go
    s_cmp_eq_u32 vcc_lo, -1
    s_cbranch_scc1 gemm1_kernel_go
    s_sleep 1
    s_branch gemm1_kernel_poll

gemm1_kernel_go:
    s_mov_b64 exec, -1
    s_barrier
    s_add_u32 m0, s30, 0
    s_add_u32 s34, s31, 0
    buffer_load_dwordx4 v10, s[16:19], s34 offen sc1 lds
    s_add_u32 m0, s30, 1024
    s_add_u32 s34, s31, 18432
    buffer_load_dwordx4 v10, s[16:19], s34 offen sc1 lds
    s_add_u32 m0, s30, 2048
    s_add_u32 s34, s31, 36864
    buffer_load_dwordx4 v10, s[16:19], s34 offen sc1 lds
    s_add_u32 m0, s30, 3072
    s_add_u32 s34, s31, 55296
    buffer_load_dwordx4 v10, s[16:19], s34 offen sc1 lds
    s_add_u32 m0, s30, 34816
    s_add_u32 s34, s31, 1024
    buffer_load_dwordx4 v10, s[16:19], s34 offen sc1 lds
    s_add_u32 m0, s30, 35840
    s_add_u32 s34, s31, 19456
    buffer_load_dwordx4 v10, s[16:19], s34 offen sc1 lds
    s_add_u32 m0, s30, 36864
    s_add_u32 s34, s31, 37888
    buffer_load_dwordx4 v10, s[16:19], s34 offen sc1 lds
    s_add_u32 m0, s30, 37888
    s_add_u32 s34, s31, 56320
    buffer_load_dwordx4 v10, s[16:19], s34 offen sc1 lds
    s_add_u32 m0, s30, 69632
    s_add_u32 s34, s31, 2048
    buffer_load_dwordx4 v10, s[16:19], s34 offen sc1 lds
    s_add_u32 m0, s30, 70656
    s_add_u32 s34, s31, 20480
    buffer_load_dwordx4 v10, s[16:19], s34 offen sc1 lds
    s_add_u32 m0, s30, 71680
    s_add_u32 s34, s31, 38912
    buffer_load_dwordx4 v10, s[16:19], s34 offen sc1 lds
    s_add_u32 m0, s30, 72704
    s_add_u32 s34, s31, 57344
    buffer_load_dwordx4 v10, s[16:19], s34 offen sc1 lds
    v_mov_b32 v88, 0
    v_mov_b32 v89, 0
    v_mov_b32 v90, 0
    v_mov_b32 v91, 0
    v_mov_b32 v92, 0
    v_mov_b32 v93, 0
    v_mov_b32 v94, 0
    v_mov_b32 v95, 0
    v_mov_b32 v96, 0
    v_mov_b32 v97, 0
    v_mov_b32 v98, 0
    v_mov_b32 v99, 0
    v_mov_b32 v100, 0
    v_mov_b32 v101, 0
    v_mov_b32 v102, 0
    v_mov_b32 v103, 0
    v_mov_b32 v104, 0
    v_mov_b32 v105, 0
    v_mov_b32 v106, 0
    v_mov_b32 v107, 0
    v_mov_b32 v108, 0
    v_mov_b32 v109, 0
    v_mov_b32 v110, 0
    v_mov_b32 v111, 0
    v_mov_b32 v112, 0
    v_mov_b32 v113, 0
    v_mov_b32 v114, 0
    v_mov_b32 v115, 0
    v_mov_b32 v116, 0
    v_mov_b32 v117, 0
    v_mov_b32 v118, 0
    v_mov_b32 v119, 0
    v_mov_b32 v120, 0
    v_mov_b32 v121, 0
    v_mov_b32 v122, 0
    v_mov_b32 v123, 0
    v_mov_b32 v124, 0
    v_mov_b32 v125, 0
    v_mov_b32 v126, 0
    v_mov_b32 v127, 0
    v_mov_b32 v128, 0
    v_mov_b32 v129, 0
    v_mov_b32 v130, 0
    v_mov_b32 v131, 0
    v_mov_b32 v132, 0
    v_mov_b32 v133, 0
    v_mov_b32 v134, 0
    v_mov_b32 v135, 0
    v_mov_b32 v136, 0
    v_mov_b32 v137, 0
    v_mov_b32 v138, 0
    v_mov_b32 v139, 0
    v_mov_b32 v140, 0
    v_mov_b32 v141, 0
    v_mov_b32 v142, 0
    v_mov_b32 v143, 0
    v_mov_b32 v144, 0
    v_mov_b32 v145, 0
    v_mov_b32 v146, 0
    v_mov_b32 v147, 0
    v_mov_b32 v148, 0
    v_mov_b32 v149, 0
    v_mov_b32 v150, 0
    v_mov_b32 v151, 0
    v_mov_b32 v152, 0
    v_mov_b32 v153, 0
    v_mov_b32 v154, 0
    v_mov_b32 v155, 0
    v_mov_b32 v156, 0
    v_mov_b32 v157, 0
    v_mov_b32 v158, 0
    v_mov_b32 v159, 0
    v_mov_b32 v160, 0
    v_mov_b32 v161, 0
    v_mov_b32 v162, 0
    v_mov_b32 v163, 0
    v_mov_b32 v164, 0
    v_mov_b32 v165, 0
    v_mov_b32 v166, 0
    v_mov_b32 v167, 0
    v_mov_b32 v168, 0
    v_mov_b32 v169, 0
    v_mov_b32 v170, 0
    v_mov_b32 v171, 0
    v_mov_b32 v172, 0
    v_mov_b32 v173, 0
    v_mov_b32 v174, 0
    v_mov_b32 v175, 0
    v_mov_b32 v176, 0
    v_mov_b32 v177, 0
    v_mov_b32 v178, 0
    v_mov_b32 v179, 0
    v_mov_b32 v180, 0
    v_mov_b32 v181, 0
    v_mov_b32 v182, 0
    v_mov_b32 v183, 0
    v_mov_b32 v184, 0
    v_mov_b32 v185, 0
    v_mov_b32 v186, 0
    v_mov_b32 v187, 0
    v_mov_b32 v188, 0
    v_mov_b32 v189, 0
    v_mov_b32 v190, 0
    v_mov_b32 v191, 0
    v_mov_b32 v192, 0
    v_mov_b32 v193, 0
    v_mov_b32 v194, 0
    v_mov_b32 v195, 0
    v_mov_b32 v196, 0
    v_mov_b32 v197, 0
    v_mov_b32 v198, 0
    v_mov_b32 v199, 0
    v_mov_b32 v200, 0
    v_mov_b32 v201, 0
    v_mov_b32 v202, 0
    v_mov_b32 v203, 0
    v_mov_b32 v204, 0
    v_mov_b32 v205, 0
    v_mov_b32 v206, 0
    v_mov_b32 v207, 0
    v_mov_b32 v208, 0
    v_mov_b32 v209, 0
    v_mov_b32 v210, 0
    v_mov_b32 v211, 0
    v_mov_b32 v212, 0
    v_mov_b32 v213, 0
    v_mov_b32 v214, 0
    v_mov_b32 v215, 0
    v_mov_b32 v216, 0
    v_mov_b32 v217, 0
    v_mov_b32 v218, 0
    v_mov_b32 v219, 0
    v_mov_b32 v220, 0
    v_mov_b32 v221, 0
    v_mov_b32 v222, 0
    v_mov_b32 v223, 0
    v_mov_b32 v224, 0
    v_mov_b32 v225, 0
    v_mov_b32 v226, 0
    v_mov_b32 v227, 0
    v_mov_b32 v228, 0
    v_mov_b32 v229, 0
    v_mov_b32 v230, 0
    v_mov_b32 v231, 0
    v_mov_b32 v232, 0
    v_mov_b32 v233, 0
    v_mov_b32 v234, 0
    v_mov_b32 v235, 0
    v_mov_b32 v236, 0
    v_mov_b32 v237, 0
    v_mov_b32 v238, 0
    v_mov_b32 v239, 0
    v_mov_b32 v240, 0
    v_mov_b32 v241, 0
    v_mov_b32 v242, 0
    v_mov_b32 v243, 0
    v_mov_b32 v244, 0
    v_mov_b32 v245, 0
    v_mov_b32 v246, 0
    v_mov_b32 v247, 0
    s_waitcnt vmcnt(8)
    s_barrier
    ds_read_b128 v[16:19], v6 offset:0
    ds_read_b128 v[20:23], v6 offset:1024
    ds_read_b128 v[24:27], v6 offset:2048
    ds_read_b128 v[28:31], v6 offset:3072
    ds_read_b64_tr_b16 v[48:49], v8 offset:16384
    ds_read_b64_tr_b16 v[50:51], v8 offset:20992
    ds_read_b64_tr_b16 v[52:53], v8 offset:25600
    ds_read_b64_tr_b16 v[54:55], v8 offset:30208
    ds_read_b64_tr_b16 v[56:57], v8 offset:16416
    ds_read_b64_tr_b16 v[58:59], v8 offset:21024
    ds_read_b64_tr_b16 v[60:61], v8 offset:25632
    ds_read_b64_tr_b16 v[62:63], v8 offset:30240
    ds_read_b64_tr_b16 v[64:65], v8 offset:16448
    ds_read_b64_tr_b16 v[66:67], v8 offset:21056
    ds_read_b64_tr_b16 v[68:69], v8 offset:25664
    ds_read_b64_tr_b16 v[70:71], v8 offset:30272
    ds_read_b64_tr_b16 v[72:73], v8 offset:16480
    ds_read_b64_tr_b16 v[74:75], v8 offset:21088
    ds_read_b64_tr_b16 v[76:77], v8 offset:25696
    ds_read_b64_tr_b16 v[78:79], v8 offset:30304
    ds_read_b64_tr_b16 v[80:81], v252 offset:16384
    ds_read_b64_tr_b16 v[82:83], v252 offset:20992
    ds_read_b64_tr_b16 v[84:85], v252 offset:25600
    ds_read_b64_tr_b16 v[86:87], v252 offset:30208
    s_waitcnt vmcnt(4)
    s_barrier
    s_waitcnt lgkmcnt(15)
    v_mfma_f32_16x16x32_bf16 v[88:91], v[48:51], v[16:19], v[88:91]
    s_add_u32 m0, s30, 104448
    s_add_u32 s34, s31, 3072
    buffer_load_dwordx4 v10, s[16:19], s34 offen sc1 lds
    v_mfma_f32_16x16x32_bf16 v[128:131], v[48:51], v[20:23], v[128:131]
    ds_read_b128 v[32:35], v6 offset:34816
    v_mfma_f32_16x16x32_bf16 v[168:171], v[48:51], v[24:27], v[168:171]
    s_add_u32 m0, s30, 105472
    s_add_u32 s34, s31, 21504
    buffer_load_dwordx4 v10, s[16:19], s34 offen sc1 lds
    v_mfma_f32_16x16x32_bf16 v[208:211], v[48:51], v[28:31], v[208:211]
    ds_read_b128 v[36:39], v6 offset:35840
    v_mfma_f32_16x16x32_bf16 v[92:95], v[52:55], v[16:19], v[92:95]
    s_add_u32 m0, s30, 106496
    s_add_u32 s34, s31, 39936
    buffer_load_dwordx4 v10, s[16:19], s34 offen sc1 lds
    v_mfma_f32_16x16x32_bf16 v[132:135], v[52:55], v[20:23], v[132:135]
    ds_read_b64_tr_b16 v[48:49], v8 offset:51200
    v_mfma_f32_16x16x32_bf16 v[172:175], v[52:55], v[24:27], v[172:175]
    s_add_u32 m0, s30, 107520
    s_add_u32 s34, s31, 58368
    buffer_load_dwordx4 v10, s[16:19], s34 offen sc1 lds
    v_mfma_f32_16x16x32_bf16 v[212:215], v[52:55], v[28:31], v[212:215]
    ds_read_b64_tr_b16 v[50:51], v8 offset:55808
    s_waitcnt lgkmcnt(15)
    v_mfma_f32_16x16x32_bf16 v[96:99], v[56:59], v[16:19], v[96:99]
    ds_read_b64_tr_b16 v[52:53], v8 offset:60416
    v_mfma_f32_16x16x32_bf16 v[136:139], v[56:59], v[20:23], v[136:139]
    ds_read_b64_tr_b16 v[54:55], v8 offset:65024
    v_mfma_f32_16x16x32_bf16 v[176:179], v[56:59], v[24:27], v[176:179]
    ds_read_b128 v[40:43], v6 offset:36864
    v_mfma_f32_16x16x32_bf16 v[216:219], v[56:59], v[28:31], v[216:219]
    ds_read_b128 v[44:47], v6 offset:37888
    v_mfma_f32_16x16x32_bf16 v[100:103], v[60:63], v[16:19], v[100:103]
    ds_read_b64_tr_b16 v[56:57], v8 offset:51232
    v_mfma_f32_16x16x32_bf16 v[140:143], v[60:63], v[20:23], v[140:143]
    ds_read_b64_tr_b16 v[58:59], v8 offset:55840
    v_mfma_f32_16x16x32_bf16 v[180:183], v[60:63], v[24:27], v[180:183]
    v_mfma_f32_16x16x32_bf16 v[220:223], v[60:63], v[28:31], v[220:223]
    s_waitcnt lgkmcnt(15)
    v_mfma_f32_16x16x32_bf16 v[104:107], v[64:67], v[16:19], v[104:107]
    ds_read_b64_tr_b16 v[60:61], v8 offset:60448
    v_mfma_f32_16x16x32_bf16 v[144:147], v[64:67], v[20:23], v[144:147]
    ds_read_b64_tr_b16 v[62:63], v8 offset:65056
    v_mfma_f32_16x16x32_bf16 v[184:187], v[64:67], v[24:27], v[184:187]
    v_mfma_f32_16x16x32_bf16 v[224:227], v[64:67], v[28:31], v[224:227]
    v_mfma_f32_16x16x32_bf16 v[108:111], v[68:71], v[16:19], v[108:111]
    ds_read_b64_tr_b16 v[64:65], v8 offset:51264
    v_mfma_f32_16x16x32_bf16 v[148:151], v[68:71], v[20:23], v[148:151]
    ds_read_b64_tr_b16 v[66:67], v8 offset:55872
    v_mfma_f32_16x16x32_bf16 v[188:191], v[68:71], v[24:27], v[188:191]
    v_mfma_f32_16x16x32_bf16 v[228:231], v[68:71], v[28:31], v[228:231]
    v_mfma_f32_16x16x32_bf16 v[112:115], v[72:75], v[16:19], v[112:115]
    ds_read_b64_tr_b16 v[68:69], v8 offset:60480
    v_mfma_f32_16x16x32_bf16 v[152:155], v[72:75], v[20:23], v[152:155]
    ds_read_b64_tr_b16 v[70:71], v8 offset:65088
    v_mfma_f32_16x16x32_bf16 v[192:195], v[72:75], v[24:27], v[192:195]
    v_mfma_f32_16x16x32_bf16 v[232:235], v[72:75], v[28:31], v[232:235]
    s_waitcnt lgkmcnt(15)
    v_mfma_f32_16x16x32_bf16 v[116:119], v[76:79], v[16:19], v[116:119]
    ds_read_b64_tr_b16 v[72:73], v8 offset:51296
    v_mfma_f32_16x16x32_bf16 v[156:159], v[76:79], v[20:23], v[156:159]
    ds_read_b64_tr_b16 v[74:75], v8 offset:55904
    v_mfma_f32_16x16x32_bf16 v[196:199], v[76:79], v[24:27], v[196:199]
    v_mfma_f32_16x16x32_bf16 v[236:239], v[76:79], v[28:31], v[236:239]
    v_mfma_f32_16x16x32_bf16 v[120:123], v[80:83], v[16:19], v[120:123]
    ds_read_b64_tr_b16 v[76:77], v8 offset:60512
    v_mfma_f32_16x16x32_bf16 v[160:163], v[80:83], v[20:23], v[160:163]
    ds_read_b64_tr_b16 v[78:79], v8 offset:65120
    v_mfma_f32_16x16x32_bf16 v[200:203], v[80:83], v[24:27], v[200:203]
    v_mfma_f32_16x16x32_bf16 v[240:243], v[80:83], v[28:31], v[240:243]
    v_mfma_f32_16x16x32_bf16 v[124:127], v[84:87], v[16:19], v[124:127]
    ds_read_b64_tr_b16 v[80:81], v252 offset:51200
    v_mfma_f32_16x16x32_bf16 v[164:167], v[84:87], v[20:23], v[164:167]
    ds_read_b64_tr_b16 v[82:83], v252 offset:55808
    v_mfma_f32_16x16x32_bf16 v[204:207], v[84:87], v[24:27], v[204:207]
    v_mfma_f32_16x16x32_bf16 v[244:247], v[84:87], v[28:31], v[244:247]
    ds_read_b64_tr_b16 v[84:85], v252 offset:60416
    ds_read_b64_tr_b16 v[86:87], v252 offset:65024
    s_waitcnt vmcnt(4)
    s_barrier
    s_waitcnt lgkmcnt(15)
    v_mfma_f32_16x16x32_bf16 v[88:91], v[48:51], v[32:35], v[88:91]
    s_add_u32 m0, s30, 0
    s_add_u32 s34, s31, 4096
    buffer_load_dwordx4 v10, s[16:19], s34 offen sc1 lds
    v_mfma_f32_16x16x32_bf16 v[128:131], v[48:51], v[36:39], v[128:131]
    ds_read_b128 v[16:19], v7 offset:0
    v_mfma_f32_16x16x32_bf16 v[168:171], v[48:51], v[40:43], v[168:171]
    s_add_u32 m0, s30, 1024
    s_add_u32 s34, s31, 22528
    buffer_load_dwordx4 v10, s[16:19], s34 offen sc1 lds
    v_mfma_f32_16x16x32_bf16 v[208:211], v[48:51], v[44:47], v[208:211]
    ds_read_b128 v[20:23], v7 offset:1024
    v_mfma_f32_16x16x32_bf16 v[92:95], v[52:55], v[32:35], v[92:95]
    s_add_u32 m0, s30, 2048
    s_add_u32 s34, s31, 40960
    buffer_load_dwordx4 v10, s[16:19], s34 offen sc1 lds
    v_mfma_f32_16x16x32_bf16 v[132:135], v[52:55], v[36:39], v[132:135]
    ds_read_b64_tr_b16 v[48:49], v9 offset:16384
    v_mfma_f32_16x16x32_bf16 v[172:175], v[52:55], v[40:43], v[172:175]
    s_add_u32 m0, s30, 3072
    s_add_u32 s34, s31, 59392
    buffer_load_dwordx4 v10, s[16:19], s34 offen sc1 lds
    v_mfma_f32_16x16x32_bf16 v[212:215], v[52:55], v[44:47], v[212:215]
    ds_read_b64_tr_b16 v[50:51], v9 offset:20992
    s_waitcnt lgkmcnt(15)
    v_mfma_f32_16x16x32_bf16 v[96:99], v[56:59], v[32:35], v[96:99]
    ds_read_b64_tr_b16 v[52:53], v9 offset:25600
    v_mfma_f32_16x16x32_bf16 v[136:139], v[56:59], v[36:39], v[136:139]
    ds_read_b64_tr_b16 v[54:55], v9 offset:30208
    v_mfma_f32_16x16x32_bf16 v[176:179], v[56:59], v[40:43], v[176:179]
    ds_read_b128 v[24:27], v7 offset:2048
    v_mfma_f32_16x16x32_bf16 v[216:219], v[56:59], v[44:47], v[216:219]
    ds_read_b128 v[28:31], v7 offset:3072
    v_mfma_f32_16x16x32_bf16 v[100:103], v[60:63], v[32:35], v[100:103]
    ds_read_b64_tr_b16 v[56:57], v9 offset:16416
    v_mfma_f32_16x16x32_bf16 v[140:143], v[60:63], v[36:39], v[140:143]
    ds_read_b64_tr_b16 v[58:59], v9 offset:21024
    v_mfma_f32_16x16x32_bf16 v[180:183], v[60:63], v[40:43], v[180:183]
    v_mfma_f32_16x16x32_bf16 v[220:223], v[60:63], v[44:47], v[220:223]
    s_waitcnt lgkmcnt(15)
    v_mfma_f32_16x16x32_bf16 v[104:107], v[64:67], v[32:35], v[104:107]
    ds_read_b64_tr_b16 v[60:61], v9 offset:25632
    v_mfma_f32_16x16x32_bf16 v[144:147], v[64:67], v[36:39], v[144:147]
    ds_read_b64_tr_b16 v[62:63], v9 offset:30240
    v_mfma_f32_16x16x32_bf16 v[184:187], v[64:67], v[40:43], v[184:187]
    v_mfma_f32_16x16x32_bf16 v[224:227], v[64:67], v[44:47], v[224:227]
    v_mfma_f32_16x16x32_bf16 v[108:111], v[68:71], v[32:35], v[108:111]
    ds_read_b64_tr_b16 v[64:65], v9 offset:16448
    v_mfma_f32_16x16x32_bf16 v[148:151], v[68:71], v[36:39], v[148:151]
    ds_read_b64_tr_b16 v[66:67], v9 offset:21056
    v_mfma_f32_16x16x32_bf16 v[188:191], v[68:71], v[40:43], v[188:191]
    v_mfma_f32_16x16x32_bf16 v[228:231], v[68:71], v[44:47], v[228:231]
    v_mfma_f32_16x16x32_bf16 v[112:115], v[72:75], v[32:35], v[112:115]
    ds_read_b64_tr_b16 v[68:69], v9 offset:25664
    v_mfma_f32_16x16x32_bf16 v[152:155], v[72:75], v[36:39], v[152:155]
    ds_read_b64_tr_b16 v[70:71], v9 offset:30272
    v_mfma_f32_16x16x32_bf16 v[192:195], v[72:75], v[40:43], v[192:195]
    v_mfma_f32_16x16x32_bf16 v[232:235], v[72:75], v[44:47], v[232:235]
    s_waitcnt lgkmcnt(15)
    v_mfma_f32_16x16x32_bf16 v[116:119], v[76:79], v[32:35], v[116:119]
    ds_read_b64_tr_b16 v[72:73], v9 offset:16480
    v_mfma_f32_16x16x32_bf16 v[156:159], v[76:79], v[36:39], v[156:159]
    ds_read_b64_tr_b16 v[74:75], v9 offset:21088
    v_mfma_f32_16x16x32_bf16 v[196:199], v[76:79], v[40:43], v[196:199]
    v_mfma_f32_16x16x32_bf16 v[236:239], v[76:79], v[44:47], v[236:239]
    v_mfma_f32_16x16x32_bf16 v[120:123], v[80:83], v[32:35], v[120:123]
    ds_read_b64_tr_b16 v[76:77], v9 offset:25696
    v_mfma_f32_16x16x32_bf16 v[160:163], v[80:83], v[36:39], v[160:163]
    ds_read_b64_tr_b16 v[78:79], v9 offset:30304
    v_mfma_f32_16x16x32_bf16 v[200:203], v[80:83], v[40:43], v[200:203]
    v_mfma_f32_16x16x32_bf16 v[240:243], v[80:83], v[44:47], v[240:243]
    v_mfma_f32_16x16x32_bf16 v[124:127], v[84:87], v[32:35], v[124:127]
    ds_read_b64_tr_b16 v[80:81], v253 offset:16384
    v_mfma_f32_16x16x32_bf16 v[164:167], v[84:87], v[36:39], v[164:167]
    ds_read_b64_tr_b16 v[82:83], v253 offset:20992
    v_mfma_f32_16x16x32_bf16 v[204:207], v[84:87], v[40:43], v[204:207]
    v_mfma_f32_16x16x32_bf16 v[244:247], v[84:87], v[44:47], v[244:247]
    ds_read_b64_tr_b16 v[84:85], v253 offset:25600
    ds_read_b64_tr_b16 v[86:87], v253 offset:30208
    s_waitcnt vmcnt(4)
    s_barrier
    s_waitcnt lgkmcnt(15)
    v_mfma_f32_16x16x32_bf16 v[88:91], v[48:51], v[16:19], v[88:91]
    s_add_u32 m0, s30, 34816
    s_add_u32 s34, s31, 5120
    buffer_load_dwordx4 v10, s[16:19], s34 offen sc1 lds
    v_mfma_f32_16x16x32_bf16 v[128:131], v[48:51], v[20:23], v[128:131]
    ds_read_b128 v[32:35], v7 offset:34816
    v_mfma_f32_16x16x32_bf16 v[168:171], v[48:51], v[24:27], v[168:171]
    s_add_u32 m0, s30, 35840
    s_add_u32 s34, s31, 23552
    buffer_load_dwordx4 v10, s[16:19], s34 offen sc1 lds
    v_mfma_f32_16x16x32_bf16 v[208:211], v[48:51], v[28:31], v[208:211]
    ds_read_b128 v[36:39], v7 offset:35840
    v_mfma_f32_16x16x32_bf16 v[92:95], v[52:55], v[16:19], v[92:95]
    s_add_u32 m0, s30, 36864
    s_add_u32 s34, s31, 41984
    buffer_load_dwordx4 v10, s[16:19], s34 offen sc1 lds
    v_mfma_f32_16x16x32_bf16 v[132:135], v[52:55], v[20:23], v[132:135]
    ds_read_b64_tr_b16 v[48:49], v9 offset:51200
    v_mfma_f32_16x16x32_bf16 v[172:175], v[52:55], v[24:27], v[172:175]
    s_add_u32 m0, s30, 37888
    s_add_u32 s34, s31, 60416
    buffer_load_dwordx4 v10, s[16:19], s34 offen sc1 lds
    v_mfma_f32_16x16x32_bf16 v[212:215], v[52:55], v[28:31], v[212:215]
    ds_read_b64_tr_b16 v[50:51], v9 offset:55808
    s_waitcnt lgkmcnt(15)
    v_mfma_f32_16x16x32_bf16 v[96:99], v[56:59], v[16:19], v[96:99]
    ds_read_b64_tr_b16 v[52:53], v9 offset:60416
    v_mfma_f32_16x16x32_bf16 v[136:139], v[56:59], v[20:23], v[136:139]
    ds_read_b64_tr_b16 v[54:55], v9 offset:65024
    v_mfma_f32_16x16x32_bf16 v[176:179], v[56:59], v[24:27], v[176:179]
    ds_read_b128 v[40:43], v7 offset:36864
    v_mfma_f32_16x16x32_bf16 v[216:219], v[56:59], v[28:31], v[216:219]
    ds_read_b128 v[44:47], v7 offset:37888
    v_mfma_f32_16x16x32_bf16 v[100:103], v[60:63], v[16:19], v[100:103]
    ds_read_b64_tr_b16 v[56:57], v9 offset:51232
    v_mfma_f32_16x16x32_bf16 v[140:143], v[60:63], v[20:23], v[140:143]
    ds_read_b64_tr_b16 v[58:59], v9 offset:55840
    v_mfma_f32_16x16x32_bf16 v[180:183], v[60:63], v[24:27], v[180:183]
    v_mfma_f32_16x16x32_bf16 v[220:223], v[60:63], v[28:31], v[220:223]
    s_waitcnt lgkmcnt(15)
    v_mfma_f32_16x16x32_bf16 v[104:107], v[64:67], v[16:19], v[104:107]
    ds_read_b64_tr_b16 v[60:61], v9 offset:60448
    v_mfma_f32_16x16x32_bf16 v[144:147], v[64:67], v[20:23], v[144:147]
    ds_read_b64_tr_b16 v[62:63], v9 offset:65056
    v_mfma_f32_16x16x32_bf16 v[184:187], v[64:67], v[24:27], v[184:187]
    v_mfma_f32_16x16x32_bf16 v[224:227], v[64:67], v[28:31], v[224:227]
    v_mfma_f32_16x16x32_bf16 v[108:111], v[68:71], v[16:19], v[108:111]
    ds_read_b64_tr_b16 v[64:65], v9 offset:51264
    v_mfma_f32_16x16x32_bf16 v[148:151], v[68:71], v[20:23], v[148:151]
    ds_read_b64_tr_b16 v[66:67], v9 offset:55872
    v_mfma_f32_16x16x32_bf16 v[188:191], v[68:71], v[24:27], v[188:191]
    v_mfma_f32_16x16x32_bf16 v[228:231], v[68:71], v[28:31], v[228:231]
    v_mfma_f32_16x16x32_bf16 v[112:115], v[72:75], v[16:19], v[112:115]
    ds_read_b64_tr_b16 v[68:69], v9 offset:60480
    v_mfma_f32_16x16x32_bf16 v[152:155], v[72:75], v[20:23], v[152:155]
    ds_read_b64_tr_b16 v[70:71], v9 offset:65088
    v_mfma_f32_16x16x32_bf16 v[192:195], v[72:75], v[24:27], v[192:195]
    v_mfma_f32_16x16x32_bf16 v[232:235], v[72:75], v[28:31], v[232:235]
    s_waitcnt lgkmcnt(15)
    v_mfma_f32_16x16x32_bf16 v[116:119], v[76:79], v[16:19], v[116:119]
    ds_read_b64_tr_b16 v[72:73], v9 offset:51296
    v_mfma_f32_16x16x32_bf16 v[156:159], v[76:79], v[20:23], v[156:159]
    ds_read_b64_tr_b16 v[74:75], v9 offset:55904
    v_mfma_f32_16x16x32_bf16 v[196:199], v[76:79], v[24:27], v[196:199]
    v_mfma_f32_16x16x32_bf16 v[236:239], v[76:79], v[28:31], v[236:239]
    v_mfma_f32_16x16x32_bf16 v[120:123], v[80:83], v[16:19], v[120:123]
    ds_read_b64_tr_b16 v[76:77], v9 offset:60512
    v_mfma_f32_16x16x32_bf16 v[160:163], v[80:83], v[20:23], v[160:163]
    ds_read_b64_tr_b16 v[78:79], v9 offset:65120
    v_mfma_f32_16x16x32_bf16 v[200:203], v[80:83], v[24:27], v[200:203]
    v_mfma_f32_16x16x32_bf16 v[240:243], v[80:83], v[28:31], v[240:243]
    v_mfma_f32_16x16x32_bf16 v[124:127], v[84:87], v[16:19], v[124:127]
    ds_read_b64_tr_b16 v[80:81], v253 offset:51200
    v_mfma_f32_16x16x32_bf16 v[164:167], v[84:87], v[20:23], v[164:167]
    ds_read_b64_tr_b16 v[82:83], v253 offset:55808
    v_mfma_f32_16x16x32_bf16 v[204:207], v[84:87], v[24:27], v[204:207]
    v_mfma_f32_16x16x32_bf16 v[244:247], v[84:87], v[28:31], v[244:247]
    ds_read_b64_tr_b16 v[84:85], v253 offset:60416
    ds_read_b64_tr_b16 v[86:87], v253 offset:65024
    s_waitcnt vmcnt(4)
    s_barrier
    s_waitcnt lgkmcnt(15)
    v_mfma_f32_16x16x32_bf16 v[88:91], v[48:51], v[32:35], v[88:91]
    s_add_u32 m0, s30, 69632
    s_add_u32 s34, s31, 6144
    buffer_load_dwordx4 v10, s[16:19], s34 offen sc1 lds
    v_mfma_f32_16x16x32_bf16 v[128:131], v[48:51], v[36:39], v[128:131]
    ds_read_b128 v[16:19], v6 offset:0
    v_mfma_f32_16x16x32_bf16 v[168:171], v[48:51], v[40:43], v[168:171]
    s_add_u32 m0, s30, 70656
    s_add_u32 s34, s31, 24576
    buffer_load_dwordx4 v10, s[16:19], s34 offen sc1 lds
    v_mfma_f32_16x16x32_bf16 v[208:211], v[48:51], v[44:47], v[208:211]
    ds_read_b128 v[20:23], v6 offset:1024
    v_mfma_f32_16x16x32_bf16 v[92:95], v[52:55], v[32:35], v[92:95]
    s_add_u32 m0, s30, 71680
    s_add_u32 s34, s31, 43008
    buffer_load_dwordx4 v10, s[16:19], s34 offen sc1 lds
    v_mfma_f32_16x16x32_bf16 v[132:135], v[52:55], v[36:39], v[132:135]
    ds_read_b64_tr_b16 v[48:49], v8 offset:16384
    v_mfma_f32_16x16x32_bf16 v[172:175], v[52:55], v[40:43], v[172:175]
    s_add_u32 m0, s30, 72704
    s_add_u32 s34, s31, 61440
    buffer_load_dwordx4 v10, s[16:19], s34 offen sc1 lds
    v_mfma_f32_16x16x32_bf16 v[212:215], v[52:55], v[44:47], v[212:215]
    ds_read_b64_tr_b16 v[50:51], v8 offset:20992
    s_waitcnt lgkmcnt(15)
    v_mfma_f32_16x16x32_bf16 v[96:99], v[56:59], v[32:35], v[96:99]
    ds_read_b64_tr_b16 v[52:53], v8 offset:25600
    v_mfma_f32_16x16x32_bf16 v[136:139], v[56:59], v[36:39], v[136:139]
    ds_read_b64_tr_b16 v[54:55], v8 offset:30208
    v_mfma_f32_16x16x32_bf16 v[176:179], v[56:59], v[40:43], v[176:179]
    ds_read_b128 v[24:27], v6 offset:2048
    v_mfma_f32_16x16x32_bf16 v[216:219], v[56:59], v[44:47], v[216:219]
    ds_read_b128 v[28:31], v6 offset:3072
    v_mfma_f32_16x16x32_bf16 v[100:103], v[60:63], v[32:35], v[100:103]
    ds_read_b64_tr_b16 v[56:57], v8 offset:16416
    v_mfma_f32_16x16x32_bf16 v[140:143], v[60:63], v[36:39], v[140:143]
    ds_read_b64_tr_b16 v[58:59], v8 offset:21024
    v_mfma_f32_16x16x32_bf16 v[180:183], v[60:63], v[40:43], v[180:183]
    v_mfma_f32_16x16x32_bf16 v[220:223], v[60:63], v[44:47], v[220:223]
    s_waitcnt lgkmcnt(15)
    v_mfma_f32_16x16x32_bf16 v[104:107], v[64:67], v[32:35], v[104:107]
    ds_read_b64_tr_b16 v[60:61], v8 offset:25632
    v_mfma_f32_16x16x32_bf16 v[144:147], v[64:67], v[36:39], v[144:147]
    ds_read_b64_tr_b16 v[62:63], v8 offset:30240
    v_mfma_f32_16x16x32_bf16 v[184:187], v[64:67], v[40:43], v[184:187]
    v_mfma_f32_16x16x32_bf16 v[224:227], v[64:67], v[44:47], v[224:227]
    v_mfma_f32_16x16x32_bf16 v[108:111], v[68:71], v[32:35], v[108:111]
    ds_read_b64_tr_b16 v[64:65], v8 offset:16448
    v_mfma_f32_16x16x32_bf16 v[148:151], v[68:71], v[36:39], v[148:151]
    ds_read_b64_tr_b16 v[66:67], v8 offset:21056
    v_mfma_f32_16x16x32_bf16 v[188:191], v[68:71], v[40:43], v[188:191]
    v_mfma_f32_16x16x32_bf16 v[228:231], v[68:71], v[44:47], v[228:231]
    v_mfma_f32_16x16x32_bf16 v[112:115], v[72:75], v[32:35], v[112:115]
    ds_read_b64_tr_b16 v[68:69], v8 offset:25664
    v_mfma_f32_16x16x32_bf16 v[152:155], v[72:75], v[36:39], v[152:155]
    ds_read_b64_tr_b16 v[70:71], v8 offset:30272
    v_mfma_f32_16x16x32_bf16 v[192:195], v[72:75], v[40:43], v[192:195]
    v_mfma_f32_16x16x32_bf16 v[232:235], v[72:75], v[44:47], v[232:235]
    s_waitcnt lgkmcnt(15)
    v_mfma_f32_16x16x32_bf16 v[116:119], v[76:79], v[32:35], v[116:119]
    ds_read_b64_tr_b16 v[72:73], v8 offset:16480
    v_mfma_f32_16x16x32_bf16 v[156:159], v[76:79], v[36:39], v[156:159]
    ds_read_b64_tr_b16 v[74:75], v8 offset:21088
    v_mfma_f32_16x16x32_bf16 v[196:199], v[76:79], v[40:43], v[196:199]
    v_mfma_f32_16x16x32_bf16 v[236:239], v[76:79], v[44:47], v[236:239]
    v_mfma_f32_16x16x32_bf16 v[120:123], v[80:83], v[32:35], v[120:123]
    ds_read_b64_tr_b16 v[76:77], v8 offset:25696
    v_mfma_f32_16x16x32_bf16 v[160:163], v[80:83], v[36:39], v[160:163]
    ds_read_b64_tr_b16 v[78:79], v8 offset:30304
    v_mfma_f32_16x16x32_bf16 v[200:203], v[80:83], v[40:43], v[200:203]
    v_mfma_f32_16x16x32_bf16 v[240:243], v[80:83], v[44:47], v[240:243]
    v_mfma_f32_16x16x32_bf16 v[124:127], v[84:87], v[32:35], v[124:127]
    ds_read_b64_tr_b16 v[80:81], v252 offset:16384
    v_mfma_f32_16x16x32_bf16 v[164:167], v[84:87], v[36:39], v[164:167]
    ds_read_b64_tr_b16 v[82:83], v252 offset:20992
    v_mfma_f32_16x16x32_bf16 v[204:207], v[84:87], v[40:43], v[204:207]
    v_mfma_f32_16x16x32_bf16 v[244:247], v[84:87], v[44:47], v[244:247]
    ds_read_b64_tr_b16 v[84:85], v252 offset:25600
    ds_read_b64_tr_b16 v[86:87], v252 offset:30208
    s_waitcnt vmcnt(4)
    s_barrier
    s_waitcnt lgkmcnt(15)
    v_mfma_f32_16x16x32_bf16 v[88:91], v[48:51], v[16:19], v[88:91]
    s_add_u32 m0, s30, 104448
    s_add_u32 s34, s31, 7168
    buffer_load_dwordx4 v10, s[16:19], s34 offen sc1 lds
    v_mfma_f32_16x16x32_bf16 v[128:131], v[48:51], v[20:23], v[128:131]
    ds_read_b128 v[32:35], v6 offset:34816
    v_mfma_f32_16x16x32_bf16 v[168:171], v[48:51], v[24:27], v[168:171]
    s_add_u32 m0, s30, 105472
    s_add_u32 s34, s31, 25600
    buffer_load_dwordx4 v10, s[16:19], s34 offen sc1 lds
    v_mfma_f32_16x16x32_bf16 v[208:211], v[48:51], v[28:31], v[208:211]
    ds_read_b128 v[36:39], v6 offset:35840
    v_mfma_f32_16x16x32_bf16 v[92:95], v[52:55], v[16:19], v[92:95]
    s_add_u32 m0, s30, 106496
    s_add_u32 s34, s31, 44032
    buffer_load_dwordx4 v10, s[16:19], s34 offen sc1 lds
    v_mfma_f32_16x16x32_bf16 v[132:135], v[52:55], v[20:23], v[132:135]
    ds_read_b64_tr_b16 v[48:49], v8 offset:51200
    v_mfma_f32_16x16x32_bf16 v[172:175], v[52:55], v[24:27], v[172:175]
    s_add_u32 m0, s30, 107520
    s_add_u32 s34, s31, 62464
    buffer_load_dwordx4 v10, s[16:19], s34 offen sc1 lds
    v_mfma_f32_16x16x32_bf16 v[212:215], v[52:55], v[28:31], v[212:215]
    ds_read_b64_tr_b16 v[50:51], v8 offset:55808
    s_waitcnt lgkmcnt(15)
    v_mfma_f32_16x16x32_bf16 v[96:99], v[56:59], v[16:19], v[96:99]
    ds_read_b64_tr_b16 v[52:53], v8 offset:60416
    v_mfma_f32_16x16x32_bf16 v[136:139], v[56:59], v[20:23], v[136:139]
    ds_read_b64_tr_b16 v[54:55], v8 offset:65024
    v_mfma_f32_16x16x32_bf16 v[176:179], v[56:59], v[24:27], v[176:179]
    ds_read_b128 v[40:43], v6 offset:36864
    v_mfma_f32_16x16x32_bf16 v[216:219], v[56:59], v[28:31], v[216:219]
    ds_read_b128 v[44:47], v6 offset:37888
    v_mfma_f32_16x16x32_bf16 v[100:103], v[60:63], v[16:19], v[100:103]
    ds_read_b64_tr_b16 v[56:57], v8 offset:51232
    v_mfma_f32_16x16x32_bf16 v[140:143], v[60:63], v[20:23], v[140:143]
    ds_read_b64_tr_b16 v[58:59], v8 offset:55840
    v_mfma_f32_16x16x32_bf16 v[180:183], v[60:63], v[24:27], v[180:183]
    v_mfma_f32_16x16x32_bf16 v[220:223], v[60:63], v[28:31], v[220:223]
    s_waitcnt lgkmcnt(15)
    v_mfma_f32_16x16x32_bf16 v[104:107], v[64:67], v[16:19], v[104:107]
    ds_read_b64_tr_b16 v[60:61], v8 offset:60448
    v_mfma_f32_16x16x32_bf16 v[144:147], v[64:67], v[20:23], v[144:147]
    ds_read_b64_tr_b16 v[62:63], v8 offset:65056
    v_mfma_f32_16x16x32_bf16 v[184:187], v[64:67], v[24:27], v[184:187]
    v_mfma_f32_16x16x32_bf16 v[224:227], v[64:67], v[28:31], v[224:227]
    v_mfma_f32_16x16x32_bf16 v[108:111], v[68:71], v[16:19], v[108:111]
    ds_read_b64_tr_b16 v[64:65], v8 offset:51264
    v_mfma_f32_16x16x32_bf16 v[148:151], v[68:71], v[20:23], v[148:151]
    ds_read_b64_tr_b16 v[66:67], v8 offset:55872
    v_mfma_f32_16x16x32_bf16 v[188:191], v[68:71], v[24:27], v[188:191]
    v_mfma_f32_16x16x32_bf16 v[228:231], v[68:71], v[28:31], v[228:231]
    v_mfma_f32_16x16x32_bf16 v[112:115], v[72:75], v[16:19], v[112:115]
    ds_read_b64_tr_b16 v[68:69], v8 offset:60480
    v_mfma_f32_16x16x32_bf16 v[152:155], v[72:75], v[20:23], v[152:155]
    ds_read_b64_tr_b16 v[70:71], v8 offset:65088
    v_mfma_f32_16x16x32_bf16 v[192:195], v[72:75], v[24:27], v[192:195]
    v_mfma_f32_16x16x32_bf16 v[232:235], v[72:75], v[28:31], v[232:235]
    s_waitcnt lgkmcnt(15)
    v_mfma_f32_16x16x32_bf16 v[116:119], v[76:79], v[16:19], v[116:119]
    ds_read_b64_tr_b16 v[72:73], v8 offset:51296
    v_mfma_f32_16x16x32_bf16 v[156:159], v[76:79], v[20:23], v[156:159]
    ds_read_b64_tr_b16 v[74:75], v8 offset:55904
    v_mfma_f32_16x16x32_bf16 v[196:199], v[76:79], v[24:27], v[196:199]
    v_mfma_f32_16x16x32_bf16 v[236:239], v[76:79], v[28:31], v[236:239]
    v_mfma_f32_16x16x32_bf16 v[120:123], v[80:83], v[16:19], v[120:123]
    ds_read_b64_tr_b16 v[76:77], v8 offset:60512
    v_mfma_f32_16x16x32_bf16 v[160:163], v[80:83], v[20:23], v[160:163]
    ds_read_b64_tr_b16 v[78:79], v8 offset:65120
    v_mfma_f32_16x16x32_bf16 v[200:203], v[80:83], v[24:27], v[200:203]
    v_mfma_f32_16x16x32_bf16 v[240:243], v[80:83], v[28:31], v[240:243]
    v_mfma_f32_16x16x32_bf16 v[124:127], v[84:87], v[16:19], v[124:127]
    ds_read_b64_tr_b16 v[80:81], v252 offset:51200
    v_mfma_f32_16x16x32_bf16 v[164:167], v[84:87], v[20:23], v[164:167]
    ds_read_b64_tr_b16 v[82:83], v252 offset:55808
    v_mfma_f32_16x16x32_bf16 v[204:207], v[84:87], v[24:27], v[204:207]
    v_mfma_f32_16x16x32_bf16 v[244:247], v[84:87], v[28:31], v[244:247]
    ds_read_b64_tr_b16 v[84:85], v252 offset:60416
    ds_read_b64_tr_b16 v[86:87], v252 offset:65024
    s_waitcnt vmcnt(4)
    s_barrier
    s_waitcnt lgkmcnt(15)
    v_mfma_f32_16x16x32_bf16 v[88:91], v[48:51], v[32:35], v[88:91]
    s_add_u32 m0, s30, 0
    s_add_u32 s34, s31, 8192
    buffer_load_dwordx4 v10, s[16:19], s34 offen sc1 lds
    v_mfma_f32_16x16x32_bf16 v[128:131], v[48:51], v[36:39], v[128:131]
    ds_read_b128 v[16:19], v7 offset:0
    v_mfma_f32_16x16x32_bf16 v[168:171], v[48:51], v[40:43], v[168:171]
    s_add_u32 m0, s30, 1024
    s_add_u32 s34, s31, 26624
    buffer_load_dwordx4 v10, s[16:19], s34 offen sc1 lds
    v_mfma_f32_16x16x32_bf16 v[208:211], v[48:51], v[44:47], v[208:211]
    ds_read_b128 v[20:23], v7 offset:1024
    v_mfma_f32_16x16x32_bf16 v[92:95], v[52:55], v[32:35], v[92:95]
    s_add_u32 m0, s30, 2048
    s_add_u32 s34, s31, 45056
    buffer_load_dwordx4 v10, s[16:19], s34 offen sc1 lds
    v_mfma_f32_16x16x32_bf16 v[132:135], v[52:55], v[36:39], v[132:135]
    ds_read_b64_tr_b16 v[48:49], v9 offset:16384
    v_mfma_f32_16x16x32_bf16 v[172:175], v[52:55], v[40:43], v[172:175]
    s_add_u32 m0, s30, 3072
    s_add_u32 s34, s31, 63488
    buffer_load_dwordx4 v10, s[16:19], s34 offen sc1 lds
    v_mfma_f32_16x16x32_bf16 v[212:215], v[52:55], v[44:47], v[212:215]
    ds_read_b64_tr_b16 v[50:51], v9 offset:20992
    s_waitcnt lgkmcnt(15)
    v_mfma_f32_16x16x32_bf16 v[96:99], v[56:59], v[32:35], v[96:99]
    ds_read_b64_tr_b16 v[52:53], v9 offset:25600
    v_mfma_f32_16x16x32_bf16 v[136:139], v[56:59], v[36:39], v[136:139]
    ds_read_b64_tr_b16 v[54:55], v9 offset:30208
    v_mfma_f32_16x16x32_bf16 v[176:179], v[56:59], v[40:43], v[176:179]
    ds_read_b128 v[24:27], v7 offset:2048
    v_mfma_f32_16x16x32_bf16 v[216:219], v[56:59], v[44:47], v[216:219]
    ds_read_b128 v[28:31], v7 offset:3072
    v_mfma_f32_16x16x32_bf16 v[100:103], v[60:63], v[32:35], v[100:103]
    ds_read_b64_tr_b16 v[56:57], v9 offset:16416
    v_mfma_f32_16x16x32_bf16 v[140:143], v[60:63], v[36:39], v[140:143]
    ds_read_b64_tr_b16 v[58:59], v9 offset:21024
    v_mfma_f32_16x16x32_bf16 v[180:183], v[60:63], v[40:43], v[180:183]
    v_mfma_f32_16x16x32_bf16 v[220:223], v[60:63], v[44:47], v[220:223]
    s_waitcnt lgkmcnt(15)
    v_mfma_f32_16x16x32_bf16 v[104:107], v[64:67], v[32:35], v[104:107]
    ds_read_b64_tr_b16 v[60:61], v9 offset:25632
    v_mfma_f32_16x16x32_bf16 v[144:147], v[64:67], v[36:39], v[144:147]
    ds_read_b64_tr_b16 v[62:63], v9 offset:30240
    v_mfma_f32_16x16x32_bf16 v[184:187], v[64:67], v[40:43], v[184:187]
    v_mfma_f32_16x16x32_bf16 v[224:227], v[64:67], v[44:47], v[224:227]
    v_mfma_f32_16x16x32_bf16 v[108:111], v[68:71], v[32:35], v[108:111]
    ds_read_b64_tr_b16 v[64:65], v9 offset:16448
    v_mfma_f32_16x16x32_bf16 v[148:151], v[68:71], v[36:39], v[148:151]
    ds_read_b64_tr_b16 v[66:67], v9 offset:21056
    v_mfma_f32_16x16x32_bf16 v[188:191], v[68:71], v[40:43], v[188:191]
    v_mfma_f32_16x16x32_bf16 v[228:231], v[68:71], v[44:47], v[228:231]
    v_mfma_f32_16x16x32_bf16 v[112:115], v[72:75], v[32:35], v[112:115]
    ds_read_b64_tr_b16 v[68:69], v9 offset:25664
    v_mfma_f32_16x16x32_bf16 v[152:155], v[72:75], v[36:39], v[152:155]
    ds_read_b64_tr_b16 v[70:71], v9 offset:30272
    v_mfma_f32_16x16x32_bf16 v[192:195], v[72:75], v[40:43], v[192:195]
    v_mfma_f32_16x16x32_bf16 v[232:235], v[72:75], v[44:47], v[232:235]
    s_waitcnt lgkmcnt(15)
    v_mfma_f32_16x16x32_bf16 v[116:119], v[76:79], v[32:35], v[116:119]
    ds_read_b64_tr_b16 v[72:73], v9 offset:16480
    v_mfma_f32_16x16x32_bf16 v[156:159], v[76:79], v[36:39], v[156:159]
    ds_read_b64_tr_b16 v[74:75], v9 offset:21088
    v_mfma_f32_16x16x32_bf16 v[196:199], v[76:79], v[40:43], v[196:199]
    v_mfma_f32_16x16x32_bf16 v[236:239], v[76:79], v[44:47], v[236:239]
    v_mfma_f32_16x16x32_bf16 v[120:123], v[80:83], v[32:35], v[120:123]
    ds_read_b64_tr_b16 v[76:77], v9 offset:25696
    v_mfma_f32_16x16x32_bf16 v[160:163], v[80:83], v[36:39], v[160:163]
    ds_read_b64_tr_b16 v[78:79], v9 offset:30304
    v_mfma_f32_16x16x32_bf16 v[200:203], v[80:83], v[40:43], v[200:203]
    v_mfma_f32_16x16x32_bf16 v[240:243], v[80:83], v[44:47], v[240:243]
    v_mfma_f32_16x16x32_bf16 v[124:127], v[84:87], v[32:35], v[124:127]
    ds_read_b64_tr_b16 v[80:81], v253 offset:16384
    v_mfma_f32_16x16x32_bf16 v[164:167], v[84:87], v[36:39], v[164:167]
    ds_read_b64_tr_b16 v[82:83], v253 offset:20992
    v_mfma_f32_16x16x32_bf16 v[204:207], v[84:87], v[40:43], v[204:207]
    v_mfma_f32_16x16x32_bf16 v[244:247], v[84:87], v[44:47], v[244:247]
    ds_read_b64_tr_b16 v[84:85], v253 offset:25600
    ds_read_b64_tr_b16 v[86:87], v253 offset:30208
    s_waitcnt vmcnt(4)
    s_barrier
    s_waitcnt lgkmcnt(15)
    v_mfma_f32_16x16x32_bf16 v[88:91], v[48:51], v[16:19], v[88:91]
    s_add_u32 m0, s30, 34816
    s_add_u32 s34, s31, 9216
    buffer_load_dwordx4 v10, s[16:19], s34 offen sc1 lds
    v_mfma_f32_16x16x32_bf16 v[128:131], v[48:51], v[20:23], v[128:131]
    ds_read_b128 v[32:35], v7 offset:34816
    v_mfma_f32_16x16x32_bf16 v[168:171], v[48:51], v[24:27], v[168:171]
    s_add_u32 m0, s30, 35840
    s_add_u32 s34, s31, 27648
    buffer_load_dwordx4 v10, s[16:19], s34 offen sc1 lds
    v_mfma_f32_16x16x32_bf16 v[208:211], v[48:51], v[28:31], v[208:211]
    ds_read_b128 v[36:39], v7 offset:35840
    v_mfma_f32_16x16x32_bf16 v[92:95], v[52:55], v[16:19], v[92:95]
    s_add_u32 m0, s30, 36864
    s_add_u32 s34, s31, 46080
    buffer_load_dwordx4 v10, s[16:19], s34 offen sc1 lds
    v_mfma_f32_16x16x32_bf16 v[132:135], v[52:55], v[20:23], v[132:135]
    ds_read_b64_tr_b16 v[48:49], v9 offset:51200
    v_mfma_f32_16x16x32_bf16 v[172:175], v[52:55], v[24:27], v[172:175]
    s_add_u32 m0, s30, 37888
    s_add_u32 s34, s31, 64512
    buffer_load_dwordx4 v10, s[16:19], s34 offen sc1 lds
    v_mfma_f32_16x16x32_bf16 v[212:215], v[52:55], v[28:31], v[212:215]
    ds_read_b64_tr_b16 v[50:51], v9 offset:55808
    s_waitcnt lgkmcnt(15)
    v_mfma_f32_16x16x32_bf16 v[96:99], v[56:59], v[16:19], v[96:99]
    ds_read_b64_tr_b16 v[52:53], v9 offset:60416
    v_mfma_f32_16x16x32_bf16 v[136:139], v[56:59], v[20:23], v[136:139]
    ds_read_b64_tr_b16 v[54:55], v9 offset:65024
    v_mfma_f32_16x16x32_bf16 v[176:179], v[56:59], v[24:27], v[176:179]
    ds_read_b128 v[40:43], v7 offset:36864
    v_mfma_f32_16x16x32_bf16 v[216:219], v[56:59], v[28:31], v[216:219]
    ds_read_b128 v[44:47], v7 offset:37888
    v_mfma_f32_16x16x32_bf16 v[100:103], v[60:63], v[16:19], v[100:103]
    ds_read_b64_tr_b16 v[56:57], v9 offset:51232
    v_mfma_f32_16x16x32_bf16 v[140:143], v[60:63], v[20:23], v[140:143]
    ds_read_b64_tr_b16 v[58:59], v9 offset:55840
    v_mfma_f32_16x16x32_bf16 v[180:183], v[60:63], v[24:27], v[180:183]
    v_mfma_f32_16x16x32_bf16 v[220:223], v[60:63], v[28:31], v[220:223]
    s_waitcnt lgkmcnt(15)
    v_mfma_f32_16x16x32_bf16 v[104:107], v[64:67], v[16:19], v[104:107]
    ds_read_b64_tr_b16 v[60:61], v9 offset:60448
    v_mfma_f32_16x16x32_bf16 v[144:147], v[64:67], v[20:23], v[144:147]
    ds_read_b64_tr_b16 v[62:63], v9 offset:65056
    v_mfma_f32_16x16x32_bf16 v[184:187], v[64:67], v[24:27], v[184:187]
    v_mfma_f32_16x16x32_bf16 v[224:227], v[64:67], v[28:31], v[224:227]
    v_mfma_f32_16x16x32_bf16 v[108:111], v[68:71], v[16:19], v[108:111]
    ds_read_b64_tr_b16 v[64:65], v9 offset:51264
    v_mfma_f32_16x16x32_bf16 v[148:151], v[68:71], v[20:23], v[148:151]
    ds_read_b64_tr_b16 v[66:67], v9 offset:55872
    v_mfma_f32_16x16x32_bf16 v[188:191], v[68:71], v[24:27], v[188:191]
    v_mfma_f32_16x16x32_bf16 v[228:231], v[68:71], v[28:31], v[228:231]
    v_mfma_f32_16x16x32_bf16 v[112:115], v[72:75], v[16:19], v[112:115]
    ds_read_b64_tr_b16 v[68:69], v9 offset:60480
    v_mfma_f32_16x16x32_bf16 v[152:155], v[72:75], v[20:23], v[152:155]
    ds_read_b64_tr_b16 v[70:71], v9 offset:65088
    v_mfma_f32_16x16x32_bf16 v[192:195], v[72:75], v[24:27], v[192:195]
    v_mfma_f32_16x16x32_bf16 v[232:235], v[72:75], v[28:31], v[232:235]
    s_waitcnt lgkmcnt(15)
    v_mfma_f32_16x16x32_bf16 v[116:119], v[76:79], v[16:19], v[116:119]
    ds_read_b64_tr_b16 v[72:73], v9 offset:51296
    v_mfma_f32_16x16x32_bf16 v[156:159], v[76:79], v[20:23], v[156:159]
    ds_read_b64_tr_b16 v[74:75], v9 offset:55904
    v_mfma_f32_16x16x32_bf16 v[196:199], v[76:79], v[24:27], v[196:199]
    v_mfma_f32_16x16x32_bf16 v[236:239], v[76:79], v[28:31], v[236:239]
    v_mfma_f32_16x16x32_bf16 v[120:123], v[80:83], v[16:19], v[120:123]
    ds_read_b64_tr_b16 v[76:77], v9 offset:60512
    v_mfma_f32_16x16x32_bf16 v[160:163], v[80:83], v[20:23], v[160:163]
    ds_read_b64_tr_b16 v[78:79], v9 offset:65120
    v_mfma_f32_16x16x32_bf16 v[200:203], v[80:83], v[24:27], v[200:203]
    v_mfma_f32_16x16x32_bf16 v[240:243], v[80:83], v[28:31], v[240:243]
    v_mfma_f32_16x16x32_bf16 v[124:127], v[84:87], v[16:19], v[124:127]
    ds_read_b64_tr_b16 v[80:81], v253 offset:51200
    v_mfma_f32_16x16x32_bf16 v[164:167], v[84:87], v[20:23], v[164:167]
    ds_read_b64_tr_b16 v[82:83], v253 offset:55808
    v_mfma_f32_16x16x32_bf16 v[204:207], v[84:87], v[24:27], v[204:207]
    v_mfma_f32_16x16x32_bf16 v[244:247], v[84:87], v[28:31], v[244:247]
    ds_read_b64_tr_b16 v[84:85], v253 offset:60416
    ds_read_b64_tr_b16 v[86:87], v253 offset:65024
    s_waitcnt vmcnt(4)
    s_barrier
    s_waitcnt lgkmcnt(15)
    v_mfma_f32_16x16x32_bf16 v[88:91], v[48:51], v[32:35], v[88:91]
    s_add_u32 m0, s30, 69632
    s_add_u32 s34, s31, 10240
    buffer_load_dwordx4 v10, s[16:19], s34 offen sc1 lds
    v_mfma_f32_16x16x32_bf16 v[128:131], v[48:51], v[36:39], v[128:131]
    ds_read_b128 v[16:19], v6 offset:0
    v_mfma_f32_16x16x32_bf16 v[168:171], v[48:51], v[40:43], v[168:171]
    s_add_u32 m0, s30, 70656
    s_add_u32 s34, s31, 28672
    buffer_load_dwordx4 v10, s[16:19], s34 offen sc1 lds
    v_mfma_f32_16x16x32_bf16 v[208:211], v[48:51], v[44:47], v[208:211]
    ds_read_b128 v[20:23], v6 offset:1024
    v_mfma_f32_16x16x32_bf16 v[92:95], v[52:55], v[32:35], v[92:95]
    s_add_u32 m0, s30, 71680
    s_add_u32 s34, s31, 47104
    buffer_load_dwordx4 v10, s[16:19], s34 offen sc1 lds
    v_mfma_f32_16x16x32_bf16 v[132:135], v[52:55], v[36:39], v[132:135]
    ds_read_b64_tr_b16 v[48:49], v8 offset:16384
    v_mfma_f32_16x16x32_bf16 v[172:175], v[52:55], v[40:43], v[172:175]
    s_add_u32 m0, s30, 72704
    s_add_u32 s34, s31, 65536
    buffer_load_dwordx4 v10, s[16:19], s34 offen sc1 lds
    v_mfma_f32_16x16x32_bf16 v[212:215], v[52:55], v[44:47], v[212:215]
    ds_read_b64_tr_b16 v[50:51], v8 offset:20992
    s_waitcnt lgkmcnt(15)
    v_mfma_f32_16x16x32_bf16 v[96:99], v[56:59], v[32:35], v[96:99]
    ds_read_b64_tr_b16 v[52:53], v8 offset:25600
    v_mfma_f32_16x16x32_bf16 v[136:139], v[56:59], v[36:39], v[136:139]
    ds_read_b64_tr_b16 v[54:55], v8 offset:30208
    v_mfma_f32_16x16x32_bf16 v[176:179], v[56:59], v[40:43], v[176:179]
    ds_read_b128 v[24:27], v6 offset:2048
    v_mfma_f32_16x16x32_bf16 v[216:219], v[56:59], v[44:47], v[216:219]
    ds_read_b128 v[28:31], v6 offset:3072
    v_mfma_f32_16x16x32_bf16 v[100:103], v[60:63], v[32:35], v[100:103]
    ds_read_b64_tr_b16 v[56:57], v8 offset:16416
    v_mfma_f32_16x16x32_bf16 v[140:143], v[60:63], v[36:39], v[140:143]
    ds_read_b64_tr_b16 v[58:59], v8 offset:21024
    v_mfma_f32_16x16x32_bf16 v[180:183], v[60:63], v[40:43], v[180:183]
    v_mfma_f32_16x16x32_bf16 v[220:223], v[60:63], v[44:47], v[220:223]
    s_waitcnt lgkmcnt(15)
    v_mfma_f32_16x16x32_bf16 v[104:107], v[64:67], v[32:35], v[104:107]
    ds_read_b64_tr_b16 v[60:61], v8 offset:25632
    v_mfma_f32_16x16x32_bf16 v[144:147], v[64:67], v[36:39], v[144:147]
    ds_read_b64_tr_b16 v[62:63], v8 offset:30240
    v_mfma_f32_16x16x32_bf16 v[184:187], v[64:67], v[40:43], v[184:187]
    v_mfma_f32_16x16x32_bf16 v[224:227], v[64:67], v[44:47], v[224:227]
    v_mfma_f32_16x16x32_bf16 v[108:111], v[68:71], v[32:35], v[108:111]
    ds_read_b64_tr_b16 v[64:65], v8 offset:16448
    v_mfma_f32_16x16x32_bf16 v[148:151], v[68:71], v[36:39], v[148:151]
    ds_read_b64_tr_b16 v[66:67], v8 offset:21056
    v_mfma_f32_16x16x32_bf16 v[188:191], v[68:71], v[40:43], v[188:191]
    v_mfma_f32_16x16x32_bf16 v[228:231], v[68:71], v[44:47], v[228:231]
    v_mfma_f32_16x16x32_bf16 v[112:115], v[72:75], v[32:35], v[112:115]
    ds_read_b64_tr_b16 v[68:69], v8 offset:25664
    v_mfma_f32_16x16x32_bf16 v[152:155], v[72:75], v[36:39], v[152:155]
    ds_read_b64_tr_b16 v[70:71], v8 offset:30272
    v_mfma_f32_16x16x32_bf16 v[192:195], v[72:75], v[40:43], v[192:195]
    v_mfma_f32_16x16x32_bf16 v[232:235], v[72:75], v[44:47], v[232:235]
    s_waitcnt lgkmcnt(15)
    v_mfma_f32_16x16x32_bf16 v[116:119], v[76:79], v[32:35], v[116:119]
    ds_read_b64_tr_b16 v[72:73], v8 offset:16480
    v_mfma_f32_16x16x32_bf16 v[156:159], v[76:79], v[36:39], v[156:159]
    ds_read_b64_tr_b16 v[74:75], v8 offset:21088
    v_mfma_f32_16x16x32_bf16 v[196:199], v[76:79], v[40:43], v[196:199]
    v_mfma_f32_16x16x32_bf16 v[236:239], v[76:79], v[44:47], v[236:239]
    v_mfma_f32_16x16x32_bf16 v[120:123], v[80:83], v[32:35], v[120:123]
    ds_read_b64_tr_b16 v[76:77], v8 offset:25696
    v_mfma_f32_16x16x32_bf16 v[160:163], v[80:83], v[36:39], v[160:163]
    ds_read_b64_tr_b16 v[78:79], v8 offset:30304
    v_mfma_f32_16x16x32_bf16 v[200:203], v[80:83], v[40:43], v[200:203]
    v_mfma_f32_16x16x32_bf16 v[240:243], v[80:83], v[44:47], v[240:243]
    v_mfma_f32_16x16x32_bf16 v[124:127], v[84:87], v[32:35], v[124:127]
    ds_read_b64_tr_b16 v[80:81], v252 offset:16384
    v_mfma_f32_16x16x32_bf16 v[164:167], v[84:87], v[36:39], v[164:167]
    ds_read_b64_tr_b16 v[82:83], v252 offset:20992
    v_mfma_f32_16x16x32_bf16 v[204:207], v[84:87], v[40:43], v[204:207]
    v_mfma_f32_16x16x32_bf16 v[244:247], v[84:87], v[44:47], v[244:247]
    ds_read_b64_tr_b16 v[84:85], v252 offset:25600
    ds_read_b64_tr_b16 v[86:87], v252 offset:30208
    s_waitcnt vmcnt(4)
    s_barrier
    s_waitcnt lgkmcnt(15)
    v_mfma_f32_16x16x32_bf16 v[88:91], v[48:51], v[16:19], v[88:91]
    s_add_u32 m0, s30, 104448
    s_add_u32 s34, s31, 11264
    buffer_load_dwordx4 v10, s[16:19], s34 offen sc1 lds
    v_mfma_f32_16x16x32_bf16 v[128:131], v[48:51], v[20:23], v[128:131]
    ds_read_b128 v[32:35], v6 offset:34816
    v_mfma_f32_16x16x32_bf16 v[168:171], v[48:51], v[24:27], v[168:171]
    s_add_u32 m0, s30, 105472
    s_add_u32 s34, s31, 29696
    buffer_load_dwordx4 v10, s[16:19], s34 offen sc1 lds
    v_mfma_f32_16x16x32_bf16 v[208:211], v[48:51], v[28:31], v[208:211]
    ds_read_b128 v[36:39], v6 offset:35840
    v_mfma_f32_16x16x32_bf16 v[92:95], v[52:55], v[16:19], v[92:95]
    s_add_u32 m0, s30, 106496
    s_add_u32 s34, s31, 48128
    buffer_load_dwordx4 v10, s[16:19], s34 offen sc1 lds
    v_mfma_f32_16x16x32_bf16 v[132:135], v[52:55], v[20:23], v[132:135]
    ds_read_b64_tr_b16 v[48:49], v8 offset:51200
    v_mfma_f32_16x16x32_bf16 v[172:175], v[52:55], v[24:27], v[172:175]
    s_add_u32 m0, s30, 107520
    s_add_u32 s34, s31, 66560
    buffer_load_dwordx4 v10, s[16:19], s34 offen sc1 lds
    v_mfma_f32_16x16x32_bf16 v[212:215], v[52:55], v[28:31], v[212:215]
    ds_read_b64_tr_b16 v[50:51], v8 offset:55808
    s_waitcnt lgkmcnt(15)
    v_mfma_f32_16x16x32_bf16 v[96:99], v[56:59], v[16:19], v[96:99]
    ds_read_b64_tr_b16 v[52:53], v8 offset:60416
    v_mfma_f32_16x16x32_bf16 v[136:139], v[56:59], v[20:23], v[136:139]
    ds_read_b64_tr_b16 v[54:55], v8 offset:65024
    v_mfma_f32_16x16x32_bf16 v[176:179], v[56:59], v[24:27], v[176:179]
    ds_read_b128 v[40:43], v6 offset:36864
    v_mfma_f32_16x16x32_bf16 v[216:219], v[56:59], v[28:31], v[216:219]
    ds_read_b128 v[44:47], v6 offset:37888
    v_mfma_f32_16x16x32_bf16 v[100:103], v[60:63], v[16:19], v[100:103]
    ds_read_b64_tr_b16 v[56:57], v8 offset:51232
    v_mfma_f32_16x16x32_bf16 v[140:143], v[60:63], v[20:23], v[140:143]
    ds_read_b64_tr_b16 v[58:59], v8 offset:55840
    v_mfma_f32_16x16x32_bf16 v[180:183], v[60:63], v[24:27], v[180:183]
    v_mfma_f32_16x16x32_bf16 v[220:223], v[60:63], v[28:31], v[220:223]
    s_waitcnt lgkmcnt(15)
    v_mfma_f32_16x16x32_bf16 v[104:107], v[64:67], v[16:19], v[104:107]
    ds_read_b64_tr_b16 v[60:61], v8 offset:60448
    v_mfma_f32_16x16x32_bf16 v[144:147], v[64:67], v[20:23], v[144:147]
    ds_read_b64_tr_b16 v[62:63], v8 offset:65056
    v_mfma_f32_16x16x32_bf16 v[184:187], v[64:67], v[24:27], v[184:187]
    v_mfma_f32_16x16x32_bf16 v[224:227], v[64:67], v[28:31], v[224:227]
    v_mfma_f32_16x16x32_bf16 v[108:111], v[68:71], v[16:19], v[108:111]
    ds_read_b64_tr_b16 v[64:65], v8 offset:51264
    v_mfma_f32_16x16x32_bf16 v[148:151], v[68:71], v[20:23], v[148:151]
    ds_read_b64_tr_b16 v[66:67], v8 offset:55872
    v_mfma_f32_16x16x32_bf16 v[188:191], v[68:71], v[24:27], v[188:191]
    v_mfma_f32_16x16x32_bf16 v[228:231], v[68:71], v[28:31], v[228:231]
    v_mfma_f32_16x16x32_bf16 v[112:115], v[72:75], v[16:19], v[112:115]
    ds_read_b64_tr_b16 v[68:69], v8 offset:60480
    v_mfma_f32_16x16x32_bf16 v[152:155], v[72:75], v[20:23], v[152:155]
    ds_read_b64_tr_b16 v[70:71], v8 offset:65088
    v_mfma_f32_16x16x32_bf16 v[192:195], v[72:75], v[24:27], v[192:195]
    v_mfma_f32_16x16x32_bf16 v[232:235], v[72:75], v[28:31], v[232:235]
    s_waitcnt lgkmcnt(15)
    v_mfma_f32_16x16x32_bf16 v[116:119], v[76:79], v[16:19], v[116:119]
    ds_read_b64_tr_b16 v[72:73], v8 offset:51296
    v_mfma_f32_16x16x32_bf16 v[156:159], v[76:79], v[20:23], v[156:159]
    ds_read_b64_tr_b16 v[74:75], v8 offset:55904
    v_mfma_f32_16x16x32_bf16 v[196:199], v[76:79], v[24:27], v[196:199]
    v_mfma_f32_16x16x32_bf16 v[236:239], v[76:79], v[28:31], v[236:239]
    v_mfma_f32_16x16x32_bf16 v[120:123], v[80:83], v[16:19], v[120:123]
    ds_read_b64_tr_b16 v[76:77], v8 offset:60512
    v_mfma_f32_16x16x32_bf16 v[160:163], v[80:83], v[20:23], v[160:163]
    ds_read_b64_tr_b16 v[78:79], v8 offset:65120
    v_mfma_f32_16x16x32_bf16 v[200:203], v[80:83], v[24:27], v[200:203]
    v_mfma_f32_16x16x32_bf16 v[240:243], v[80:83], v[28:31], v[240:243]
    v_mfma_f32_16x16x32_bf16 v[124:127], v[84:87], v[16:19], v[124:127]
    ds_read_b64_tr_b16 v[80:81], v252 offset:51200
    v_mfma_f32_16x16x32_bf16 v[164:167], v[84:87], v[20:23], v[164:167]
    ds_read_b64_tr_b16 v[82:83], v252 offset:55808
    v_mfma_f32_16x16x32_bf16 v[204:207], v[84:87], v[24:27], v[204:207]
    v_mfma_f32_16x16x32_bf16 v[244:247], v[84:87], v[28:31], v[244:247]
    ds_read_b64_tr_b16 v[84:85], v252 offset:60416
    ds_read_b64_tr_b16 v[86:87], v252 offset:65024
    s_waitcnt vmcnt(4)
    s_barrier
    s_waitcnt lgkmcnt(15)
    v_mfma_f32_16x16x32_bf16 v[88:91], v[48:51], v[32:35], v[88:91]
    s_add_u32 m0, s30, 0
    s_add_u32 s34, s31, 12288
    buffer_load_dwordx4 v10, s[16:19], s34 offen sc1 lds
    v_mfma_f32_16x16x32_bf16 v[128:131], v[48:51], v[36:39], v[128:131]
    ds_read_b128 v[16:19], v7 offset:0
    v_mfma_f32_16x16x32_bf16 v[168:171], v[48:51], v[40:43], v[168:171]
    s_add_u32 m0, s30, 1024
    s_add_u32 s34, s31, 30720
    buffer_load_dwordx4 v10, s[16:19], s34 offen sc1 lds
    v_mfma_f32_16x16x32_bf16 v[208:211], v[48:51], v[44:47], v[208:211]
    ds_read_b128 v[20:23], v7 offset:1024
    v_mfma_f32_16x16x32_bf16 v[92:95], v[52:55], v[32:35], v[92:95]
    s_add_u32 m0, s30, 2048
    s_add_u32 s34, s31, 49152
    buffer_load_dwordx4 v10, s[16:19], s34 offen sc1 lds
    v_mfma_f32_16x16x32_bf16 v[132:135], v[52:55], v[36:39], v[132:135]
    ds_read_b64_tr_b16 v[48:49], v9 offset:16384
    v_mfma_f32_16x16x32_bf16 v[172:175], v[52:55], v[40:43], v[172:175]
    s_add_u32 m0, s30, 3072
    s_add_u32 s34, s31, 67584
    buffer_load_dwordx4 v10, s[16:19], s34 offen sc1 lds
    v_mfma_f32_16x16x32_bf16 v[212:215], v[52:55], v[44:47], v[212:215]
    ds_read_b64_tr_b16 v[50:51], v9 offset:20992
    s_waitcnt lgkmcnt(15)
    v_mfma_f32_16x16x32_bf16 v[96:99], v[56:59], v[32:35], v[96:99]
    ds_read_b64_tr_b16 v[52:53], v9 offset:25600
    v_mfma_f32_16x16x32_bf16 v[136:139], v[56:59], v[36:39], v[136:139]
    ds_read_b64_tr_b16 v[54:55], v9 offset:30208
    v_mfma_f32_16x16x32_bf16 v[176:179], v[56:59], v[40:43], v[176:179]
    ds_read_b128 v[24:27], v7 offset:2048
    v_mfma_f32_16x16x32_bf16 v[216:219], v[56:59], v[44:47], v[216:219]
    ds_read_b128 v[28:31], v7 offset:3072
    v_mfma_f32_16x16x32_bf16 v[100:103], v[60:63], v[32:35], v[100:103]
    ds_read_b64_tr_b16 v[56:57], v9 offset:16416
    v_mfma_f32_16x16x32_bf16 v[140:143], v[60:63], v[36:39], v[140:143]
    ds_read_b64_tr_b16 v[58:59], v9 offset:21024
    v_mfma_f32_16x16x32_bf16 v[180:183], v[60:63], v[40:43], v[180:183]
    v_mfma_f32_16x16x32_bf16 v[220:223], v[60:63], v[44:47], v[220:223]
    s_waitcnt lgkmcnt(15)
    v_mfma_f32_16x16x32_bf16 v[104:107], v[64:67], v[32:35], v[104:107]
    ds_read_b64_tr_b16 v[60:61], v9 offset:25632
    v_mfma_f32_16x16x32_bf16 v[144:147], v[64:67], v[36:39], v[144:147]
    ds_read_b64_tr_b16 v[62:63], v9 offset:30240
    v_mfma_f32_16x16x32_bf16 v[184:187], v[64:67], v[40:43], v[184:187]
    v_mfma_f32_16x16x32_bf16 v[224:227], v[64:67], v[44:47], v[224:227]
    v_mfma_f32_16x16x32_bf16 v[108:111], v[68:71], v[32:35], v[108:111]
    ds_read_b64_tr_b16 v[64:65], v9 offset:16448
    v_mfma_f32_16x16x32_bf16 v[148:151], v[68:71], v[36:39], v[148:151]
    ds_read_b64_tr_b16 v[66:67], v9 offset:21056
    v_mfma_f32_16x16x32_bf16 v[188:191], v[68:71], v[40:43], v[188:191]
    v_mfma_f32_16x16x32_bf16 v[228:231], v[68:71], v[44:47], v[228:231]
    v_mfma_f32_16x16x32_bf16 v[112:115], v[72:75], v[32:35], v[112:115]
    ds_read_b64_tr_b16 v[68:69], v9 offset:25664
    v_mfma_f32_16x16x32_bf16 v[152:155], v[72:75], v[36:39], v[152:155]
    ds_read_b64_tr_b16 v[70:71], v9 offset:30272
    v_mfma_f32_16x16x32_bf16 v[192:195], v[72:75], v[40:43], v[192:195]
    v_mfma_f32_16x16x32_bf16 v[232:235], v[72:75], v[44:47], v[232:235]
    s_waitcnt lgkmcnt(15)
    v_mfma_f32_16x16x32_bf16 v[116:119], v[76:79], v[32:35], v[116:119]
    ds_read_b64_tr_b16 v[72:73], v9 offset:16480
    v_mfma_f32_16x16x32_bf16 v[156:159], v[76:79], v[36:39], v[156:159]
    ds_read_b64_tr_b16 v[74:75], v9 offset:21088
    v_mfma_f32_16x16x32_bf16 v[196:199], v[76:79], v[40:43], v[196:199]
    v_mfma_f32_16x16x32_bf16 v[236:239], v[76:79], v[44:47], v[236:239]
    v_mfma_f32_16x16x32_bf16 v[120:123], v[80:83], v[32:35], v[120:123]
    ds_read_b64_tr_b16 v[76:77], v9 offset:25696
    v_mfma_f32_16x16x32_bf16 v[160:163], v[80:83], v[36:39], v[160:163]
    ds_read_b64_tr_b16 v[78:79], v9 offset:30304
    v_mfma_f32_16x16x32_bf16 v[200:203], v[80:83], v[40:43], v[200:203]
    v_mfma_f32_16x16x32_bf16 v[240:243], v[80:83], v[44:47], v[240:243]
    v_mfma_f32_16x16x32_bf16 v[124:127], v[84:87], v[32:35], v[124:127]
    ds_read_b64_tr_b16 v[80:81], v253 offset:16384
    v_mfma_f32_16x16x32_bf16 v[164:167], v[84:87], v[36:39], v[164:167]
    ds_read_b64_tr_b16 v[82:83], v253 offset:20992
    v_mfma_f32_16x16x32_bf16 v[204:207], v[84:87], v[40:43], v[204:207]
    v_mfma_f32_16x16x32_bf16 v[244:247], v[84:87], v[44:47], v[244:247]
    ds_read_b64_tr_b16 v[84:85], v253 offset:25600
    ds_read_b64_tr_b16 v[86:87], v253 offset:30208
    s_waitcnt vmcnt(4)
    s_barrier
    s_waitcnt lgkmcnt(15)
    v_mfma_f32_16x16x32_bf16 v[88:91], v[48:51], v[16:19], v[88:91]
    s_add_u32 m0, s30, 34816
    s_add_u32 s34, s31, 13312
    buffer_load_dwordx4 v10, s[16:19], s34 offen sc1 lds
    v_mfma_f32_16x16x32_bf16 v[128:131], v[48:51], v[20:23], v[128:131]
    ds_read_b128 v[32:35], v7 offset:34816
    v_mfma_f32_16x16x32_bf16 v[168:171], v[48:51], v[24:27], v[168:171]
    s_add_u32 m0, s30, 35840
    s_add_u32 s34, s31, 31744
    buffer_load_dwordx4 v10, s[16:19], s34 offen sc1 lds
    v_mfma_f32_16x16x32_bf16 v[208:211], v[48:51], v[28:31], v[208:211]
    ds_read_b128 v[36:39], v7 offset:35840
    v_mfma_f32_16x16x32_bf16 v[92:95], v[52:55], v[16:19], v[92:95]
    s_add_u32 m0, s30, 36864
    s_add_u32 s34, s31, 50176
    buffer_load_dwordx4 v10, s[16:19], s34 offen sc1 lds
    v_mfma_f32_16x16x32_bf16 v[132:135], v[52:55], v[20:23], v[132:135]
    ds_read_b64_tr_b16 v[48:49], v9 offset:51200
    v_mfma_f32_16x16x32_bf16 v[172:175], v[52:55], v[24:27], v[172:175]
    s_add_u32 m0, s30, 37888
    s_add_u32 s34, s31, 68608
    buffer_load_dwordx4 v10, s[16:19], s34 offen sc1 lds
    v_mfma_f32_16x16x32_bf16 v[212:215], v[52:55], v[28:31], v[212:215]
    ds_read_b64_tr_b16 v[50:51], v9 offset:55808
    s_waitcnt lgkmcnt(15)
    v_mfma_f32_16x16x32_bf16 v[96:99], v[56:59], v[16:19], v[96:99]
    ds_read_b64_tr_b16 v[52:53], v9 offset:60416
    v_mfma_f32_16x16x32_bf16 v[136:139], v[56:59], v[20:23], v[136:139]
    ds_read_b64_tr_b16 v[54:55], v9 offset:65024
    v_mfma_f32_16x16x32_bf16 v[176:179], v[56:59], v[24:27], v[176:179]
    ds_read_b128 v[40:43], v7 offset:36864
    v_mfma_f32_16x16x32_bf16 v[216:219], v[56:59], v[28:31], v[216:219]
    ds_read_b128 v[44:47], v7 offset:37888
    v_mfma_f32_16x16x32_bf16 v[100:103], v[60:63], v[16:19], v[100:103]
    ds_read_b64_tr_b16 v[56:57], v9 offset:51232
    v_mfma_f32_16x16x32_bf16 v[140:143], v[60:63], v[20:23], v[140:143]
    ds_read_b64_tr_b16 v[58:59], v9 offset:55840
    v_mfma_f32_16x16x32_bf16 v[180:183], v[60:63], v[24:27], v[180:183]
    v_mfma_f32_16x16x32_bf16 v[220:223], v[60:63], v[28:31], v[220:223]
    s_waitcnt lgkmcnt(15)
    v_mfma_f32_16x16x32_bf16 v[104:107], v[64:67], v[16:19], v[104:107]
    ds_read_b64_tr_b16 v[60:61], v9 offset:60448
    v_mfma_f32_16x16x32_bf16 v[144:147], v[64:67], v[20:23], v[144:147]
    ds_read_b64_tr_b16 v[62:63], v9 offset:65056
    v_mfma_f32_16x16x32_bf16 v[184:187], v[64:67], v[24:27], v[184:187]
    v_mfma_f32_16x16x32_bf16 v[224:227], v[64:67], v[28:31], v[224:227]
    v_mfma_f32_16x16x32_bf16 v[108:111], v[68:71], v[16:19], v[108:111]
    ds_read_b64_tr_b16 v[64:65], v9 offset:51264
    v_mfma_f32_16x16x32_bf16 v[148:151], v[68:71], v[20:23], v[148:151]
    ds_read_b64_tr_b16 v[66:67], v9 offset:55872
    v_mfma_f32_16x16x32_bf16 v[188:191], v[68:71], v[24:27], v[188:191]
    v_mfma_f32_16x16x32_bf16 v[228:231], v[68:71], v[28:31], v[228:231]
    v_mfma_f32_16x16x32_bf16 v[112:115], v[72:75], v[16:19], v[112:115]
    ds_read_b64_tr_b16 v[68:69], v9 offset:60480
    v_mfma_f32_16x16x32_bf16 v[152:155], v[72:75], v[20:23], v[152:155]
    ds_read_b64_tr_b16 v[70:71], v9 offset:65088
    v_mfma_f32_16x16x32_bf16 v[192:195], v[72:75], v[24:27], v[192:195]
    v_mfma_f32_16x16x32_bf16 v[232:235], v[72:75], v[28:31], v[232:235]
    s_waitcnt lgkmcnt(15)
    v_mfma_f32_16x16x32_bf16 v[116:119], v[76:79], v[16:19], v[116:119]
    ds_read_b64_tr_b16 v[72:73], v9 offset:51296
    v_mfma_f32_16x16x32_bf16 v[156:159], v[76:79], v[20:23], v[156:159]
    ds_read_b64_tr_b16 v[74:75], v9 offset:55904
    v_mfma_f32_16x16x32_bf16 v[196:199], v[76:79], v[24:27], v[196:199]
    v_mfma_f32_16x16x32_bf16 v[236:239], v[76:79], v[28:31], v[236:239]
    v_mfma_f32_16x16x32_bf16 v[120:123], v[80:83], v[16:19], v[120:123]
    ds_read_b64_tr_b16 v[76:77], v9 offset:60512
    v_mfma_f32_16x16x32_bf16 v[160:163], v[80:83], v[20:23], v[160:163]
    ds_read_b64_tr_b16 v[78:79], v9 offset:65120
    v_mfma_f32_16x16x32_bf16 v[200:203], v[80:83], v[24:27], v[200:203]
    v_mfma_f32_16x16x32_bf16 v[240:243], v[80:83], v[28:31], v[240:243]
    v_mfma_f32_16x16x32_bf16 v[124:127], v[84:87], v[16:19], v[124:127]
    ds_read_b64_tr_b16 v[80:81], v253 offset:51200
    v_mfma_f32_16x16x32_bf16 v[164:167], v[84:87], v[20:23], v[164:167]
    ds_read_b64_tr_b16 v[82:83], v253 offset:55808
    v_mfma_f32_16x16x32_bf16 v[204:207], v[84:87], v[24:27], v[204:207]
    v_mfma_f32_16x16x32_bf16 v[244:247], v[84:87], v[28:31], v[244:247]
    ds_read_b64_tr_b16 v[84:85], v253 offset:60416
    ds_read_b64_tr_b16 v[86:87], v253 offset:65024
    s_waitcnt vmcnt(4)
    s_barrier
    s_waitcnt lgkmcnt(15)
    v_mfma_f32_16x16x32_bf16 v[88:91], v[48:51], v[32:35], v[88:91]
    s_add_u32 m0, s30, 69632
    s_add_u32 s34, s31, 14336
    buffer_load_dwordx4 v10, s[16:19], s34 offen sc1 lds
    v_mfma_f32_16x16x32_bf16 v[128:131], v[48:51], v[36:39], v[128:131]
    ds_read_b128 v[16:19], v6 offset:0
    v_mfma_f32_16x16x32_bf16 v[168:171], v[48:51], v[40:43], v[168:171]
    s_add_u32 m0, s30, 70656
    s_add_u32 s34, s31, 32768
    buffer_load_dwordx4 v10, s[16:19], s34 offen sc1 lds
    v_mfma_f32_16x16x32_bf16 v[208:211], v[48:51], v[44:47], v[208:211]
    ds_read_b128 v[20:23], v6 offset:1024
    v_mfma_f32_16x16x32_bf16 v[92:95], v[52:55], v[32:35], v[92:95]
    s_add_u32 m0, s30, 71680
    s_add_u32 s34, s31, 51200
    buffer_load_dwordx4 v10, s[16:19], s34 offen sc1 lds
    v_mfma_f32_16x16x32_bf16 v[132:135], v[52:55], v[36:39], v[132:135]
    ds_read_b64_tr_b16 v[48:49], v8 offset:16384
    v_mfma_f32_16x16x32_bf16 v[172:175], v[52:55], v[40:43], v[172:175]
    s_add_u32 m0, s30, 72704
    s_add_u32 s34, s31, 69632
    buffer_load_dwordx4 v10, s[16:19], s34 offen sc1 lds
    v_mfma_f32_16x16x32_bf16 v[212:215], v[52:55], v[44:47], v[212:215]
    ds_read_b64_tr_b16 v[50:51], v8 offset:20992
    s_waitcnt lgkmcnt(15)
    v_mfma_f32_16x16x32_bf16 v[96:99], v[56:59], v[32:35], v[96:99]
    ds_read_b64_tr_b16 v[52:53], v8 offset:25600
    v_mfma_f32_16x16x32_bf16 v[136:139], v[56:59], v[36:39], v[136:139]
    ds_read_b64_tr_b16 v[54:55], v8 offset:30208
    v_mfma_f32_16x16x32_bf16 v[176:179], v[56:59], v[40:43], v[176:179]
    ds_read_b128 v[24:27], v6 offset:2048
    v_mfma_f32_16x16x32_bf16 v[216:219], v[56:59], v[44:47], v[216:219]
    ds_read_b128 v[28:31], v6 offset:3072
    v_mfma_f32_16x16x32_bf16 v[100:103], v[60:63], v[32:35], v[100:103]
    ds_read_b64_tr_b16 v[56:57], v8 offset:16416
    v_mfma_f32_16x16x32_bf16 v[140:143], v[60:63], v[36:39], v[140:143]
    ds_read_b64_tr_b16 v[58:59], v8 offset:21024
    v_mfma_f32_16x16x32_bf16 v[180:183], v[60:63], v[40:43], v[180:183]
    v_mfma_f32_16x16x32_bf16 v[220:223], v[60:63], v[44:47], v[220:223]
    s_waitcnt lgkmcnt(15)
    v_mfma_f32_16x16x32_bf16 v[104:107], v[64:67], v[32:35], v[104:107]
    ds_read_b64_tr_b16 v[60:61], v8 offset:25632
    v_mfma_f32_16x16x32_bf16 v[144:147], v[64:67], v[36:39], v[144:147]
    ds_read_b64_tr_b16 v[62:63], v8 offset:30240
    v_mfma_f32_16x16x32_bf16 v[184:187], v[64:67], v[40:43], v[184:187]
    v_mfma_f32_16x16x32_bf16 v[224:227], v[64:67], v[44:47], v[224:227]
    v_mfma_f32_16x16x32_bf16 v[108:111], v[68:71], v[32:35], v[108:111]
    ds_read_b64_tr_b16 v[64:65], v8 offset:16448
    v_mfma_f32_16x16x32_bf16 v[148:151], v[68:71], v[36:39], v[148:151]
    ds_read_b64_tr_b16 v[66:67], v8 offset:21056
    v_mfma_f32_16x16x32_bf16 v[188:191], v[68:71], v[40:43], v[188:191]
    v_mfma_f32_16x16x32_bf16 v[228:231], v[68:71], v[44:47], v[228:231]
    v_mfma_f32_16x16x32_bf16 v[112:115], v[72:75], v[32:35], v[112:115]
    ds_read_b64_tr_b16 v[68:69], v8 offset:25664
    v_mfma_f32_16x16x32_bf16 v[152:155], v[72:75], v[36:39], v[152:155]
    ds_read_b64_tr_b16 v[70:71], v8 offset:30272
    v_mfma_f32_16x16x32_bf16 v[192:195], v[72:75], v[40:43], v[192:195]
    v_mfma_f32_16x16x32_bf16 v[232:235], v[72:75], v[44:47], v[232:235]
    s_waitcnt lgkmcnt(15)
    v_mfma_f32_16x16x32_bf16 v[116:119], v[76:79], v[32:35], v[116:119]
    ds_read_b64_tr_b16 v[72:73], v8 offset:16480
    v_mfma_f32_16x16x32_bf16 v[156:159], v[76:79], v[36:39], v[156:159]
    ds_read_b64_tr_b16 v[74:75], v8 offset:21088
    v_mfma_f32_16x16x32_bf16 v[196:199], v[76:79], v[40:43], v[196:199]
    v_mfma_f32_16x16x32_bf16 v[236:239], v[76:79], v[44:47], v[236:239]
    v_mfma_f32_16x16x32_bf16 v[120:123], v[80:83], v[32:35], v[120:123]
    ds_read_b64_tr_b16 v[76:77], v8 offset:25696
    v_mfma_f32_16x16x32_bf16 v[160:163], v[80:83], v[36:39], v[160:163]
    ds_read_b64_tr_b16 v[78:79], v8 offset:30304
    v_mfma_f32_16x16x32_bf16 v[200:203], v[80:83], v[40:43], v[200:203]
    v_mfma_f32_16x16x32_bf16 v[240:243], v[80:83], v[44:47], v[240:243]
    v_mfma_f32_16x16x32_bf16 v[124:127], v[84:87], v[32:35], v[124:127]
    ds_read_b64_tr_b16 v[80:81], v252 offset:16384
    v_mfma_f32_16x16x32_bf16 v[164:167], v[84:87], v[36:39], v[164:167]
    ds_read_b64_tr_b16 v[82:83], v252 offset:20992
    v_mfma_f32_16x16x32_bf16 v[204:207], v[84:87], v[40:43], v[204:207]
    v_mfma_f32_16x16x32_bf16 v[244:247], v[84:87], v[44:47], v[244:247]
    ds_read_b64_tr_b16 v[84:85], v252 offset:25600
    ds_read_b64_tr_b16 v[86:87], v252 offset:30208
    s_waitcnt vmcnt(4)
    s_barrier
    s_waitcnt lgkmcnt(15)
    v_mfma_f32_16x16x32_bf16 v[88:91], v[48:51], v[16:19], v[88:91]
    s_add_u32 m0, s30, 104448
    s_add_u32 s34, s31, 15360
    buffer_load_dwordx4 v10, s[16:19], s34 offen sc1 lds
    v_mfma_f32_16x16x32_bf16 v[128:131], v[48:51], v[20:23], v[128:131]
    ds_read_b128 v[32:35], v6 offset:34816
    v_mfma_f32_16x16x32_bf16 v[168:171], v[48:51], v[24:27], v[168:171]
    s_add_u32 m0, s30, 105472
    s_add_u32 s34, s31, 33792
    buffer_load_dwordx4 v10, s[16:19], s34 offen sc1 lds
    v_mfma_f32_16x16x32_bf16 v[208:211], v[48:51], v[28:31], v[208:211]
    ds_read_b128 v[36:39], v6 offset:35840
    v_mfma_f32_16x16x32_bf16 v[92:95], v[52:55], v[16:19], v[92:95]
    s_add_u32 m0, s30, 106496
    s_add_u32 s34, s31, 52224
    buffer_load_dwordx4 v10, s[16:19], s34 offen sc1 lds
    v_mfma_f32_16x16x32_bf16 v[132:135], v[52:55], v[20:23], v[132:135]
    ds_read_b64_tr_b16 v[48:49], v8 offset:51200
    v_mfma_f32_16x16x32_bf16 v[172:175], v[52:55], v[24:27], v[172:175]
    s_add_u32 m0, s30, 107520
    s_add_u32 s34, s31, 70656
    buffer_load_dwordx4 v10, s[16:19], s34 offen sc1 lds
    v_mfma_f32_16x16x32_bf16 v[212:215], v[52:55], v[28:31], v[212:215]
    ds_read_b64_tr_b16 v[50:51], v8 offset:55808
    s_waitcnt lgkmcnt(15)
    v_mfma_f32_16x16x32_bf16 v[96:99], v[56:59], v[16:19], v[96:99]
    ds_read_b64_tr_b16 v[52:53], v8 offset:60416
    v_mfma_f32_16x16x32_bf16 v[136:139], v[56:59], v[20:23], v[136:139]
    ds_read_b64_tr_b16 v[54:55], v8 offset:65024
    v_mfma_f32_16x16x32_bf16 v[176:179], v[56:59], v[24:27], v[176:179]
    ds_read_b128 v[40:43], v6 offset:36864
    v_mfma_f32_16x16x32_bf16 v[216:219], v[56:59], v[28:31], v[216:219]
    ds_read_b128 v[44:47], v6 offset:37888
    v_mfma_f32_16x16x32_bf16 v[100:103], v[60:63], v[16:19], v[100:103]
    ds_read_b64_tr_b16 v[56:57], v8 offset:51232
    v_mfma_f32_16x16x32_bf16 v[140:143], v[60:63], v[20:23], v[140:143]
    ds_read_b64_tr_b16 v[58:59], v8 offset:55840
    v_mfma_f32_16x16x32_bf16 v[180:183], v[60:63], v[24:27], v[180:183]
    v_mfma_f32_16x16x32_bf16 v[220:223], v[60:63], v[28:31], v[220:223]
    s_waitcnt lgkmcnt(15)
    v_mfma_f32_16x16x32_bf16 v[104:107], v[64:67], v[16:19], v[104:107]
    ds_read_b64_tr_b16 v[60:61], v8 offset:60448
    v_mfma_f32_16x16x32_bf16 v[144:147], v[64:67], v[20:23], v[144:147]
    ds_read_b64_tr_b16 v[62:63], v8 offset:65056
    v_mfma_f32_16x16x32_bf16 v[184:187], v[64:67], v[24:27], v[184:187]
    v_mfma_f32_16x16x32_bf16 v[224:227], v[64:67], v[28:31], v[224:227]
    v_mfma_f32_16x16x32_bf16 v[108:111], v[68:71], v[16:19], v[108:111]
    ds_read_b64_tr_b16 v[64:65], v8 offset:51264
    v_mfma_f32_16x16x32_bf16 v[148:151], v[68:71], v[20:23], v[148:151]
    ds_read_b64_tr_b16 v[66:67], v8 offset:55872
    v_mfma_f32_16x16x32_bf16 v[188:191], v[68:71], v[24:27], v[188:191]
    v_mfma_f32_16x16x32_bf16 v[228:231], v[68:71], v[28:31], v[228:231]
    v_mfma_f32_16x16x32_bf16 v[112:115], v[72:75], v[16:19], v[112:115]
    ds_read_b64_tr_b16 v[68:69], v8 offset:60480
    v_mfma_f32_16x16x32_bf16 v[152:155], v[72:75], v[20:23], v[152:155]
    ds_read_b64_tr_b16 v[70:71], v8 offset:65088
    v_mfma_f32_16x16x32_bf16 v[192:195], v[72:75], v[24:27], v[192:195]
    v_mfma_f32_16x16x32_bf16 v[232:235], v[72:75], v[28:31], v[232:235]
    s_waitcnt lgkmcnt(15)
    v_mfma_f32_16x16x32_bf16 v[116:119], v[76:79], v[16:19], v[116:119]
    ds_read_b64_tr_b16 v[72:73], v8 offset:51296
    v_mfma_f32_16x16x32_bf16 v[156:159], v[76:79], v[20:23], v[156:159]
    ds_read_b64_tr_b16 v[74:75], v8 offset:55904
    v_mfma_f32_16x16x32_bf16 v[196:199], v[76:79], v[24:27], v[196:199]
    v_mfma_f32_16x16x32_bf16 v[236:239], v[76:79], v[28:31], v[236:239]
    v_mfma_f32_16x16x32_bf16 v[120:123], v[80:83], v[16:19], v[120:123]
    ds_read_b64_tr_b16 v[76:77], v8 offset:60512
    v_mfma_f32_16x16x32_bf16 v[160:163], v[80:83], v[20:23], v[160:163]
    ds_read_b64_tr_b16 v[78:79], v8 offset:65120
    v_mfma_f32_16x16x32_bf16 v[200:203], v[80:83], v[24:27], v[200:203]
    v_mfma_f32_16x16x32_bf16 v[240:243], v[80:83], v[28:31], v[240:243]
    v_mfma_f32_16x16x32_bf16 v[124:127], v[84:87], v[16:19], v[124:127]
    ds_read_b64_tr_b16 v[80:81], v252 offset:51200
    v_mfma_f32_16x16x32_bf16 v[164:167], v[84:87], v[20:23], v[164:167]
    ds_read_b64_tr_b16 v[82:83], v252 offset:55808
    v_mfma_f32_16x16x32_bf16 v[204:207], v[84:87], v[24:27], v[204:207]
    v_mfma_f32_16x16x32_bf16 v[244:247], v[84:87], v[28:31], v[244:247]
    ds_read_b64_tr_b16 v[84:85], v252 offset:60416
    ds_read_b64_tr_b16 v[86:87], v252 offset:65024
    s_waitcnt vmcnt(4)
    s_barrier
    s_waitcnt lgkmcnt(15)
    v_mfma_f32_16x16x32_bf16 v[88:91], v[48:51], v[32:35], v[88:91]
    s_add_u32 m0, s30, 0
    s_add_u32 s34, s31, 16384
    buffer_load_dwordx4 v10, s[16:19], s34 offen sc1 lds
    v_mfma_f32_16x16x32_bf16 v[128:131], v[48:51], v[36:39], v[128:131]
    ds_read_b128 v[16:19], v7 offset:0
    v_mfma_f32_16x16x32_bf16 v[168:171], v[48:51], v[40:43], v[168:171]
    s_add_u32 m0, s30, 1024
    s_add_u32 s34, s31, 34816
    buffer_load_dwordx4 v10, s[16:19], s34 offen sc1 lds
    v_mfma_f32_16x16x32_bf16 v[208:211], v[48:51], v[44:47], v[208:211]
    ds_read_b128 v[20:23], v7 offset:1024
    v_mfma_f32_16x16x32_bf16 v[92:95], v[52:55], v[32:35], v[92:95]
    s_add_u32 m0, s30, 2048
    s_add_u32 s34, s31, 53248
    buffer_load_dwordx4 v10, s[16:19], s34 offen sc1 lds
    v_mfma_f32_16x16x32_bf16 v[132:135], v[52:55], v[36:39], v[132:135]
    ds_read_b64_tr_b16 v[48:49], v9 offset:16384
    v_mfma_f32_16x16x32_bf16 v[172:175], v[52:55], v[40:43], v[172:175]
    s_add_u32 m0, s30, 3072
    s_add_u32 s34, s31, 71680
    buffer_load_dwordx4 v10, s[16:19], s34 offen sc1 lds
    v_mfma_f32_16x16x32_bf16 v[212:215], v[52:55], v[44:47], v[212:215]
    ds_read_b64_tr_b16 v[50:51], v9 offset:20992
    s_waitcnt lgkmcnt(15)
    v_mfma_f32_16x16x32_bf16 v[96:99], v[56:59], v[32:35], v[96:99]
    ds_read_b64_tr_b16 v[52:53], v9 offset:25600
    v_mfma_f32_16x16x32_bf16 v[136:139], v[56:59], v[36:39], v[136:139]
    ds_read_b64_tr_b16 v[54:55], v9 offset:30208
    v_mfma_f32_16x16x32_bf16 v[176:179], v[56:59], v[40:43], v[176:179]
    ds_read_b128 v[24:27], v7 offset:2048
    v_mfma_f32_16x16x32_bf16 v[216:219], v[56:59], v[44:47], v[216:219]
    ds_read_b128 v[28:31], v7 offset:3072
    v_mfma_f32_16x16x32_bf16 v[100:103], v[60:63], v[32:35], v[100:103]
    ds_read_b64_tr_b16 v[56:57], v9 offset:16416
    v_mfma_f32_16x16x32_bf16 v[140:143], v[60:63], v[36:39], v[140:143]
    ds_read_b64_tr_b16 v[58:59], v9 offset:21024
    v_mfma_f32_16x16x32_bf16 v[180:183], v[60:63], v[40:43], v[180:183]
    v_mfma_f32_16x16x32_bf16 v[220:223], v[60:63], v[44:47], v[220:223]
    s_waitcnt lgkmcnt(15)
    v_mfma_f32_16x16x32_bf16 v[104:107], v[64:67], v[32:35], v[104:107]
    ds_read_b64_tr_b16 v[60:61], v9 offset:25632
    v_mfma_f32_16x16x32_bf16 v[144:147], v[64:67], v[36:39], v[144:147]
    ds_read_b64_tr_b16 v[62:63], v9 offset:30240
    v_mfma_f32_16x16x32_bf16 v[184:187], v[64:67], v[40:43], v[184:187]
    v_mfma_f32_16x16x32_bf16 v[224:227], v[64:67], v[44:47], v[224:227]
    v_mfma_f32_16x16x32_bf16 v[108:111], v[68:71], v[32:35], v[108:111]
    ds_read_b64_tr_b16 v[64:65], v9 offset:16448
    v_mfma_f32_16x16x32_bf16 v[148:151], v[68:71], v[36:39], v[148:151]
    ds_read_b64_tr_b16 v[66:67], v9 offset:21056
    v_mfma_f32_16x16x32_bf16 v[188:191], v[68:71], v[40:43], v[188:191]
    v_mfma_f32_16x16x32_bf16 v[228:231], v[68:71], v[44:47], v[228:231]
    v_mfma_f32_16x16x32_bf16 v[112:115], v[72:75], v[32:35], v[112:115]
    ds_read_b64_tr_b16 v[68:69], v9 offset:25664
    v_mfma_f32_16x16x32_bf16 v[152:155], v[72:75], v[36:39], v[152:155]
    ds_read_b64_tr_b16 v[70:71], v9 offset:30272
    v_mfma_f32_16x16x32_bf16 v[192:195], v[72:75], v[40:43], v[192:195]
    v_mfma_f32_16x16x32_bf16 v[232:235], v[72:75], v[44:47], v[232:235]
    s_waitcnt lgkmcnt(15)
    v_mfma_f32_16x16x32_bf16 v[116:119], v[76:79], v[32:35], v[116:119]
    ds_read_b64_tr_b16 v[72:73], v9 offset:16480
    v_mfma_f32_16x16x32_bf16 v[156:159], v[76:79], v[36:39], v[156:159]
    ds_read_b64_tr_b16 v[74:75], v9 offset:21088
    v_mfma_f32_16x16x32_bf16 v[196:199], v[76:79], v[40:43], v[196:199]
    v_mfma_f32_16x16x32_bf16 v[236:239], v[76:79], v[44:47], v[236:239]
    v_mfma_f32_16x16x32_bf16 v[120:123], v[80:83], v[32:35], v[120:123]
    ds_read_b64_tr_b16 v[76:77], v9 offset:25696
    v_mfma_f32_16x16x32_bf16 v[160:163], v[80:83], v[36:39], v[160:163]
    ds_read_b64_tr_b16 v[78:79], v9 offset:30304
    v_mfma_f32_16x16x32_bf16 v[200:203], v[80:83], v[40:43], v[200:203]
    v_mfma_f32_16x16x32_bf16 v[240:243], v[80:83], v[44:47], v[240:243]
    v_mfma_f32_16x16x32_bf16 v[124:127], v[84:87], v[32:35], v[124:127]
    ds_read_b64_tr_b16 v[80:81], v253 offset:16384
    v_mfma_f32_16x16x32_bf16 v[164:167], v[84:87], v[36:39], v[164:167]
    ds_read_b64_tr_b16 v[82:83], v253 offset:20992
    v_mfma_f32_16x16x32_bf16 v[204:207], v[84:87], v[40:43], v[204:207]
    v_mfma_f32_16x16x32_bf16 v[244:247], v[84:87], v[44:47], v[244:247]
    ds_read_b64_tr_b16 v[84:85], v253 offset:25600
    ds_read_b64_tr_b16 v[86:87], v253 offset:30208
    s_waitcnt vmcnt(4)
    s_barrier
    s_waitcnt lgkmcnt(15)
    v_mfma_f32_16x16x32_bf16 v[88:91], v[48:51], v[16:19], v[88:91]
    s_add_u32 m0, s30, 34816
    s_add_u32 s34, s31, 17408
    buffer_load_dwordx4 v10, s[16:19], s34 offen sc1 lds
    v_mfma_f32_16x16x32_bf16 v[128:131], v[48:51], v[20:23], v[128:131]
    ds_read_b128 v[32:35], v7 offset:34816
    v_mfma_f32_16x16x32_bf16 v[168:171], v[48:51], v[24:27], v[168:171]
    s_add_u32 m0, s30, 35840
    s_add_u32 s34, s31, 35840
    buffer_load_dwordx4 v10, s[16:19], s34 offen sc1 lds
    v_mfma_f32_16x16x32_bf16 v[208:211], v[48:51], v[28:31], v[208:211]
    ds_read_b128 v[36:39], v7 offset:35840
    v_mfma_f32_16x16x32_bf16 v[92:95], v[52:55], v[16:19], v[92:95]
    s_add_u32 m0, s30, 36864
    s_add_u32 s34, s31, 54272
    buffer_load_dwordx4 v10, s[16:19], s34 offen sc1 lds
    v_mfma_f32_16x16x32_bf16 v[132:135], v[52:55], v[20:23], v[132:135]
    ds_read_b64_tr_b16 v[48:49], v9 offset:51200
    v_mfma_f32_16x16x32_bf16 v[172:175], v[52:55], v[24:27], v[172:175]
    s_add_u32 m0, s30, 37888
    s_add_u32 s34, s31, 72704
    buffer_load_dwordx4 v10, s[16:19], s34 offen sc1 lds
    v_mfma_f32_16x16x32_bf16 v[212:215], v[52:55], v[28:31], v[212:215]
    ds_read_b64_tr_b16 v[50:51], v9 offset:55808
    s_waitcnt lgkmcnt(15)
    v_mfma_f32_16x16x32_bf16 v[96:99], v[56:59], v[16:19], v[96:99]
    ds_read_b64_tr_b16 v[52:53], v9 offset:60416
    v_mfma_f32_16x16x32_bf16 v[136:139], v[56:59], v[20:23], v[136:139]
    ds_read_b64_tr_b16 v[54:55], v9 offset:65024
    v_mfma_f32_16x16x32_bf16 v[176:179], v[56:59], v[24:27], v[176:179]
    ds_read_b128 v[40:43], v7 offset:36864
    v_mfma_f32_16x16x32_bf16 v[216:219], v[56:59], v[28:31], v[216:219]
    ds_read_b128 v[44:47], v7 offset:37888
    v_mfma_f32_16x16x32_bf16 v[100:103], v[60:63], v[16:19], v[100:103]
    ds_read_b64_tr_b16 v[56:57], v9 offset:51232
    v_mfma_f32_16x16x32_bf16 v[140:143], v[60:63], v[20:23], v[140:143]
    ds_read_b64_tr_b16 v[58:59], v9 offset:55840
    v_mfma_f32_16x16x32_bf16 v[180:183], v[60:63], v[24:27], v[180:183]
    v_mfma_f32_16x16x32_bf16 v[220:223], v[60:63], v[28:31], v[220:223]
    s_waitcnt lgkmcnt(15)
    v_mfma_f32_16x16x32_bf16 v[104:107], v[64:67], v[16:19], v[104:107]
    ds_read_b64_tr_b16 v[60:61], v9 offset:60448
    v_mfma_f32_16x16x32_bf16 v[144:147], v[64:67], v[20:23], v[144:147]
    ds_read_b64_tr_b16 v[62:63], v9 offset:65056
    v_mfma_f32_16x16x32_bf16 v[184:187], v[64:67], v[24:27], v[184:187]
    v_mfma_f32_16x16x32_bf16 v[224:227], v[64:67], v[28:31], v[224:227]
    v_mfma_f32_16x16x32_bf16 v[108:111], v[68:71], v[16:19], v[108:111]
    ds_read_b64_tr_b16 v[64:65], v9 offset:51264
    v_mfma_f32_16x16x32_bf16 v[148:151], v[68:71], v[20:23], v[148:151]
    ds_read_b64_tr_b16 v[66:67], v9 offset:55872
    v_mfma_f32_16x16x32_bf16 v[188:191], v[68:71], v[24:27], v[188:191]
    v_mfma_f32_16x16x32_bf16 v[228:231], v[68:71], v[28:31], v[228:231]
    v_mfma_f32_16x16x32_bf16 v[112:115], v[72:75], v[16:19], v[112:115]
    ds_read_b64_tr_b16 v[68:69], v9 offset:60480
    v_mfma_f32_16x16x32_bf16 v[152:155], v[72:75], v[20:23], v[152:155]
    ds_read_b64_tr_b16 v[70:71], v9 offset:65088
    v_mfma_f32_16x16x32_bf16 v[192:195], v[72:75], v[24:27], v[192:195]
    v_mfma_f32_16x16x32_bf16 v[232:235], v[72:75], v[28:31], v[232:235]
    s_waitcnt lgkmcnt(15)
    v_mfma_f32_16x16x32_bf16 v[116:119], v[76:79], v[16:19], v[116:119]
    ds_read_b64_tr_b16 v[72:73], v9 offset:51296
    v_mfma_f32_16x16x32_bf16 v[156:159], v[76:79], v[20:23], v[156:159]
    ds_read_b64_tr_b16 v[74:75], v9 offset:55904
    v_mfma_f32_16x16x32_bf16 v[196:199], v[76:79], v[24:27], v[196:199]
    v_mfma_f32_16x16x32_bf16 v[236:239], v[76:79], v[28:31], v[236:239]
    v_mfma_f32_16x16x32_bf16 v[120:123], v[80:83], v[16:19], v[120:123]
    ds_read_b64_tr_b16 v[76:77], v9 offset:60512
    v_mfma_f32_16x16x32_bf16 v[160:163], v[80:83], v[20:23], v[160:163]
    ds_read_b64_tr_b16 v[78:79], v9 offset:65120
    v_mfma_f32_16x16x32_bf16 v[200:203], v[80:83], v[24:27], v[200:203]
    v_mfma_f32_16x16x32_bf16 v[240:243], v[80:83], v[28:31], v[240:243]
    v_mfma_f32_16x16x32_bf16 v[124:127], v[84:87], v[16:19], v[124:127]
    ds_read_b64_tr_b16 v[80:81], v253 offset:51200
    v_mfma_f32_16x16x32_bf16 v[164:167], v[84:87], v[20:23], v[164:167]
    ds_read_b64_tr_b16 v[82:83], v253 offset:55808
    v_mfma_f32_16x16x32_bf16 v[204:207], v[84:87], v[24:27], v[204:207]
    v_mfma_f32_16x16x32_bf16 v[244:247], v[84:87], v[28:31], v[244:247]
    ds_read_b64_tr_b16 v[84:85], v253 offset:60416
    ds_read_b64_tr_b16 v[86:87], v253 offset:65024
    s_waitcnt vmcnt(4)
    s_barrier
    s_waitcnt lgkmcnt(15)
    v_mfma_f32_16x16x32_bf16 v[88:91], v[48:51], v[32:35], v[88:91]
    ds_read_b128 v[16:19], v6 offset:0
    v_mfma_f32_16x16x32_bf16 v[128:131], v[48:51], v[36:39], v[128:131]
    ds_read_b128 v[20:23], v6 offset:1024
    v_mfma_f32_16x16x32_bf16 v[168:171], v[48:51], v[40:43], v[168:171]
    ds_read_b128 v[24:27], v6 offset:2048
    v_mfma_f32_16x16x32_bf16 v[208:211], v[48:51], v[44:47], v[208:211]
    ds_read_b128 v[28:31], v6 offset:3072
    v_mfma_f32_16x16x32_bf16 v[92:95], v[52:55], v[32:35], v[92:95]
    ds_read_b64_tr_b16 v[48:49], v8 offset:16384
    v_mfma_f32_16x16x32_bf16 v[132:135], v[52:55], v[36:39], v[132:135]
    ds_read_b64_tr_b16 v[50:51], v8 offset:20992
    v_mfma_f32_16x16x32_bf16 v[172:175], v[52:55], v[40:43], v[172:175]
    v_mfma_f32_16x16x32_bf16 v[212:215], v[52:55], v[44:47], v[212:215]
    s_waitcnt lgkmcnt(15)
    v_mfma_f32_16x16x32_bf16 v[96:99], v[56:59], v[32:35], v[96:99]
    ds_read_b64_tr_b16 v[52:53], v8 offset:25600
    v_mfma_f32_16x16x32_bf16 v[136:139], v[56:59], v[36:39], v[136:139]
    ds_read_b64_tr_b16 v[54:55], v8 offset:30208
    v_mfma_f32_16x16x32_bf16 v[176:179], v[56:59], v[40:43], v[176:179]
    v_mfma_f32_16x16x32_bf16 v[216:219], v[56:59], v[44:47], v[216:219]
    v_mfma_f32_16x16x32_bf16 v[100:103], v[60:63], v[32:35], v[100:103]
    ds_read_b64_tr_b16 v[56:57], v8 offset:16416
    v_mfma_f32_16x16x32_bf16 v[140:143], v[60:63], v[36:39], v[140:143]
    ds_read_b64_tr_b16 v[58:59], v8 offset:21024
    v_mfma_f32_16x16x32_bf16 v[180:183], v[60:63], v[40:43], v[180:183]
    v_mfma_f32_16x16x32_bf16 v[220:223], v[60:63], v[44:47], v[220:223]
    v_mfma_f32_16x16x32_bf16 v[104:107], v[64:67], v[32:35], v[104:107]
    ds_read_b64_tr_b16 v[60:61], v8 offset:25632
    v_mfma_f32_16x16x32_bf16 v[144:147], v[64:67], v[36:39], v[144:147]
    ds_read_b64_tr_b16 v[62:63], v8 offset:30240
    v_mfma_f32_16x16x32_bf16 v[184:187], v[64:67], v[40:43], v[184:187]
    v_mfma_f32_16x16x32_bf16 v[224:227], v[64:67], v[44:47], v[224:227]
    s_waitcnt lgkmcnt(15)
    v_mfma_f32_16x16x32_bf16 v[108:111], v[68:71], v[32:35], v[108:111]
    ds_read_b64_tr_b16 v[64:65], v8 offset:16448
    v_mfma_f32_16x16x32_bf16 v[148:151], v[68:71], v[36:39], v[148:151]
    ds_read_b64_tr_b16 v[66:67], v8 offset:21056
    v_mfma_f32_16x16x32_bf16 v[188:191], v[68:71], v[40:43], v[188:191]
    v_mfma_f32_16x16x32_bf16 v[228:231], v[68:71], v[44:47], v[228:231]
    v_mfma_f32_16x16x32_bf16 v[112:115], v[72:75], v[32:35], v[112:115]
    ds_read_b64_tr_b16 v[68:69], v8 offset:25664
    v_mfma_f32_16x16x32_bf16 v[152:155], v[72:75], v[36:39], v[152:155]
    ds_read_b64_tr_b16 v[70:71], v8 offset:30272
    v_mfma_f32_16x16x32_bf16 v[192:195], v[72:75], v[40:43], v[192:195]
    v_mfma_f32_16x16x32_bf16 v[232:235], v[72:75], v[44:47], v[232:235]
    v_mfma_f32_16x16x32_bf16 v[116:119], v[76:79], v[32:35], v[116:119]
    ds_read_b64_tr_b16 v[72:73], v8 offset:16480
    v_mfma_f32_16x16x32_bf16 v[156:159], v[76:79], v[36:39], v[156:159]
    ds_read_b64_tr_b16 v[74:75], v8 offset:21088
    v_mfma_f32_16x16x32_bf16 v[196:199], v[76:79], v[40:43], v[196:199]
    v_mfma_f32_16x16x32_bf16 v[236:239], v[76:79], v[44:47], v[236:239]
    s_waitcnt lgkmcnt(15)
    v_mfma_f32_16x16x32_bf16 v[120:123], v[80:83], v[32:35], v[120:123]
    ds_read_b64_tr_b16 v[76:77], v8 offset:25696
    v_mfma_f32_16x16x32_bf16 v[160:163], v[80:83], v[36:39], v[160:163]
    ds_read_b64_tr_b16 v[78:79], v8 offset:30304
    v_mfma_f32_16x16x32_bf16 v[200:203], v[80:83], v[40:43], v[200:203]
    v_mfma_f32_16x16x32_bf16 v[240:243], v[80:83], v[44:47], v[240:243]
    v_mfma_f32_16x16x32_bf16 v[124:127], v[84:87], v[32:35], v[124:127]
    ds_read_b64_tr_b16 v[80:81], v252 offset:16384
    v_mfma_f32_16x16x32_bf16 v[164:167], v[84:87], v[36:39], v[164:167]
    ds_read_b64_tr_b16 v[82:83], v252 offset:20992
    v_mfma_f32_16x16x32_bf16 v[204:207], v[84:87], v[40:43], v[204:207]
    v_mfma_f32_16x16x32_bf16 v[244:247], v[84:87], v[44:47], v[244:247]
    ds_read_b64_tr_b16 v[84:85], v252 offset:25600
    ds_read_b64_tr_b16 v[86:87], v252 offset:30208
    s_waitcnt vmcnt(0)
    s_barrier
    s_waitcnt lgkmcnt(15)
    v_mfma_f32_16x16x32_bf16 v[88:91], v[48:51], v[16:19], v[88:91]
    ds_read_b128 v[32:35], v6 offset:34816
    v_mfma_f32_16x16x32_bf16 v[128:131], v[48:51], v[20:23], v[128:131]
    ds_read_b128 v[36:39], v6 offset:35840
    v_mfma_f32_16x16x32_bf16 v[168:171], v[48:51], v[24:27], v[168:171]
    ds_read_b128 v[40:43], v6 offset:36864
    v_mfma_f32_16x16x32_bf16 v[208:211], v[48:51], v[28:31], v[208:211]
    ds_read_b128 v[44:47], v6 offset:37888
    v_mfma_f32_16x16x32_bf16 v[92:95], v[52:55], v[16:19], v[92:95]
    ds_read_b64_tr_b16 v[48:49], v8 offset:51200
    v_mfma_f32_16x16x32_bf16 v[132:135], v[52:55], v[20:23], v[132:135]
    ds_read_b64_tr_b16 v[50:51], v8 offset:55808
    v_mfma_f32_16x16x32_bf16 v[172:175], v[52:55], v[24:27], v[172:175]
    v_mfma_f32_16x16x32_bf16 v[212:215], v[52:55], v[28:31], v[212:215]
    s_waitcnt lgkmcnt(15)
    v_mfma_f32_16x16x32_bf16 v[96:99], v[56:59], v[16:19], v[96:99]
    ds_read_b64_tr_b16 v[52:53], v8 offset:60416
    v_mfma_f32_16x16x32_bf16 v[136:139], v[56:59], v[20:23], v[136:139]
    ds_read_b64_tr_b16 v[54:55], v8 offset:65024
    v_mfma_f32_16x16x32_bf16 v[176:179], v[56:59], v[24:27], v[176:179]
    v_mfma_f32_16x16x32_bf16 v[216:219], v[56:59], v[28:31], v[216:219]
    v_mfma_f32_16x16x32_bf16 v[100:103], v[60:63], v[16:19], v[100:103]
    ds_read_b64_tr_b16 v[56:57], v8 offset:51232
    v_mfma_f32_16x16x32_bf16 v[140:143], v[60:63], v[20:23], v[140:143]
    ds_read_b64_tr_b16 v[58:59], v8 offset:55840
    v_mfma_f32_16x16x32_bf16 v[180:183], v[60:63], v[24:27], v[180:183]
    v_mfma_f32_16x16x32_bf16 v[220:223], v[60:63], v[28:31], v[220:223]
    v_mfma_f32_16x16x32_bf16 v[104:107], v[64:67], v[16:19], v[104:107]
    ds_read_b64_tr_b16 v[60:61], v8 offset:60448
    v_mfma_f32_16x16x32_bf16 v[144:147], v[64:67], v[20:23], v[144:147]
    ds_read_b64_tr_b16 v[62:63], v8 offset:65056
    v_mfma_f32_16x16x32_bf16 v[184:187], v[64:67], v[24:27], v[184:187]
    v_mfma_f32_16x16x32_bf16 v[224:227], v[64:67], v[28:31], v[224:227]
    s_waitcnt lgkmcnt(15)
    v_mfma_f32_16x16x32_bf16 v[108:111], v[68:71], v[16:19], v[108:111]
    ds_read_b64_tr_b16 v[64:65], v8 offset:51264
    v_mfma_f32_16x16x32_bf16 v[148:151], v[68:71], v[20:23], v[148:151]
    ds_read_b64_tr_b16 v[66:67], v8 offset:55872
    v_mfma_f32_16x16x32_bf16 v[188:191], v[68:71], v[24:27], v[188:191]
    v_mfma_f32_16x16x32_bf16 v[228:231], v[68:71], v[28:31], v[228:231]
    v_mfma_f32_16x16x32_bf16 v[112:115], v[72:75], v[16:19], v[112:115]
    ds_read_b64_tr_b16 v[68:69], v8 offset:60480
    v_mfma_f32_16x16x32_bf16 v[152:155], v[72:75], v[20:23], v[152:155]
    ds_read_b64_tr_b16 v[70:71], v8 offset:65088
    v_mfma_f32_16x16x32_bf16 v[192:195], v[72:75], v[24:27], v[192:195]
    v_mfma_f32_16x16x32_bf16 v[232:235], v[72:75], v[28:31], v[232:235]
    v_mfma_f32_16x16x32_bf16 v[116:119], v[76:79], v[16:19], v[116:119]
    ds_read_b64_tr_b16 v[72:73], v8 offset:51296
    v_mfma_f32_16x16x32_bf16 v[156:159], v[76:79], v[20:23], v[156:159]
    ds_read_b64_tr_b16 v[74:75], v8 offset:55904
    v_mfma_f32_16x16x32_bf16 v[196:199], v[76:79], v[24:27], v[196:199]
    v_mfma_f32_16x16x32_bf16 v[236:239], v[76:79], v[28:31], v[236:239]
    s_waitcnt lgkmcnt(15)
    v_mfma_f32_16x16x32_bf16 v[120:123], v[80:83], v[16:19], v[120:123]
    ds_read_b64_tr_b16 v[76:77], v8 offset:60512
    v_mfma_f32_16x16x32_bf16 v[160:163], v[80:83], v[20:23], v[160:163]
    ds_read_b64_tr_b16 v[78:79], v8 offset:65120
    v_mfma_f32_16x16x32_bf16 v[200:203], v[80:83], v[24:27], v[200:203]
    v_mfma_f32_16x16x32_bf16 v[240:243], v[80:83], v[28:31], v[240:243]
    v_mfma_f32_16x16x32_bf16 v[124:127], v[84:87], v[16:19], v[124:127]
    ds_read_b64_tr_b16 v[80:81], v252 offset:51200
    v_mfma_f32_16x16x32_bf16 v[164:167], v[84:87], v[20:23], v[164:167]
    ds_read_b64_tr_b16 v[82:83], v252 offset:55808
    v_mfma_f32_16x16x32_bf16 v[204:207], v[84:87], v[24:27], v[204:207]
    v_mfma_f32_16x16x32_bf16 v[244:247], v[84:87], v[28:31], v[244:247]
    ds_read_b64_tr_b16 v[84:85], v252 offset:60416
    ds_read_b64_tr_b16 v[86:87], v252 offset:65024
    s_waitcnt lgkmcnt(15)
    v_mfma_f32_16x16x32_bf16 v[88:91], v[48:51], v[32:35], v[88:91]
    v_mfma_f32_16x16x32_bf16 v[128:131], v[48:51], v[36:39], v[128:131]
    v_mfma_f32_16x16x32_bf16 v[168:171], v[48:51], v[40:43], v[168:171]
    v_mfma_f32_16x16x32_bf16 v[208:211], v[48:51], v[44:47], v[208:211]
    v_mfma_f32_16x16x32_bf16 v[92:95], v[52:55], v[32:35], v[92:95]
    v_mfma_f32_16x16x32_bf16 v[132:135], v[52:55], v[36:39], v[132:135]
    v_mfma_f32_16x16x32_bf16 v[172:175], v[52:55], v[40:43], v[172:175]
    v_mfma_f32_16x16x32_bf16 v[212:215], v[52:55], v[44:47], v[212:215]
    s_waitcnt lgkmcnt(14)
    v_mfma_f32_16x16x32_bf16 v[96:99], v[56:59], v[32:35], v[96:99]
    v_mfma_f32_16x16x32_bf16 v[136:139], v[56:59], v[36:39], v[136:139]
    v_mfma_f32_16x16x32_bf16 v[176:179], v[56:59], v[40:43], v[176:179]
    v_mfma_f32_16x16x32_bf16 v[216:219], v[56:59], v[44:47], v[216:219]
    s_waitcnt lgkmcnt(12)
    v_mfma_f32_16x16x32_bf16 v[100:103], v[60:63], v[32:35], v[100:103]
    v_mfma_f32_16x16x32_bf16 v[140:143], v[60:63], v[36:39], v[140:143]
    v_mfma_f32_16x16x32_bf16 v[180:183], v[60:63], v[40:43], v[180:183]
    v_mfma_f32_16x16x32_bf16 v[220:223], v[60:63], v[44:47], v[220:223]
    s_waitcnt lgkmcnt(10)
    v_mfma_f32_16x16x32_bf16 v[104:107], v[64:67], v[32:35], v[104:107]
    v_mfma_f32_16x16x32_bf16 v[144:147], v[64:67], v[36:39], v[144:147]
    v_mfma_f32_16x16x32_bf16 v[184:187], v[64:67], v[40:43], v[184:187]
    v_mfma_f32_16x16x32_bf16 v[224:227], v[64:67], v[44:47], v[224:227]
    s_waitcnt lgkmcnt(8)
    v_mfma_f32_16x16x32_bf16 v[108:111], v[68:71], v[32:35], v[108:111]
    v_mfma_f32_16x16x32_bf16 v[148:151], v[68:71], v[36:39], v[148:151]
    v_mfma_f32_16x16x32_bf16 v[188:191], v[68:71], v[40:43], v[188:191]
    v_mfma_f32_16x16x32_bf16 v[228:231], v[68:71], v[44:47], v[228:231]
    s_waitcnt lgkmcnt(6)
    v_mfma_f32_16x16x32_bf16 v[112:115], v[72:75], v[32:35], v[112:115]
    v_mfma_f32_16x16x32_bf16 v[152:155], v[72:75], v[36:39], v[152:155]
    v_mfma_f32_16x16x32_bf16 v[192:195], v[72:75], v[40:43], v[192:195]
    v_mfma_f32_16x16x32_bf16 v[232:235], v[72:75], v[44:47], v[232:235]
    s_waitcnt lgkmcnt(4)
    v_mfma_f32_16x16x32_bf16 v[116:119], v[76:79], v[32:35], v[116:119]
    v_mfma_f32_16x16x32_bf16 v[156:159], v[76:79], v[36:39], v[156:159]
    v_mfma_f32_16x16x32_bf16 v[196:199], v[76:79], v[40:43], v[196:199]
    v_mfma_f32_16x16x32_bf16 v[236:239], v[76:79], v[44:47], v[236:239]
    s_waitcnt lgkmcnt(2)
    v_mfma_f32_16x16x32_bf16 v[120:123], v[80:83], v[32:35], v[120:123]
    v_mfma_f32_16x16x32_bf16 v[160:163], v[80:83], v[36:39], v[160:163]
    v_mfma_f32_16x16x32_bf16 v[200:203], v[80:83], v[40:43], v[200:203]
    v_mfma_f32_16x16x32_bf16 v[240:243], v[80:83], v[44:47], v[240:243]
    s_waitcnt lgkmcnt(0)
    v_mfma_f32_16x16x32_bf16 v[124:127], v[84:87], v[32:35], v[124:127]
    v_mfma_f32_16x16x32_bf16 v[164:167], v[84:87], v[36:39], v[164:167]
    v_mfma_f32_16x16x32_bf16 v[204:207], v[84:87], v[40:43], v[204:207]
    v_mfma_f32_16x16x32_bf16 v[244:247], v[84:87], v[44:47], v[244:247]
gemm1_kernel_epi0:
    s_lshl_b32 s14, s11, 4
    s_lshl_b32 s15, s13, 2
    s_add_u32 s14, s14, s15
    s_mul_i32 s35, s14, 147456
    s_mul_i32 s36, s10, 9
    s_add_u32 s39, s36, s44
    s_add_u32 s39, s39, 0
    s_lshl_b32 s39, s39, 9
    s_add_u32 s39, s39, s35
    s_xor_b32 s40, s44, 1
    s_lshl_b32 s40, s40, 3
    s_add_u32 s40, s40, s36
    s_lshr_b32 s40, s40, 1
    s_lshl_b32 s40, s40, 10
    s_lshl_b32 s41, s44, 3
    s_add_u32 s40, s40, s41
    s_add_u32 s40, s40, s35
    s_mov_b32 s42, 0xbfb8aa3b
    s_mov_b32 s43, 0xbfb8aa3b
    s_nop 7

    v_pk_mul_f32 v[16:17], v[88:89], s[42:43]
    v_pk_mul_f32 v[18:19], v[90:91], s[42:43]
    v_pk_mul_f32 v[20:21], v[96:97], s[42:43]
    v_pk_mul_f32 v[22:23], v[98:99], s[42:43]
    v_exp_f32 v16, v16
    v_exp_f32 v17, v17
    v_exp_f32 v18, v18
    v_exp_f32 v19, v19
    v_exp_f32 v20, v20
    v_exp_f32 v21, v21
    v_exp_f32 v22, v22
    v_exp_f32 v23, v23
    v_pk_mul_f32 v[88:89], v[88:89], v[92:93]
    v_pk_mul_f32 v[90:91], v[90:91], v[94:95]
    v_pk_mul_f32 v[96:97], v[96:97], v[100:101]
    v_pk_mul_f32 v[98:99], v[98:99], v[102:103]
    v_pk_add_f32 v[16:17], v[16:17], 1.0 op_sel_hi:[1,0]
    v_pk_add_f32 v[18:19], v[18:19], 1.0 op_sel_hi:[1,0]
    v_pk_add_f32 v[20:21], v[20:21], 1.0 op_sel_hi:[1,0]
    v_pk_add_f32 v[22:23], v[22:23], 1.0 op_sel_hi:[1,0]
    v_rcp_f32 v16, v16
    v_rcp_f32 v17, v17
    v_rcp_f32 v18, v18
    v_rcp_f32 v19, v19
    v_rcp_f32 v20, v20
    v_rcp_f32 v21, v21
    v_rcp_f32 v22, v22
    v_rcp_f32 v23, v23
    s_nop 0
    v_pk_mul_f32 v[16:17], v[88:89], v[16:17]
    v_pk_mul_f32 v[18:19], v[90:91], v[18:19]
    v_pk_mul_f32 v[20:21], v[96:97], v[20:21]
    v_pk_mul_f32 v[22:23], v[98:99], v[22:23]
    v_cvt_pk_bf16_f32 v24, v16, v17
    v_cvt_pk_bf16_f32 v25, v18, v19
    v_cvt_pk_bf16_f32 v26, v20, v21
    v_cvt_pk_bf16_f32 v27, v22, v23
    s_add_u32 s41, s39, 0
    buffer_store_dwordx4 v[24:27], v2, s[24:27], s41 offen
    v_pk_mul_f32 v[32:33], v[128:129], s[42:43]
    v_pk_mul_f32 v[34:35], v[130:131], s[42:43]
    v_pk_mul_f32 v[36:37], v[136:137], s[42:43]
    v_pk_mul_f32 v[38:39], v[138:139], s[42:43]
    v_exp_f32 v32, v32
    v_exp_f32 v33, v33
    v_exp_f32 v34, v34
    v_exp_f32 v35, v35
    v_exp_f32 v36, v36
    v_exp_f32 v37, v37
    v_exp_f32 v38, v38
    v_exp_f32 v39, v39
    v_pk_mul_f32 v[128:129], v[128:129], v[132:133]
    v_pk_mul_f32 v[130:131], v[130:131], v[134:135]
    v_pk_mul_f32 v[136:137], v[136:137], v[140:141]
    v_pk_mul_f32 v[138:139], v[138:139], v[142:143]
    v_pk_add_f32 v[32:33], v[32:33], 1.0 op_sel_hi:[1,0]
    v_pk_add_f32 v[34:35], v[34:35], 1.0 op_sel_hi:[1,0]
    v_pk_add_f32 v[36:37], v[36:37], 1.0 op_sel_hi:[1,0]
    v_pk_add_f32 v[38:39], v[38:39], 1.0 op_sel_hi:[1,0]
    v_rcp_f32 v32, v32
    v_rcp_f32 v33, v33
    v_rcp_f32 v34, v34
    v_rcp_f32 v35, v35
    v_rcp_f32 v36, v36
    v_rcp_f32 v37, v37
    v_rcp_f32 v38, v38
    v_rcp_f32 v39, v39
    s_nop 0
    v_pk_mul_f32 v[32:33], v[128:129], v[32:33]
    v_pk_mul_f32 v[34:35], v[130:131], v[34:35]
    v_pk_mul_f32 v[36:37], v[136:137], v[36:37]
    v_pk_mul_f32 v[38:39], v[138:139], v[38:39]
    v_cvt_pk_bf16_f32 v40, v32, v33
    v_cvt_pk_bf16_f32 v41, v34, v35
    v_cvt_pk_bf16_f32 v42, v36, v37
    v_cvt_pk_bf16_f32 v43, v38, v39
    s_add_u32 s41, s39, 147456
    buffer_store_dwordx4 v[40:43], v2, s[24:27], s41 offen
    v_pk_mul_f32 v[48:49], v[168:169], s[42:43]
    v_pk_mul_f32 v[50:51], v[170:171], s[42:43]
    v_pk_mul_f32 v[52:53], v[176:177], s[42:43]
    v_pk_mul_f32 v[54:55], v[178:179], s[42:43]
    v_exp_f32 v48, v48
    v_exp_f32 v49, v49
    v_exp_f32 v50, v50
    v_exp_f32 v51, v51
    v_exp_f32 v52, v52
    v_exp_f32 v53, v53
    v_exp_f32 v54, v54
    v_exp_f32 v55, v55
    v_pk_mul_f32 v[168:169], v[168:169], v[172:173]
    v_pk_mul_f32 v[170:171], v[170:171], v[174:175]
    v_pk_mul_f32 v[176:177], v[176:177], v[180:181]
    v_pk_mul_f32 v[178:179], v[178:179], v[182:183]
    v_pk_add_f32 v[48:49], v[48:49], 1.0 op_sel_hi:[1,0]
    v_pk_add_f32 v[50:51], v[50:51], 1.0 op_sel_hi:[1,0]
    v_pk_add_f32 v[52:53], v[52:53], 1.0 op_sel_hi:[1,0]
    v_pk_add_f32 v[54:55], v[54:55], 1.0 op_sel_hi:[1,0]
    v_rcp_f32 v48, v48
    v_rcp_f32 v49, v49
    v_rcp_f32 v50, v50
    v_rcp_f32 v51, v51
    v_rcp_f32 v52, v52
    v_rcp_f32 v53, v53
    v_rcp_f32 v54, v54
    v_rcp_f32 v55, v55
    s_nop 0
    v_pk_mul_f32 v[48:49], v[168:169], v[48:49]
    v_pk_mul_f32 v[50:51], v[170:171], v[50:51]
    v_pk_mul_f32 v[52:53], v[176:177], v[52:53]
    v_pk_mul_f32 v[54:55], v[178:179], v[54:55]
    v_cvt_pk_bf16_f32 v56, v48, v49
    v_cvt_pk_bf16_f32 v57, v50, v51
    v_cvt_pk_bf16_f32 v58, v52, v53
    v_cvt_pk_bf16_f32 v59, v54, v55
    s_add_u32 s41, s39, 294912
    buffer_store_dwordx4 v[56:59], v2, s[24:27], s41 offen
    v_pk_mul_f32 v[64:65], v[208:209], s[42:43]
    v_pk_mul_f32 v[66:67], v[210:211], s[42:43]
    v_pk_mul_f32 v[68:69], v[216:217], s[42:43]
    v_pk_mul_f32 v[70:71], v[218:219], s[42:43]
    v_exp_f32 v64, v64
    v_exp_f32 v65, v65
    v_exp_f32 v66, v66
    v_exp_f32 v67, v67
    v_exp_f32 v68, v68
    v_exp_f32 v69, v69
    v_exp_f32 v70, v70
    v_exp_f32 v71, v71
    v_pk_mul_f32 v[208:209], v[208:209], v[212:213]
    v_pk_mul_f32 v[210:211], v[210:211], v[214:215]
    v_pk_mul_f32 v[216:217], v[216:217], v[220:221]
    v_pk_mul_f32 v[218:219], v[218:219], v[222:223]
    v_pk_add_f32 v[64:65], v[64:65], 1.0 op_sel_hi:[1,0]
    v_pk_add_f32 v[66:67], v[66:67], 1.0 op_sel_hi:[1,0]
    v_pk_add_f32 v[68:69], v[68:69], 1.0 op_sel_hi:[1,0]
    v_pk_add_f32 v[70:71], v[70:71], 1.0 op_sel_hi:[1,0]
    v_rcp_f32 v64, v64
    v_rcp_f32 v65, v65
    v_rcp_f32 v66, v66
    v_rcp_f32 v67, v67
    v_rcp_f32 v68, v68
    v_rcp_f32 v69, v69
    v_rcp_f32 v70, v70
    v_rcp_f32 v71, v71
    s_nop 0
    v_pk_mul_f32 v[64:65], v[208:209], v[64:65]
    v_pk_mul_f32 v[66:67], v[210:211], v[66:67]
    v_pk_mul_f32 v[68:69], v[216:217], v[68:69]
    v_pk_mul_f32 v[70:71], v[218:219], v[70:71]
    v_cvt_pk_bf16_f32 v72, v64, v65
    v_cvt_pk_bf16_f32 v73, v66, v67
    v_cvt_pk_bf16_f32 v74, v68, v69
    v_cvt_pk_bf16_f32 v75, v70, v71
    s_add_u32 s41, s39, 442368
    buffer_store_dwordx4 v[72:75], v2, s[24:27], s41 offen
    v_pk_mul_f32 v[16:17], v[104:105], s[42:43]
    v_pk_mul_f32 v[18:19], v[106:107], s[42:43]
    v_pk_mul_f32 v[20:21], v[112:113], s[42:43]
    v_pk_mul_f32 v[22:23], v[114:115], s[42:43]
    v_exp_f32 v16, v16
    v_exp_f32 v17, v17
    v_exp_f32 v18, v18
    v_exp_f32 v19, v19
    v_exp_f32 v20, v20
    v_exp_f32 v21, v21
    v_exp_f32 v22, v22
    v_exp_f32 v23, v23
    v_pk_mul_f32 v[104:105], v[104:105], v[108:109]
    v_pk_mul_f32 v[106:107], v[106:107], v[110:111]
    v_pk_mul_f32 v[112:113], v[112:113], v[116:117]
    v_pk_mul_f32 v[114:115], v[114:115], v[118:119]
    v_pk_add_f32 v[16:17], v[16:17], 1.0 op_sel_hi:[1,0]
    v_pk_add_f32 v[18:19], v[18:19], 1.0 op_sel_hi:[1,0]
    v_pk_add_f32 v[20:21], v[20:21], 1.0 op_sel_hi:[1,0]
    v_pk_add_f32 v[22:23], v[22:23], 1.0 op_sel_hi:[1,0]
    v_rcp_f32 v16, v16
    v_rcp_f32 v17, v17
    v_rcp_f32 v18, v18
    v_rcp_f32 v19, v19
    v_rcp_f32 v20, v20
    v_rcp_f32 v21, v21
    v_rcp_f32 v22, v22
    v_rcp_f32 v23, v23
    s_nop 0
    v_pk_mul_f32 v[16:17], v[104:105], v[16:17]
    v_pk_mul_f32 v[18:19], v[106:107], v[18:19]
    v_pk_mul_f32 v[20:21], v[112:113], v[20:21]
    v_pk_mul_f32 v[22:23], v[114:115], v[22:23]
    v_cvt_pk_bf16_f32 v24, v16, v17
    v_cvt_pk_bf16_f32 v25, v18, v19
    v_cvt_pk_bf16_f32 v26, v20, v21
    v_cvt_pk_bf16_f32 v27, v22, v23
    s_add_u32 s41, s39, 1024
    buffer_store_dwordx4 v[24:27], v2, s[24:27], s41 offen
    v_pk_mul_f32 v[32:33], v[144:145], s[42:43]
    v_pk_mul_f32 v[34:35], v[146:147], s[42:43]
    v_pk_mul_f32 v[36:37], v[152:153], s[42:43]
    v_pk_mul_f32 v[38:39], v[154:155], s[42:43]
    v_exp_f32 v32, v32
    v_exp_f32 v33, v33
    v_exp_f32 v34, v34
    v_exp_f32 v35, v35
    v_exp_f32 v36, v36
    v_exp_f32 v37, v37
    v_exp_f32 v38, v38
    v_exp_f32 v39, v39
    v_pk_mul_f32 v[144:145], v[144:145], v[148:149]
    v_pk_mul_f32 v[146:147], v[146:147], v[150:151]
    v_pk_mul_f32 v[152:153], v[152:153], v[156:157]
    v_pk_mul_f32 v[154:155], v[154:155], v[158:159]
    v_pk_add_f32 v[32:33], v[32:33], 1.0 op_sel_hi:[1,0]
    v_pk_add_f32 v[34:35], v[34:35], 1.0 op_sel_hi:[1,0]
    v_pk_add_f32 v[36:37], v[36:37], 1.0 op_sel_hi:[1,0]
    v_pk_add_f32 v[38:39], v[38:39], 1.0 op_sel_hi:[1,0]
    v_rcp_f32 v32, v32
    v_rcp_f32 v33, v33
    v_rcp_f32 v34, v34
    v_rcp_f32 v35, v35
    v_rcp_f32 v36, v36
    v_rcp_f32 v37, v37
    v_rcp_f32 v38, v38
    v_rcp_f32 v39, v39
    s_nop 0
    v_pk_mul_f32 v[32:33], v[144:145], v[32:33]
    v_pk_mul_f32 v[34:35], v[146:147], v[34:35]
    v_pk_mul_f32 v[36:37], v[152:153], v[36:37]
    v_pk_mul_f32 v[38:39], v[154:155], v[38:39]
    v_cvt_pk_bf16_f32 v40, v32, v33
    v_cvt_pk_bf16_f32 v41, v34, v35
    v_cvt_pk_bf16_f32 v42, v36, v37
    v_cvt_pk_bf16_f32 v43, v38, v39
    s_add_u32 s41, s39, 148480
    buffer_store_dwordx4 v[40:43], v2, s[24:27], s41 offen
    v_pk_mul_f32 v[48:49], v[184:185], s[42:43]
    v_pk_mul_f32 v[50:51], v[186:187], s[42:43]
    v_pk_mul_f32 v[52:53], v[192:193], s[42:43]
    v_pk_mul_f32 v[54:55], v[194:195], s[42:43]
    v_exp_f32 v48, v48
    v_exp_f32 v49, v49
    v_exp_f32 v50, v50
    v_exp_f32 v51, v51
    v_exp_f32 v52, v52
    v_exp_f32 v53, v53
    v_exp_f32 v54, v54
    v_exp_f32 v55, v55
    v_pk_mul_f32 v[184:185], v[184:185], v[188:189]
    v_pk_mul_f32 v[186:187], v[186:187], v[190:191]
    v_pk_mul_f32 v[192:193], v[192:193], v[196:197]
    v_pk_mul_f32 v[194:195], v[194:195], v[198:199]
    v_pk_add_f32 v[48:49], v[48:49], 1.0 op_sel_hi:[1,0]
    v_pk_add_f32 v[50:51], v[50:51], 1.0 op_sel_hi:[1,0]
    v_pk_add_f32 v[52:53], v[52:53], 1.0 op_sel_hi:[1,0]
    v_pk_add_f32 v[54:55], v[54:55], 1.0 op_sel_hi:[1,0]
    v_rcp_f32 v48, v48
    v_rcp_f32 v49, v49
    v_rcp_f32 v50, v50
    v_rcp_f32 v51, v51
    v_rcp_f32 v52, v52
    v_rcp_f32 v53, v53
    v_rcp_f32 v54, v54
    v_rcp_f32 v55, v55
    s_nop 0
    v_pk_mul_f32 v[48:49], v[184:185], v[48:49]
    v_pk_mul_f32 v[50:51], v[186:187], v[50:51]
    v_pk_mul_f32 v[52:53], v[192:193], v[52:53]
    v_pk_mul_f32 v[54:55], v[194:195], v[54:55]
    v_cvt_pk_bf16_f32 v56, v48, v49
    v_cvt_pk_bf16_f32 v57, v50, v51
    v_cvt_pk_bf16_f32 v58, v52, v53
    v_cvt_pk_bf16_f32 v59, v54, v55
    s_add_u32 s41, s39, 295936
    buffer_store_dwordx4 v[56:59], v2, s[24:27], s41 offen
    v_pk_mul_f32 v[64:65], v[224:225], s[42:43]
    v_pk_mul_f32 v[66:67], v[226:227], s[42:43]
    v_pk_mul_f32 v[68:69], v[232:233], s[42:43]
    v_pk_mul_f32 v[70:71], v[234:235], s[42:43]
    v_exp_f32 v64, v64
    v_exp_f32 v65, v65
    v_exp_f32 v66, v66
    v_exp_f32 v67, v67
    v_exp_f32 v68, v68
    v_exp_f32 v69, v69
    v_exp_f32 v70, v70
    v_exp_f32 v71, v71
    v_pk_mul_f32 v[224:225], v[224:225], v[228:229]
    v_pk_mul_f32 v[226:227], v[226:227], v[230:231]
    v_pk_mul_f32 v[232:233], v[232:233], v[236:237]
    v_pk_mul_f32 v[234:235], v[234:235], v[238:239]
    v_pk_add_f32 v[64:65], v[64:65], 1.0 op_sel_hi:[1,0]
    v_pk_add_f32 v[66:67], v[66:67], 1.0 op_sel_hi:[1,0]
    v_pk_add_f32 v[68:69], v[68:69], 1.0 op_sel_hi:[1,0]
    v_pk_add_f32 v[70:71], v[70:71], 1.0 op_sel_hi:[1,0]
    v_rcp_f32 v64, v64
    v_rcp_f32 v65, v65
    v_rcp_f32 v66, v66
    v_rcp_f32 v67, v67
    v_rcp_f32 v68, v68
    v_rcp_f32 v69, v69
    v_rcp_f32 v70, v70
    v_rcp_f32 v71, v71
    s_nop 0
    v_pk_mul_f32 v[64:65], v[224:225], v[64:65]
    v_pk_mul_f32 v[66:67], v[226:227], v[66:67]
    v_pk_mul_f32 v[68:69], v[232:233], v[68:69]
    v_pk_mul_f32 v[70:71], v[234:235], v[70:71]
    v_cvt_pk_bf16_f32 v72, v64, v65
    v_cvt_pk_bf16_f32 v73, v66, v67
    v_cvt_pk_bf16_f32 v74, v68, v69
    v_cvt_pk_bf16_f32 v75, v70, v71
    s_add_u32 s41, s39, 443392
    buffer_store_dwordx4 v[72:75], v2, s[24:27], s41 offen
    v_pk_mul_f32 v[16:17], v[120:121], s[42:43]
    v_pk_mul_f32 v[18:19], v[122:123], s[42:43]
    v_pk_mul_f32 v[20:21], v[160:161], s[42:43]
    v_pk_mul_f32 v[22:23], v[162:163], s[42:43]
    v_exp_f32 v16, v16
    v_exp_f32 v17, v17
    v_exp_f32 v18, v18
    v_exp_f32 v19, v19
    v_exp_f32 v20, v20
    v_exp_f32 v21, v21
    v_exp_f32 v22, v22
    v_exp_f32 v23, v23
    v_pk_mul_f32 v[120:121], v[120:121], v[124:125]
    v_pk_mul_f32 v[122:123], v[122:123], v[126:127]
    v_pk_mul_f32 v[160:161], v[160:161], v[164:165]
    v_pk_mul_f32 v[162:163], v[162:163], v[166:167]
    v_pk_add_f32 v[16:17], v[16:17], 1.0 op_sel_hi:[1,0]
    v_pk_add_f32 v[18:19], v[18:19], 1.0 op_sel_hi:[1,0]
    v_pk_add_f32 v[20:21], v[20:21], 1.0 op_sel_hi:[1,0]
    v_pk_add_f32 v[22:23], v[22:23], 1.0 op_sel_hi:[1,0]
    v_rcp_f32 v16, v16
    v_rcp_f32 v17, v17
    v_rcp_f32 v18, v18
    v_rcp_f32 v19, v19
    v_rcp_f32 v20, v20
    v_rcp_f32 v21, v21
    v_rcp_f32 v22, v22
    v_rcp_f32 v23, v23
    s_nop 0
    v_pk_mul_f32 v[16:17], v[120:121], v[16:17]
    v_pk_mul_f32 v[18:19], v[122:123], v[18:19]
    v_pk_mul_f32 v[20:21], v[160:161], v[20:21]
    v_pk_mul_f32 v[22:23], v[162:163], v[22:23]
    v_cvt_pk_bf16_f32 v24, v16, v17
    v_cvt_pk_bf16_f32 v25, v18, v19
    v_cvt_pk_bf16_f32 v26, v20, v21
    v_cvt_pk_bf16_f32 v27, v22, v23
    s_add_u32 s41, s40, 0
    buffer_store_dwordx2 v[24:25], v2, s[24:27], s41 offen
    s_add_u32 s41, s40, 147456
    buffer_store_dwordx2 v[26:27], v2, s[24:27], s41 offen
    v_pk_mul_f32 v[32:33], v[200:201], s[42:43]
    v_pk_mul_f32 v[34:35], v[202:203], s[42:43]
    v_pk_mul_f32 v[36:37], v[240:241], s[42:43]
    v_pk_mul_f32 v[38:39], v[242:243], s[42:43]
    v_exp_f32 v32, v32
    v_exp_f32 v33, v33
    v_exp_f32 v34, v34
    v_exp_f32 v35, v35
    v_exp_f32 v36, v36
    v_exp_f32 v37, v37
    v_exp_f32 v38, v38
    v_exp_f32 v39, v39
    v_pk_mul_f32 v[200:201], v[200:201], v[204:205]
    v_pk_mul_f32 v[202:203], v[202:203], v[206:207]
    v_pk_mul_f32 v[240:241], v[240:241], v[244:245]
    v_pk_mul_f32 v[242:243], v[242:243], v[246:247]
    v_pk_add_f32 v[32:33], v[32:33], 1.0 op_sel_hi:[1,0]
    v_pk_add_f32 v[34:35], v[34:35], 1.0 op_sel_hi:[1,0]
    v_pk_add_f32 v[36:37], v[36:37], 1.0 op_sel_hi:[1,0]
    v_pk_add_f32 v[38:39], v[38:39], 1.0 op_sel_hi:[1,0]
    v_rcp_f32 v32, v32
    v_rcp_f32 v33, v33
    v_rcp_f32 v34, v34
    v_rcp_f32 v35, v35
    v_rcp_f32 v36, v36
    v_rcp_f32 v37, v37
    v_rcp_f32 v38, v38
    v_rcp_f32 v39, v39
    s_nop 0
    v_pk_mul_f32 v[32:33], v[200:201], v[32:33]
    v_pk_mul_f32 v[34:35], v[202:203], v[34:35]
    v_pk_mul_f32 v[36:37], v[240:241], v[36:37]
    v_pk_mul_f32 v[38:39], v[242:243], v[38:39]
    v_cvt_pk_bf16_f32 v40, v32, v33
    v_cvt_pk_bf16_f32 v41, v34, v35
    v_cvt_pk_bf16_f32 v42, v36, v37
    v_cvt_pk_bf16_f32 v43, v38, v39
    s_add_u32 s41, s40, 294912
    buffer_store_dwordx2 v[40:41], v2, s[24:27], s41 offen
    s_add_u32 s41, s40, 442368
    buffer_store_dwordx2 v[42:43], v2, s[24:27], s41 offen
    s_branch gemm1_kernel_end
gemm1_kernel_p1:
    s_and_b32 s14, s3, 1
    s_mul_i32 s15, s14, 147456
    s_mul_i32 s31, s10, 288
    s_add_u32 s15, s15, s31
    s_mov_b32 s32, 238609295
    s_lshr_b32 s33, s13, 1
    s_mul_i32 s30, s33, 9216
    s_mul_i32 s33, s14, 4608
    s_add_u32 s30, s30, s33
    s_add_u32 s30, s30, 16384

    v_add_u32 v4, 0, v1
    v_mul_hi_u32 v5, v4, s32
    v_mul_u32_u24 v15, 18, v5
    v_sub_u32 v4, v4, v15
    v_mul_u32_u24 v5, 9216, v5
    v_lshl_add_u32 v10, v4, 4, v5
    v_add_u32 v10, s15, v10

    v_add_u32 v4, 64, v1
    v_mul_hi_u32 v5, v4, s32
    v_mul_u32_u24 v15, 18, v5
    v_sub_u32 v4, v4, v15
    v_mul_u32_u24 v5, 9216, v5
    v_lshl_add_u32 v11, v4, 4, v5
    v_add_u32 v11, s15, v11

    v_add_u32 v4, 128, v1
    v_mul_hi_u32 v5, v4, s32
    v_mul_u32_u24 v15, 18, v5
    v_sub_u32 v4, v4, v15
    v_mul_u32_u24 v5, 9216, v5
    v_lshl_add_u32 v12, v4, 4, v5
    v_add_u32 v12, s15, v12

    v_add_u32 v4, 192, v1
    v_mul_hi_u32 v5, v4, s32
    v_mul_u32_u24 v15, 18, v5
    v_sub_u32 v4, v4, v15
    v_mul_u32_u24 v5, 9216, v5
    v_lshl_add_u32 v13, v4, 4, v5
    v_add_u32 v13, s15, v13

    v_add_u32 v4, 256, v1
    v_mul_hi_u32 v5, v4, s32
    v_mul_u32_u24 v15, 18, v5
    v_sub_u32 v4, v4, v15
    v_mul_u32_u24 v5, 9216, v5
    v_lshl_add_u32 v14, v4, 4, v5
    v_add_u32 v14, s15, v14

    s_waitcnt vmcnt(0) lgkmcnt(0)
    s_barrier
    s_add_u32 m0, s30, 0
    s_mov_b32 s34, 0
    buffer_load_dwordx4 v10, s[20:23], s34 offen lds
    s_add_u32 m0, s30, 1024
    s_mov_b32 s34, 0
    buffer_load_dwordx4 v11, s[20:23], s34 offen lds
    s_add_u32 m0, s30, 2048
    s_mov_b32 s34, 0
    buffer_load_dwordx4 v12, s[20:23], s34 offen lds
    s_add_u32 m0, s30, 3072
    s_mov_b32 s34, 0
    buffer_load_dwordx4 v13, s[20:23], s34 offen lds
    s_add_u32 m0, s30, 4096
    s_mov_b32 s34, 0
    s_mov_b64 exec, 0xffffffff
    buffer_load_dwordx4 v14, s[20:23], s34 offen lds
    s_mov_b64 exec, -1
    s_add_u32 m0, s30, 34816
    s_mov_b32 s34, 294912
    buffer_load_dwordx4 v10, s[20:23], s34 offen lds
    s_add_u32 m0, s30, 35840
    s_mov_b32 s34, 294912
    buffer_load_dwordx4 v11, s[20:23], s34 offen lds
    s_add_u32 m0, s30, 36864
    s_mov_b32 s34, 294912
    buffer_load_dwordx4 v12, s[20:23], s34 offen lds
    s_add_u32 m0, s30, 37888
    s_mov_b32 s34, 294912
    buffer_load_dwordx4 v13, s[20:23], s34 offen lds
    s_add_u32 m0, s30, 38912
    s_mov_b32 s34, 294912
    s_mov_b64 exec, 0xffffffff
    buffer_load_dwordx4 v14, s[20:23], s34 offen lds
    s_mov_b64 exec, -1
    s_add_u32 m0, s30, 69632
    s_mov_b32 s34, 589824
    buffer_load_dwordx4 v10, s[20:23], s34 offen lds
    s_add_u32 m0, s30, 70656
    s_mov_b32 s34, 589824
    buffer_load_dwordx4 v11, s[20:23], s34 offen lds
    s_add_u32 m0, s30, 71680
    s_mov_b32 s34, 589824
    buffer_load_dwordx4 v12, s[20:23], s34 offen lds
    s_add_u32 m0, s30, 72704
    s_mov_b32 s34, 589824
    buffer_load_dwordx4 v13, s[20:23], s34 offen lds
    s_add_u32 m0, s30, 73728
    s_mov_b32 s34, 589824
    s_mov_b64 exec, 0xffffffff
    buffer_load_dwordx4 v14, s[20:23], s34 offen lds
    s_mov_b64 exec, -1
    s_barrier
    v_mov_b32 v88, 0
    v_mov_b32 v89, 0
    v_mov_b32 v90, 0
    v_mov_b32 v91, 0
    v_mov_b32 v92, 0
    v_mov_b32 v93, 0
    v_mov_b32 v94, 0
    v_mov_b32 v95, 0
    v_mov_b32 v96, 0
    v_mov_b32 v97, 0
    v_mov_b32 v98, 0
    v_mov_b32 v99, 0
    v_mov_b32 v100, 0
    v_mov_b32 v101, 0
    v_mov_b32 v102, 0
    v_mov_b32 v103, 0
    v_mov_b32 v104, 0
    v_mov_b32 v105, 0
    v_mov_b32 v106, 0
    v_mov_b32 v107, 0
    v_mov_b32 v108, 0
    v_mov_b32 v109, 0
    v_mov_b32 v110, 0
    v_mov_b32 v111, 0
    v_mov_b32 v112, 0
    v_mov_b32 v113, 0
    v_mov_b32 v114, 0
    v_mov_b32 v115, 0
    v_mov_b32 v116, 0
    v_mov_b32 v117, 0
    v_mov_b32 v118, 0
    v_mov_b32 v119, 0
    v_mov_b32 v120, 0
    v_mov_b32 v121, 0
    v_mov_b32 v122, 0
    v_mov_b32 v123, 0
    v_mov_b32 v124, 0
    v_mov_b32 v125, 0
    v_mov_b32 v126, 0
    v_mov_b32 v127, 0
    v_mov_b32 v128, 0
    v_mov_b32 v129, 0
    v_mov_b32 v130, 0
    v_mov_b32 v131, 0
    v_mov_b32 v132, 0
    v_mov_b32 v133, 0
    v_mov_b32 v134, 0
    v_mov_b32 v135, 0
    v_mov_b32 v136, 0
    v_mov_b32 v137, 0
    v_mov_b32 v138, 0
    v_mov_b32 v139, 0
    v_mov_b32 v140, 0
    v_mov_b32 v141, 0
    v_mov_b32 v142, 0
    v_mov_b32 v143, 0
    v_mov_b32 v144, 0
    v_mov_b32 v145, 0
    v_mov_b32 v146, 0
    v_mov_b32 v147, 0
    v_mov_b32 v148, 0
    v_mov_b32 v149, 0
    v_mov_b32 v150, 0
    v_mov_b32 v151, 0
    v_mov_b32 v152, 0
    v_mov_b32 v153, 0
    v_mov_b32 v154, 0
    v_mov_b32 v155, 0
    v_mov_b32 v156, 0
    v_mov_b32 v157, 0
    v_mov_b32 v158, 0
    v_mov_b32 v159, 0
    v_mov_b32 v160, 0
    v_mov_b32 v161, 0
    v_mov_b32 v162, 0
    v_mov_b32 v163, 0
    v_mov_b32 v164, 0
    v_mov_b32 v165, 0
    v_mov_b32 v166, 0
    v_mov_b32 v167, 0
    v_mov_b32 v168, 0
    v_mov_b32 v169, 0
    v_mov_b32 v170, 0
    v_mov_b32 v171, 0
    v_mov_b32 v172, 0
    v_mov_b32 v173, 0
    v_mov_b32 v174, 0
    v_mov_b32 v175, 0
    v_mov_b32 v176, 0
    v_mov_b32 v177, 0
    v_mov_b32 v178, 0
    v_mov_b32 v179, 0
    v_mov_b32 v180, 0
    v_mov_b32 v181, 0
    v_mov_b32 v182, 0
    v_mov_b32 v183, 0
    v_mov_b32 v184, 0
    v_mov_b32 v185, 0
    v_mov_b32 v186, 0
    v_mov_b32 v187, 0
    v_mov_b32 v188, 0
    v_mov_b32 v189, 0
    v_mov_b32 v190, 0
    v_mov_b32 v191, 0
    v_mov_b32 v192, 0
    v_mov_b32 v193, 0
    v_mov_b32 v194, 0
    v_mov_b32 v195, 0
    v_mov_b32 v196, 0
    v_mov_b32 v197, 0
    v_mov_b32 v198, 0
    v_mov_b32 v199, 0
    v_mov_b32 v200, 0
    v_mov_b32 v201, 0
    v_mov_b32 v202, 0
    v_mov_b32 v203, 0
    v_mov_b32 v204, 0
    v_mov_b32 v205, 0
    v_mov_b32 v206, 0
    v_mov_b32 v207, 0
    v_mov_b32 v208, 0
    v_mov_b32 v209, 0
    v_mov_b32 v210, 0
    v_mov_b32 v211, 0
    v_mov_b32 v212, 0
    v_mov_b32 v213, 0
    v_mov_b32 v214, 0
    v_mov_b32 v215, 0
    s_waitcnt vmcnt(10)
    s_barrier
    ds_read_b128 v[16:19], v6 offset:0
    ds_read_b128 v[20:23], v6 offset:1024
    ds_read_b128 v[24:27], v6 offset:2048
    ds_read_b128 v[28:31], v6 offset:3072
    ds_read_b64_tr_b16 v[48:49], v8 offset:16384
    ds_read_b64_tr_b16 v[50:51], v8 offset:20992
    ds_read_b64_tr_b16 v[52:53], v8 offset:25600
    ds_read_b64_tr_b16 v[54:55], v8 offset:30208
    ds_read_b64_tr_b16 v[56:57], v8 offset:16416
    ds_read_b64_tr_b16 v[58:59], v8 offset:21024
    ds_read_b64_tr_b16 v[60:61], v8 offset:25632
    ds_read_b64_tr_b16 v[62:63], v8 offset:30240
    ds_read_b64_tr_b16 v[64:65], v8 offset:16448
    ds_read_b64_tr_b16 v[66:67], v8 offset:21056
    ds_read_b64_tr_b16 v[68:69], v8 offset:25664
    ds_read_b64_tr_b16 v[70:71], v8 offset:30272
    ds_read_b64_tr_b16 v[72:73], v8 offset:16480
    ds_read_b64_tr_b16 v[74:75], v8 offset:21088
    ds_read_b64_tr_b16 v[76:77], v8 offset:25696
    ds_read_b64_tr_b16 v[78:79], v8 offset:30304
    s_waitcnt vmcnt(5)
    s_barrier
    s_waitcnt lgkmcnt(14)
    v_mfma_f32_16x16x32_bf16 v[88:91], v[48:51], v[16:19], v[88:91]
    s_add_u32 m0, s30, 104448
    s_mov_b32 s34, 884736
    buffer_load_dwordx4 v10, s[20:23], s34 offen lds
    v_mfma_f32_16x16x32_bf16 v[120:123], v[48:51], v[20:23], v[120:123]
    ds_read_b128 v[32:35], v6 offset:34816
    v_mfma_f32_16x16x32_bf16 v[152:155], v[48:51], v[24:27], v[152:155]
    s_add_u32 m0, s30, 105472
    s_mov_b32 s34, 884736
    buffer_load_dwordx4 v11, s[20:23], s34 offen lds
    v_mfma_f32_16x16x32_bf16 v[184:187], v[48:51], v[28:31], v[184:187]
    ds_read_b128 v[36:39], v6 offset:35840
    s_waitcnt lgkmcnt(14)
    v_mfma_f32_16x16x32_bf16 v[92:95], v[52:55], v[16:19], v[92:95]
    s_add_u32 m0, s30, 106496
    s_mov_b32 s34, 884736
    buffer_load_dwordx4 v12, s[20:23], s34 offen lds
    v_mfma_f32_16x16x32_bf16 v[124:127], v[52:55], v[20:23], v[124:127]
    ds_read_b64_tr_b16 v[48:49], v8 offset:51200
    v_mfma_f32_16x16x32_bf16 v[156:159], v[52:55], v[24:27], v[156:159]
    s_add_u32 m0, s30, 107520
    s_mov_b32 s34, 884736
    buffer_load_dwordx4 v13, s[20:23], s34 offen lds
    v_mfma_f32_16x16x32_bf16 v[188:191], v[52:55], v[28:31], v[188:191]
    ds_read_b64_tr_b16 v[50:51], v8 offset:55808
    s_waitcnt lgkmcnt(14)
    v_mfma_f32_16x16x32_bf16 v[96:99], v[56:59], v[16:19], v[96:99]
    s_add_u32 m0, s30, 108544
    s_mov_b32 s34, 884736
    s_mov_b64 exec, 0xffffffff
    buffer_load_dwordx4 v14, s[20:23], s34 offen lds
    s_mov_b64 exec, -1
    v_mfma_f32_16x16x32_bf16 v[128:131], v[56:59], v[20:23], v[128:131]
    ds_read_b64_tr_b16 v[52:53], v8 offset:60416
    v_mfma_f32_16x16x32_bf16 v[160:163], v[56:59], v[24:27], v[160:163]
    ds_read_b64_tr_b16 v[54:55], v8 offset:65024
    v_mfma_f32_16x16x32_bf16 v[192:195], v[56:59], v[28:31], v[192:195]
    ds_read_b128 v[40:43], v6 offset:36864
    s_waitcnt lgkmcnt(15)
    v_mfma_f32_16x16x32_bf16 v[100:103], v[60:63], v[16:19], v[100:103]
    ds_read_b64_tr_b16 v[56:57], v8 offset:51232
    v_mfma_f32_16x16x32_bf16 v[132:135], v[60:63], v[20:23], v[132:135]
    ds_read_b64_tr_b16 v[58:59], v8 offset:55840
    v_mfma_f32_16x16x32_bf16 v[164:167], v[60:63], v[24:27], v[164:167]
    ds_read_b128 v[44:47], v6 offset:37888
    v_mfma_f32_16x16x32_bf16 v[196:199], v[60:63], v[28:31], v[196:199]
    s_waitcnt lgkmcnt(15)
    v_mfma_f32_16x16x32_bf16 v[104:107], v[64:67], v[16:19], v[104:107]
    ds_read_b64_tr_b16 v[60:61], v8 offset:60448
    v_mfma_f32_16x16x32_bf16 v[136:139], v[64:67], v[20:23], v[136:139]
    ds_read_b64_tr_b16 v[62:63], v8 offset:65056
    v_mfma_f32_16x16x32_bf16 v[168:171], v[64:67], v[24:27], v[168:171]
    v_mfma_f32_16x16x32_bf16 v[200:203], v[64:67], v[28:31], v[200:203]
    s_waitcnt lgkmcnt(15)
    v_mfma_f32_16x16x32_bf16 v[108:111], v[68:71], v[16:19], v[108:111]
    ds_read_b64_tr_b16 v[64:65], v8 offset:51264
    v_mfma_f32_16x16x32_bf16 v[140:143], v[68:71], v[20:23], v[140:143]
    ds_read_b64_tr_b16 v[66:67], v8 offset:55872
    v_mfma_f32_16x16x32_bf16 v[172:175], v[68:71], v[24:27], v[172:175]
    v_mfma_f32_16x16x32_bf16 v[204:207], v[68:71], v[28:31], v[204:207]
    s_waitcnt lgkmcnt(15)
    v_mfma_f32_16x16x32_bf16 v[112:115], v[72:75], v[16:19], v[112:115]
    ds_read_b64_tr_b16 v[68:69], v8 offset:60480
    v_mfma_f32_16x16x32_bf16 v[144:147], v[72:75], v[20:23], v[144:147]
    ds_read_b64_tr_b16 v[70:71], v8 offset:65088
    v_mfma_f32_16x16x32_bf16 v[176:179], v[72:75], v[24:27], v[176:179]
    v_mfma_f32_16x16x32_bf16 v[208:211], v[72:75], v[28:31], v[208:211]
    s_waitcnt lgkmcnt(15)
    v_mfma_f32_16x16x32_bf16 v[116:119], v[76:79], v[16:19], v[116:119]
    ds_read_b64_tr_b16 v[72:73], v8 offset:51296
    v_mfma_f32_16x16x32_bf16 v[148:151], v[76:79], v[20:23], v[148:151]
    ds_read_b64_tr_b16 v[74:75], v8 offset:55904
    v_mfma_f32_16x16x32_bf16 v[180:183], v[76:79], v[24:27], v[180:183]
    v_mfma_f32_16x16x32_bf16 v[212:215], v[76:79], v[28:31], v[212:215]
    ds_read_b64_tr_b16 v[76:77], v8 offset:60512
    ds_read_b64_tr_b16 v[78:79], v8 offset:65120
    s_waitcnt vmcnt(5)
    s_barrier
    s_waitcnt lgkmcnt(15)
    v_mfma_f32_16x16x32_bf16 v[88:91], v[48:51], v[32:35], v[88:91]
    s_add_u32 m0, s30, 0
    s_mov_b32 s34, 1179648
    buffer_load_dwordx4 v10, s[20:23], s34 offen lds
    v_mfma_f32_16x16x32_bf16 v[120:123], v[48:51], v[36:39], v[120:123]
    ds_read_b128 v[16:19], v7 offset:0
    s_waitcnt lgkmcnt(14)
    v_mfma_f32_16x16x32_bf16 v[152:155], v[48:51], v[40:43], v[152:155]
    s_add_u32 m0, s30, 1024
    s_mov_b32 s34, 1179648
    buffer_load_dwordx4 v11, s[20:23], s34 offen lds
    s_waitcnt lgkmcnt(11)
    v_mfma_f32_16x16x32_bf16 v[184:187], v[48:51], v[44:47], v[184:187]
    ds_read_b128 v[20:23], v7 offset:1024
    v_mfma_f32_16x16x32_bf16 v[92:95], v[52:55], v[32:35], v[92:95]
    s_add_u32 m0, s30, 2048
    s_mov_b32 s34, 1179648
    buffer_load_dwordx4 v12, s[20:23], s34 offen lds
    v_mfma_f32_16x16x32_bf16 v[124:127], v[52:55], v[36:39], v[124:127]
    ds_read_b64_tr_b16 v[48:49], v9 offset:16384
    v_mfma_f32_16x16x32_bf16 v[156:159], v[52:55], v[40:43], v[156:159]
    s_add_u32 m0, s30, 3072
    s_mov_b32 s34, 1179648
    buffer_load_dwordx4 v13, s[20:23], s34 offen lds
    v_mfma_f32_16x16x32_bf16 v[188:191], v[52:55], v[44:47], v[188:191]
    ds_read_b64_tr_b16 v[50:51], v9 offset:20992
    v_mfma_f32_16x16x32_bf16 v[96:99], v[56:59], v[32:35], v[96:99]
    s_add_u32 m0, s30, 4096
    s_mov_b32 s34, 1179648
    s_mov_b64 exec, 0xffffffff
    buffer_load_dwordx4 v14, s[20:23], s34 offen lds
    s_mov_b64 exec, -1
    v_mfma_f32_16x16x32_bf16 v[128:131], v[56:59], v[36:39], v[128:131]
    ds_read_b64_tr_b16 v[52:53], v9 offset:25600
    v_mfma_f32_16x16x32_bf16 v[160:163], v[56:59], v[40:43], v[160:163]
    ds_read_b64_tr_b16 v[54:55], v9 offset:30208
    v_mfma_f32_16x16x32_bf16 v[192:195], v[56:59], v[44:47], v[192:195]
    ds_read_b128 v[24:27], v7 offset:2048
    s_waitcnt lgkmcnt(15)
    v_mfma_f32_16x16x32_bf16 v[100:103], v[60:63], v[32:35], v[100:103]
    ds_read_b64_tr_b16 v[56:57], v9 offset:16416
    v_mfma_f32_16x16x32_bf16 v[132:135], v[60:63], v[36:39], v[132:135]
    ds_read_b64_tr_b16 v[58:59], v9 offset:21024
    v_mfma_f32_16x16x32_bf16 v[164:167], v[60:63], v[40:43], v[164:167]
    ds_read_b128 v[28:31], v7 offset:3072
    v_mfma_f32_16x16x32_bf16 v[196:199], v[60:63], v[44:47], v[196:199]
    s_waitcnt lgkmcnt(15)
    v_mfma_f32_16x16x32_bf16 v[104:107], v[64:67], v[32:35], v[104:107]
    ds_read_b64_tr_b16 v[60:61], v9 offset:25632
    v_mfma_f32_16x16x32_bf16 v[136:139], v[64:67], v[36:39], v[136:139]
    ds_read_b64_tr_b16 v[62:63], v9 offset:30240
    v_mfma_f32_16x16x32_bf16 v[168:171], v[64:67], v[40:43], v[168:171]
    v_mfma_f32_16x16x32_bf16 v[200:203], v[64:67], v[44:47], v[200:203]
    s_waitcnt lgkmcnt(15)
    v_mfma_f32_16x16x32_bf16 v[108:111], v[68:71], v[32:35], v[108:111]
    ds_read_b64_tr_b16 v[64:65], v9 offset:16448
    v_mfma_f32_16x16x32_bf16 v[140:143], v[68:71], v[36:39], v[140:143]
    ds_read_b64_tr_b16 v[66:67], v9 offset:21056
    v_mfma_f32_16x16x32_bf16 v[172:175], v[68:71], v[40:43], v[172:175]
    v_mfma_f32_16x16x32_bf16 v[204:207], v[68:71], v[44:47], v[204:207]
    s_waitcnt lgkmcnt(15)
    v_mfma_f32_16x16x32_bf16 v[112:115], v[72:75], v[32:35], v[112:115]
    ds_read_b64_tr_b16 v[68:69], v9 offset:25664
    v_mfma_f32_16x16x32_bf16 v[144:147], v[72:75], v[36:39], v[144:147]
    ds_read_b64_tr_b16 v[70:71], v9 offset:30272
    v_mfma_f32_16x16x32_bf16 v[176:179], v[72:75], v[40:43], v[176:179]
    v_mfma_f32_16x16x32_bf16 v[208:211], v[72:75], v[44:47], v[208:211]
    s_waitcnt lgkmcnt(15)
    v_mfma_f32_16x16x32_bf16 v[116:119], v[76:79], v[32:35], v[116:119]
    ds_read_b64_tr_b16 v[72:73], v9 offset:16480
    v_mfma_f32_16x16x32_bf16 v[148:151], v[76:79], v[36:39], v[148:151]
    ds_read_b64_tr_b16 v[74:75], v9 offset:21088
    v_mfma_f32_16x16x32_bf16 v[180:183], v[76:79], v[40:43], v[180:183]
    v_mfma_f32_16x16x32_bf16 v[212:215], v[76:79], v[44:47], v[212:215]
    ds_read_b64_tr_b16 v[76:77], v9 offset:25696
    ds_read_b64_tr_b16 v[78:79], v9 offset:30304
    s_waitcnt vmcnt(5)
    s_barrier
    s_waitcnt lgkmcnt(15)
    v_mfma_f32_16x16x32_bf16 v[88:91], v[48:51], v[16:19], v[88:91]
    s_add_u32 m0, s30, 34816
    s_mov_b32 s34, 1474560
    buffer_load_dwordx4 v10, s[20:23], s34 offen lds
    v_mfma_f32_16x16x32_bf16 v[120:123], v[48:51], v[20:23], v[120:123]
    ds_read_b128 v[32:35], v7 offset:34816
    s_waitcnt lgkmcnt(14)
    v_mfma_f32_16x16x32_bf16 v[152:155], v[48:51], v[24:27], v[152:155]
    s_add_u32 m0, s30, 35840
    s_mov_b32 s34, 1474560
    buffer_load_dwordx4 v11, s[20:23], s34 offen lds
    s_waitcnt lgkmcnt(11)
    v_mfma_f32_16x16x32_bf16 v[184:187], v[48:51], v[28:31], v[184:187]
    ds_read_b128 v[36:39], v7 offset:35840
    v_mfma_f32_16x16x32_bf16 v[92:95], v[52:55], v[16:19], v[92:95]
    s_add_u32 m0, s30, 36864
    s_mov_b32 s34, 1474560
    buffer_load_dwordx4 v12, s[20:23], s34 offen lds
    v_mfma_f32_16x16x32_bf16 v[124:127], v[52:55], v[20:23], v[124:127]
    ds_read_b64_tr_b16 v[48:49], v9 offset:51200
    v_mfma_f32_16x16x32_bf16 v[156:159], v[52:55], v[24:27], v[156:159]
    s_add_u32 m0, s30, 37888
    s_mov_b32 s34, 1474560
    buffer_load_dwordx4 v13, s[20:23], s34 offen lds
    v_mfma_f32_16x16x32_bf16 v[188:191], v[52:55], v[28:31], v[188:191]
    ds_read_b64_tr_b16 v[50:51], v9 offset:55808
    v_mfma_f32_16x16x32_bf16 v[96:99], v[56:59], v[16:19], v[96:99]
    s_add_u32 m0, s30, 38912
    s_mov_b32 s34, 1474560
    s_mov_b64 exec, 0xffffffff
    buffer_load_dwordx4 v14, s[20:23], s34 offen lds
    s_mov_b64 exec, -1
    v_mfma_f32_16x16x32_bf16 v[128:131], v[56:59], v[20:23], v[128:131]
    ds_read_b64_tr_b16 v[52:53], v9 offset:60416
    v_mfma_f32_16x16x32_bf16 v[160:163], v[56:59], v[24:27], v[160:163]
    ds_read_b64_tr_b16 v[54:55], v9 offset:65024
    v_mfma_f32_16x16x32_bf16 v[192:195], v[56:59], v[28:31], v[192:195]
    ds_read_b128 v[40:43], v7 offset:36864
    s_waitcnt lgkmcnt(15)
    v_mfma_f32_16x16x32_bf16 v[100:103], v[60:63], v[16:19], v[100:103]
    ds_read_b64_tr_b16 v[56:57], v9 offset:51232
    v_mfma_f32_16x16x32_bf16 v[132:135], v[60:63], v[20:23], v[132:135]
    ds_read_b64_tr_b16 v[58:59], v9 offset:55840
    v_mfma_f32_16x16x32_bf16 v[164:167], v[60:63], v[24:27], v[164:167]
    ds_read_b128 v[44:47], v7 offset:37888
    v_mfma_f32_16x16x32_bf16 v[196:199], v[60:63], v[28:31], v[196:199]
    s_waitcnt lgkmcnt(15)
    v_mfma_f32_16x16x32_bf16 v[104:107], v[64:67], v[16:19], v[104:107]
    ds_read_b64_tr_b16 v[60:61], v9 offset:60448
    v_mfma_f32_16x16x32_bf16 v[136:139], v[64:67], v[20:23], v[136:139]
    ds_read_b64_tr_b16 v[62:63], v9 offset:65056
    v_mfma_f32_16x16x32_bf16 v[168:171], v[64:67], v[24:27], v[168:171]
    v_mfma_f32_16x16x32_bf16 v[200:203], v[64:67], v[28:31], v[200:203]
    s_waitcnt lgkmcnt(15)
    v_mfma_f32_16x16x32_bf16 v[108:111], v[68:71], v[16:19], v[108:111]
    ds_read_b64_tr_b16 v[64:65], v9 offset:51264
    v_mfma_f32_16x16x32_bf16 v[140:143], v[68:71], v[20:23], v[140:143]
    ds_read_b64_tr_b16 v[66:67], v9 offset:55872
    v_mfma_f32_16x16x32_bf16 v[172:175], v[68:71], v[24:27], v[172:175]
    v_mfma_f32_16x16x32_bf16 v[204:207], v[68:71], v[28:31], v[204:207]
    s_waitcnt lgkmcnt(15)
    v_mfma_f32_16x16x32_bf16 v[112:115], v[72:75], v[16:19], v[112:115]
    ds_read_b64_tr_b16 v[68:69], v9 offset:60480
    v_mfma_f32_16x16x32_bf16 v[144:147], v[72:75], v[20:23], v[144:147]
    ds_read_b64_tr_b16 v[70:71], v9 offset:65088
    v_mfma_f32_16x16x32_bf16 v[176:179], v[72:75], v[24:27], v[176:179]
    v_mfma_f32_16x16x32_bf16 v[208:211], v[72:75], v[28:31], v[208:211]
    s_waitcnt lgkmcnt(15)
    v_mfma_f32_16x16x32_bf16 v[116:119], v[76:79], v[16:19], v[116:119]
    ds_read_b64_tr_b16 v[72:73], v9 offset:51296
    v_mfma_f32_16x16x32_bf16 v[148:151], v[76:79], v[20:23], v[148:151]
    ds_read_b64_tr_b16 v[74:75], v9 offset:55904
    v_mfma_f32_16x16x32_bf16 v[180:183], v[76:79], v[24:27], v[180:183]
    v_mfma_f32_16x16x32_bf16 v[212:215], v[76:79], v[28:31], v[212:215]
    ds_read_b64_tr_b16 v[76:77], v9 offset:60512
    ds_read_b64_tr_b16 v[78:79], v9 offset:65120
    s_waitcnt vmcnt(5)
    s_barrier
    s_waitcnt lgkmcnt(15)
    v_mfma_f32_16x16x32_bf16 v[88:91], v[48:51], v[32:35], v[88:91]
    s_add_u32 m0, s30, 69632
    s_mov_b32 s34, 1769472
    buffer_load_dwordx4 v10, s[20:23], s34 offen lds
    v_mfma_f32_16x16x32_bf16 v[120:123], v[48:51], v[36:39], v[120:123]
    ds_read_b128 v[16:19], v6 offset:0
    s_waitcnt lgkmcnt(14)
    v_mfma_f32_16x16x32_bf16 v[152:155], v[48:51], v[40:43], v[152:155]
    s_add_u32 m0, s30, 70656
    s_mov_b32 s34, 1769472
    buffer_load_dwordx4 v11, s[20:23], s34 offen lds
    s_waitcnt lgkmcnt(11)
    v_mfma_f32_16x16x32_bf16 v[184:187], v[48:51], v[44:47], v[184:187]
    ds_read_b128 v[20:23], v6 offset:1024
    v_mfma_f32_16x16x32_bf16 v[92:95], v[52:55], v[32:35], v[92:95]
    s_add_u32 m0, s30, 71680
    s_mov_b32 s34, 1769472
    buffer_load_dwordx4 v12, s[20:23], s34 offen lds
    v_mfma_f32_16x16x32_bf16 v[124:127], v[52:55], v[36:39], v[124:127]
    ds_read_b64_tr_b16 v[48:49], v8 offset:16384
    v_mfma_f32_16x16x32_bf16 v[156:159], v[52:55], v[40:43], v[156:159]
    s_add_u32 m0, s30, 72704
    s_mov_b32 s34, 1769472
    buffer_load_dwordx4 v13, s[20:23], s34 offen lds
    v_mfma_f32_16x16x32_bf16 v[188:191], v[52:55], v[44:47], v[188:191]
    ds_read_b64_tr_b16 v[50:51], v8 offset:20992
    v_mfma_f32_16x16x32_bf16 v[96:99], v[56:59], v[32:35], v[96:99]
    s_add_u32 m0, s30, 73728
    s_mov_b32 s34, 1769472
    s_mov_b64 exec, 0xffffffff
    buffer_load_dwordx4 v14, s[20:23], s34 offen lds
    s_mov_b64 exec, -1
    v_mfma_f32_16x16x32_bf16 v[128:131], v[56:59], v[36:39], v[128:131]
    ds_read_b64_tr_b16 v[52:53], v8 offset:25600
    v_mfma_f32_16x16x32_bf16 v[160:163], v[56:59], v[40:43], v[160:163]
    ds_read_b64_tr_b16 v[54:55], v8 offset:30208
    v_mfma_f32_16x16x32_bf16 v[192:195], v[56:59], v[44:47], v[192:195]
    ds_read_b128 v[24:27], v6 offset:2048
    s_waitcnt lgkmcnt(15)
    v_mfma_f32_16x16x32_bf16 v[100:103], v[60:63], v[32:35], v[100:103]
    ds_read_b64_tr_b16 v[56:57], v8 offset:16416
    v_mfma_f32_16x16x32_bf16 v[132:135], v[60:63], v[36:39], v[132:135]
    ds_read_b64_tr_b16 v[58:59], v8 offset:21024
    v_mfma_f32_16x16x32_bf16 v[164:167], v[60:63], v[40:43], v[164:167]
    ds_read_b128 v[28:31], v6 offset:3072
    v_mfma_f32_16x16x32_bf16 v[196:199], v[60:63], v[44:47], v[196:199]
    s_waitcnt lgkmcnt(15)
    v_mfma_f32_16x16x32_bf16 v[104:107], v[64:67], v[32:35], v[104:107]
    ds_read_b64_tr_b16 v[60:61], v8 offset:25632
    v_mfma_f32_16x16x32_bf16 v[136:139], v[64:67], v[36:39], v[136:139]
    ds_read_b64_tr_b16 v[62:63], v8 offset:30240
    v_mfma_f32_16x16x32_bf16 v[168:171], v[64:67], v[40:43], v[168:171]
    v_mfma_f32_16x16x32_bf16 v[200:203], v[64:67], v[44:47], v[200:203]
    s_waitcnt lgkmcnt(15)
    v_mfma_f32_16x16x32_bf16 v[108:111], v[68:71], v[32:35], v[108:111]
    ds_read_b64_tr_b16 v[64:65], v8 offset:16448
    v_mfma_f32_16x16x32_bf16 v[140:143], v[68:71], v[36:39], v[140:143]
    ds_read_b64_tr_b16 v[66:67], v8 offset:21056
    v_mfma_f32_16x16x32_bf16 v[172:175], v[68:71], v[40:43], v[172:175]
    v_mfma_f32_16x16x32_bf16 v[204:207], v[68:71], v[44:47], v[204:207]
    s_waitcnt lgkmcnt(15)
    v_mfma_f32_16x16x32_bf16 v[112:115], v[72:75], v[32:35], v[112:115]
    ds_read_b64_tr_b16 v[68:69], v8 offset:25664
    v_mfma_f32_16x16x32_bf16 v[144:147], v[72:75], v[36:39], v[144:147]
    ds_read_b64_tr_b16 v[70:71], v8 offset:30272
    v_mfma_f32_16x16x32_bf16 v[176:179], v[72:75], v[40:43], v[176:179]
    v_mfma_f32_16x16x32_bf16 v[208:211], v[72:75], v[44:47], v[208:211]
    s_waitcnt lgkmcnt(15)
    v_mfma_f32_16x16x32_bf16 v[116:119], v[76:79], v[32:35], v[116:119]
    ds_read_b64_tr_b16 v[72:73], v8 offset:16480
    v_mfma_f32_16x16x32_bf16 v[148:151], v[76:79], v[36:39], v[148:151]
    ds_read_b64_tr_b16 v[74:75], v8 offset:21088
    v_mfma_f32_16x16x32_bf16 v[180:183], v[76:79], v[40:43], v[180:183]
    v_mfma_f32_16x16x32_bf16 v[212:215], v[76:79], v[44:47], v[212:215]
    ds_read_b64_tr_b16 v[76:77], v8 offset:25696
    ds_read_b64_tr_b16 v[78:79], v8 offset:30304
    s_waitcnt vmcnt(5)
    s_barrier
    s_waitcnt lgkmcnt(15)
    v_mfma_f32_16x16x32_bf16 v[88:91], v[48:51], v[16:19], v[88:91]
    s_add_u32 m0, s30, 104448
    s_mov_b32 s34, 2064384
    buffer_load_dwordx4 v10, s[20:23], s34 offen lds
    v_mfma_f32_16x16x32_bf16 v[120:123], v[48:51], v[20:23], v[120:123]
    ds_read_b128 v[32:35], v6 offset:34816
    s_waitcnt lgkmcnt(14)
    v_mfma_f32_16x16x32_bf16 v[152:155], v[48:51], v[24:27], v[152:155]
    s_add_u32 m0, s30, 105472
    s_mov_b32 s34, 2064384
    buffer_load_dwordx4 v11, s[20:23], s34 offen lds
    s_waitcnt lgkmcnt(11)
    v_mfma_f32_16x16x32_bf16 v[184:187], v[48:51], v[28:31], v[184:187]
    ds_read_b128 v[36:39], v6 offset:35840
    v_mfma_f32_16x16x32_bf16 v[92:95], v[52:55], v[16:19], v[92:95]
    s_add_u32 m0, s30, 106496
    s_mov_b32 s34, 2064384
    buffer_load_dwordx4 v12, s[20:23], s34 offen lds
    v_mfma_f32_16x16x32_bf16 v[124:127], v[52:55], v[20:23], v[124:127]
    ds_read_b64_tr_b16 v[48:49], v8 offset:51200
    v_mfma_f32_16x16x32_bf16 v[156:159], v[52:55], v[24:27], v[156:159]
    s_add_u32 m0, s30, 107520
    s_mov_b32 s34, 2064384
    buffer_load_dwordx4 v13, s[20:23], s34 offen lds
    v_mfma_f32_16x16x32_bf16 v[188:191], v[52:55], v[28:31], v[188:191]
    ds_read_b64_tr_b16 v[50:51], v8 offset:55808
    v_mfma_f32_16x16x32_bf16 v[96:99], v[56:59], v[16:19], v[96:99]
    s_add_u32 m0, s30, 108544
    s_mov_b32 s34, 2064384
    s_mov_b64 exec, 0xffffffff
    buffer_load_dwordx4 v14, s[20:23], s34 offen lds
    s_mov_b64 exec, -1
    v_mfma_f32_16x16x32_bf16 v[128:131], v[56:59], v[20:23], v[128:131]
    ds_read_b64_tr_b16 v[52:53], v8 offset:60416
    v_mfma_f32_16x16x32_bf16 v[160:163], v[56:59], v[24:27], v[160:163]
    ds_read_b64_tr_b16 v[54:55], v8 offset:65024
    v_mfma_f32_16x16x32_bf16 v[192:195], v[56:59], v[28:31], v[192:195]
    ds_read_b128 v[40:43], v6 offset:36864
    s_waitcnt lgkmcnt(15)
    v_mfma_f32_16x16x32_bf16 v[100:103], v[60:63], v[16:19], v[100:103]
    ds_read_b64_tr_b16 v[56:57], v8 offset:51232
    v_mfma_f32_16x16x32_bf16 v[132:135], v[60:63], v[20:23], v[132:135]
    ds_read_b64_tr_b16 v[58:59], v8 offset:55840
    v_mfma_f32_16x16x32_bf16 v[164:167], v[60:63], v[24:27], v[164:167]
    ds_read_b128 v[44:47], v6 offset:37888
    v_mfma_f32_16x16x32_bf16 v[196:199], v[60:63], v[28:31], v[196:199]
    s_waitcnt lgkmcnt(15)
    v_mfma_f32_16x16x32_bf16 v[104:107], v[64:67], v[16:19], v[104:107]
    ds_read_b64_tr_b16 v[60:61], v8 offset:60448
    v_mfma_f32_16x16x32_bf16 v[136:139], v[64:67], v[20:23], v[136:139]
    ds_read_b64_tr_b16 v[62:63], v8 offset:65056
    v_mfma_f32_16x16x32_bf16 v[168:171], v[64:67], v[24:27], v[168:171]
    v_mfma_f32_16x16x32_bf16 v[200:203], v[64:67], v[28:31], v[200:203]
    s_waitcnt lgkmcnt(15)
    v_mfma_f32_16x16x32_bf16 v[108:111], v[68:71], v[16:19], v[108:111]
    ds_read_b64_tr_b16 v[64:65], v8 offset:51264
    v_mfma_f32_16x16x32_bf16 v[140:143], v[68:71], v[20:23], v[140:143]
    ds_read_b64_tr_b16 v[66:67], v8 offset:55872
    v_mfma_f32_16x16x32_bf16 v[172:175], v[68:71], v[24:27], v[172:175]
    v_mfma_f32_16x16x32_bf16 v[204:207], v[68:71], v[28:31], v[204:207]
    s_waitcnt lgkmcnt(15)
    v_mfma_f32_16x16x32_bf16 v[112:115], v[72:75], v[16:19], v[112:115]
    ds_read_b64_tr_b16 v[68:69], v8 offset:60480
    v_mfma_f32_16x16x32_bf16 v[144:147], v[72:75], v[20:23], v[144:147]
    ds_read_b64_tr_b16 v[70:71], v8 offset:65088
    v_mfma_f32_16x16x32_bf16 v[176:179], v[72:75], v[24:27], v[176:179]
    v_mfma_f32_16x16x32_bf16 v[208:211], v[72:75], v[28:31], v[208:211]
    s_waitcnt lgkmcnt(15)
    v_mfma_f32_16x16x32_bf16 v[116:119], v[76:79], v[16:19], v[116:119]
    ds_read_b64_tr_b16 v[72:73], v8 offset:51296
    v_mfma_f32_16x16x32_bf16 v[148:151], v[76:79], v[20:23], v[148:151]
    ds_read_b64_tr_b16 v[74:75], v8 offset:55904
    v_mfma_f32_16x16x32_bf16 v[180:183], v[76:79], v[24:27], v[180:183]
    v_mfma_f32_16x16x32_bf16 v[212:215], v[76:79], v[28:31], v[212:215]
    ds_read_b64_tr_b16 v[76:77], v8 offset:60512
    ds_read_b64_tr_b16 v[78:79], v8 offset:65120
    s_waitcnt vmcnt(5)
    s_barrier
    s_waitcnt lgkmcnt(15)
    v_mfma_f32_16x16x32_bf16 v[88:91], v[48:51], v[32:35], v[88:91]
    s_add_u32 m0, s30, 0
    s_mov_b32 s34, 2359296
    buffer_load_dwordx4 v10, s[20:23], s34 offen lds
    v_mfma_f32_16x16x32_bf16 v[120:123], v[48:51], v[36:39], v[120:123]
    ds_read_b128 v[16:19], v7 offset:0
    s_waitcnt lgkmcnt(14)
    v_mfma_f32_16x16x32_bf16 v[152:155], v[48:51], v[40:43], v[152:155]
    s_add_u32 m0, s30, 1024
    s_mov_b32 s34, 2359296
    buffer_load_dwordx4 v11, s[20:23], s34 offen lds
    s_waitcnt lgkmcnt(11)
    v_mfma_f32_16x16x32_bf16 v[184:187], v[48:51], v[44:47], v[184:187]
    ds_read_b128 v[20:23], v7 offset:1024
    v_mfma_f32_16x16x32_bf16 v[92:95], v[52:55], v[32:35], v[92:95]
    s_add_u32 m0, s30, 2048
    s_mov_b32 s34, 2359296
    buffer_load_dwordx4 v12, s[20:23], s34 offen lds
    v_mfma_f32_16x16x32_bf16 v[124:127], v[52:55], v[36:39], v[124:127]
    ds_read_b64_tr_b16 v[48:49], v9 offset:16384
    v_mfma_f32_16x16x32_bf16 v[156:159], v[52:55], v[40:43], v[156:159]
    s_add_u32 m0, s30, 3072
    s_mov_b32 s34, 2359296
    buffer_load_dwordx4 v13, s[20:23], s34 offen lds
    v_mfma_f32_16x16x32_bf16 v[188:191], v[52:55], v[44:47], v[188:191]
    ds_read_b64_tr_b16 v[50:51], v9 offset:20992
    v_mfma_f32_16x16x32_bf16 v[96:99], v[56:59], v[32:35], v[96:99]
    s_add_u32 m0, s30, 4096
    s_mov_b32 s34, 2359296
    s_mov_b64 exec, 0xffffffff
    buffer_load_dwordx4 v14, s[20:23], s34 offen lds
    s_mov_b64 exec, -1
    v_mfma_f32_16x16x32_bf16 v[128:131], v[56:59], v[36:39], v[128:131]
    ds_read_b64_tr_b16 v[52:53], v9 offset:25600
    v_mfma_f32_16x16x32_bf16 v[160:163], v[56:59], v[40:43], v[160:163]
    ds_read_b64_tr_b16 v[54:55], v9 offset:30208
    v_mfma_f32_16x16x32_bf16 v[192:195], v[56:59], v[44:47], v[192:195]
    ds_read_b128 v[24:27], v7 offset:2048
    s_waitcnt lgkmcnt(15)
    v_mfma_f32_16x16x32_bf16 v[100:103], v[60:63], v[32:35], v[100:103]
    ds_read_b64_tr_b16 v[56:57], v9 offset:16416
    v_mfma_f32_16x16x32_bf16 v[132:135], v[60:63], v[36:39], v[132:135]
    ds_read_b64_tr_b16 v[58:59], v9 offset:21024
    v_mfma_f32_16x16x32_bf16 v[164:167], v[60:63], v[40:43], v[164:167]
    ds_read_b128 v[28:31], v7 offset:3072
    v_mfma_f32_16x16x32_bf16 v[196:199], v[60:63], v[44:47], v[196:199]
    s_waitcnt lgkmcnt(15)
    v_mfma_f32_16x16x32_bf16 v[104:107], v[64:67], v[32:35], v[104:107]
    ds_read_b64_tr_b16 v[60:61], v9 offset:25632
    v_mfma_f32_16x16x32_bf16 v[136:139], v[64:67], v[36:39], v[136:139]
    ds_read_b64_tr_b16 v[62:63], v9 offset:30240
    v_mfma_f32_16x16x32_bf16 v[168:171], v[64:67], v[40:43], v[168:171]
    v_mfma_f32_16x16x32_bf16 v[200:203], v[64:67], v[44:47], v[200:203]
    s_waitcnt lgkmcnt(15)
    v_mfma_f32_16x16x32_bf16 v[108:111], v[68:71], v[32:35], v[108:111]
    ds_read_b64_tr_b16 v[64:65], v9 offset:16448
    v_mfma_f32_16x16x32_bf16 v[140:143], v[68:71], v[36:39], v[140:143]
    ds_read_b64_tr_b16 v[66:67], v9 offset:21056
    v_mfma_f32_16x16x32_bf16 v[172:175], v[68:71], v[40:43], v[172:175]
    v_mfma_f32_16x16x32_bf16 v[204:207], v[68:71], v[44:47], v[204:207]
    s_waitcnt lgkmcnt(15)
    v_mfma_f32_16x16x32_bf16 v[112:115], v[72:75], v[32:35], v[112:115]
    ds_read_b64_tr_b16 v[68:69], v9 offset:25664
    v_mfma_f32_16x16x32_bf16 v[144:147], v[72:75], v[36:39], v[144:147]
    ds_read_b64_tr_b16 v[70:71], v9 offset:30272
    v_mfma_f32_16x16x32_bf16 v[176:179], v[72:75], v[40:43], v[176:179]
    v_mfma_f32_16x16x32_bf16 v[208:211], v[72:75], v[44:47], v[208:211]
    s_waitcnt lgkmcnt(15)
    v_mfma_f32_16x16x32_bf16 v[116:119], v[76:79], v[32:35], v[116:119]
    ds_read_b64_tr_b16 v[72:73], v9 offset:16480
    v_mfma_f32_16x16x32_bf16 v[148:151], v[76:79], v[36:39], v[148:151]
    ds_read_b64_tr_b16 v[74:75], v9 offset:21088
    v_mfma_f32_16x16x32_bf16 v[180:183], v[76:79], v[40:43], v[180:183]
    v_mfma_f32_16x16x32_bf16 v[212:215], v[76:79], v[44:47], v[212:215]
    ds_read_b64_tr_b16 v[76:77], v9 offset:25696
    ds_read_b64_tr_b16 v[78:79], v9 offset:30304
    s_waitcnt vmcnt(5)
    s_barrier
    s_waitcnt lgkmcnt(15)
    v_mfma_f32_16x16x32_bf16 v[88:91], v[48:51], v[16:19], v[88:91]
    s_add_u32 m0, s30, 34816
    s_mov_b32 s34, 2654208
    buffer_load_dwordx4 v10, s[20:23], s34 offen lds
    v_mfma_f32_16x16x32_bf16 v[120:123], v[48:51], v[20:23], v[120:123]
    ds_read_b128 v[32:35], v7 offset:34816
    s_waitcnt lgkmcnt(14)
    v_mfma_f32_16x16x32_bf16 v[152:155], v[48:51], v[24:27], v[152:155]
    s_add_u32 m0, s30, 35840
    s_mov_b32 s34, 2654208
    buffer_load_dwordx4 v11, s[20:23], s34 offen lds
    s_waitcnt lgkmcnt(11)
    v_mfma_f32_16x16x32_bf16 v[184:187], v[48:51], v[28:31], v[184:187]
    ds_read_b128 v[36:39], v7 offset:35840
    v_mfma_f32_16x16x32_bf16 v[92:95], v[52:55], v[16:19], v[92:95]
    s_add_u32 m0, s30, 36864
    s_mov_b32 s34, 2654208
    buffer_load_dwordx4 v12, s[20:23], s34 offen lds
    v_mfma_f32_16x16x32_bf16 v[124:127], v[52:55], v[20:23], v[124:127]
    ds_read_b64_tr_b16 v[48:49], v9 offset:51200
    v_mfma_f32_16x16x32_bf16 v[156:159], v[52:55], v[24:27], v[156:159]
    s_add_u32 m0, s30, 37888
    s_mov_b32 s34, 2654208
    buffer_load_dwordx4 v13, s[20:23], s34 offen lds
    v_mfma_f32_16x16x32_bf16 v[188:191], v[52:55], v[28:31], v[188:191]
    ds_read_b64_tr_b16 v[50:51], v9 offset:55808
    v_mfma_f32_16x16x32_bf16 v[96:99], v[56:59], v[16:19], v[96:99]
    s_add_u32 m0, s30, 38912
    s_mov_b32 s34, 2654208
    s_mov_b64 exec, 0xffffffff
    buffer_load_dwordx4 v14, s[20:23], s34 offen lds
    s_mov_b64 exec, -1
    v_mfma_f32_16x16x32_bf16 v[128:131], v[56:59], v[20:23], v[128:131]
    ds_read_b64_tr_b16 v[52:53], v9 offset:60416
    v_mfma_f32_16x16x32_bf16 v[160:163], v[56:59], v[24:27], v[160:163]
    ds_read_b64_tr_b16 v[54:55], v9 offset:65024
    v_mfma_f32_16x16x32_bf16 v[192:195], v[56:59], v[28:31], v[192:195]
    ds_read_b128 v[40:43], v7 offset:36864
    s_waitcnt lgkmcnt(15)
    v_mfma_f32_16x16x32_bf16 v[100:103], v[60:63], v[16:19], v[100:103]
    ds_read_b64_tr_b16 v[56:57], v9 offset:51232
    v_mfma_f32_16x16x32_bf16 v[132:135], v[60:63], v[20:23], v[132:135]
    ds_read_b64_tr_b16 v[58:59], v9 offset:55840
    v_mfma_f32_16x16x32_bf16 v[164:167], v[60:63], v[24:27], v[164:167]
    ds_read_b128 v[44:47], v7 offset:37888
    v_mfma_f32_16x16x32_bf16 v[196:199], v[60:63], v[28:31], v[196:199]
    s_waitcnt lgkmcnt(15)
    v_mfma_f32_16x16x32_bf16 v[104:107], v[64:67], v[16:19], v[104:107]
    ds_read_b64_tr_b16 v[60:61], v9 offset:60448
    v_mfma_f32_16x16x32_bf16 v[136:139], v[64:67], v[20:23], v[136:139]
    ds_read_b64_tr_b16 v[62:63], v9 offset:65056
    v_mfma_f32_16x16x32_bf16 v[168:171], v[64:67], v[24:27], v[168:171]
    v_mfma_f32_16x16x32_bf16 v[200:203], v[64:67], v[28:31], v[200:203]
    s_waitcnt lgkmcnt(15)
    v_mfma_f32_16x16x32_bf16 v[108:111], v[68:71], v[16:19], v[108:111]
    ds_read_b64_tr_b16 v[64:65], v9 offset:51264
    v_mfma_f32_16x16x32_bf16 v[140:143], v[68:71], v[20:23], v[140:143]
    ds_read_b64_tr_b16 v[66:67], v9 offset:55872
    v_mfma_f32_16x16x32_bf16 v[172:175], v[68:71], v[24:27], v[172:175]
    v_mfma_f32_16x16x32_bf16 v[204:207], v[68:71], v[28:31], v[204:207]
    s_waitcnt lgkmcnt(15)
    v_mfma_f32_16x16x32_bf16 v[112:115], v[72:75], v[16:19], v[112:115]
    ds_read_b64_tr_b16 v[68:69], v9 offset:60480
    v_mfma_f32_16x16x32_bf16 v[144:147], v[72:75], v[20:23], v[144:147]
    ds_read_b64_tr_b16 v[70:71], v9 offset:65088
    v_mfma_f32_16x16x32_bf16 v[176:179], v[72:75], v[24:27], v[176:179]
    v_mfma_f32_16x16x32_bf16 v[208:211], v[72:75], v[28:31], v[208:211]
    s_waitcnt lgkmcnt(15)
    v_mfma_f32_16x16x32_bf16 v[116:119], v[76:79], v[16:19], v[116:119]
    ds_read_b64_tr_b16 v[72:73], v9 offset:51296
    v_mfma_f32_16x16x32_bf16 v[148:151], v[76:79], v[20:23], v[148:151]
    ds_read_b64_tr_b16 v[74:75], v9 offset:55904
    v_mfma_f32_16x16x32_bf16 v[180:183], v[76:79], v[24:27], v[180:183]
    v_mfma_f32_16x16x32_bf16 v[212:215], v[76:79], v[28:31], v[212:215]
    ds_read_b64_tr_b16 v[76:77], v9 offset:60512
    ds_read_b64_tr_b16 v[78:79], v9 offset:65120
    s_waitcnt vmcnt(5)
    s_barrier
    s_waitcnt lgkmcnt(15)
    v_mfma_f32_16x16x32_bf16 v[88:91], v[48:51], v[32:35], v[88:91]
    s_add_u32 m0, s30, 69632
    s_mov_b32 s34, 2949120
    buffer_load_dwordx4 v10, s[20:23], s34 offen lds
    v_mfma_f32_16x16x32_bf16 v[120:123], v[48:51], v[36:39], v[120:123]
    ds_read_b128 v[16:19], v6 offset:0
    s_waitcnt lgkmcnt(14)
    v_mfma_f32_16x16x32_bf16 v[152:155], v[48:51], v[40:43], v[152:155]
    s_add_u32 m0, s30, 70656
    s_mov_b32 s34, 2949120
    buffer_load_dwordx4 v11, s[20:23], s34 offen lds
    s_waitcnt lgkmcnt(11)
    v_mfma_f32_16x16x32_bf16 v[184:187], v[48:51], v[44:47], v[184:187]
    ds_read_b128 v[20:23], v6 offset:1024
    v_mfma_f32_16x16x32_bf16 v[92:95], v[52:55], v[32:35], v[92:95]
    s_add_u32 m0, s30, 71680
    s_mov_b32 s34, 2949120
    buffer_load_dwordx4 v12, s[20:23], s34 offen lds
    v_mfma_f32_16x16x32_bf16 v[124:127], v[52:55], v[36:39], v[124:127]
    ds_read_b64_tr_b16 v[48:49], v8 offset:16384
    v_mfma_f32_16x16x32_bf16 v[156:159], v[52:55], v[40:43], v[156:159]
    s_add_u32 m0, s30, 72704
    s_mov_b32 s34, 2949120
    buffer_load_dwordx4 v13, s[20:23], s34 offen lds
    v_mfma_f32_16x16x32_bf16 v[188:191], v[52:55], v[44:47], v[188:191]
    ds_read_b64_tr_b16 v[50:51], v8 offset:20992
    v_mfma_f32_16x16x32_bf16 v[96:99], v[56:59], v[32:35], v[96:99]
    s_add_u32 m0, s30, 73728
    s_mov_b32 s34, 2949120
    s_mov_b64 exec, 0xffffffff
    buffer_load_dwordx4 v14, s[20:23], s34 offen lds
    s_mov_b64 exec, -1
    v_mfma_f32_16x16x32_bf16 v[128:131], v[56:59], v[36:39], v[128:131]
    ds_read_b64_tr_b16 v[52:53], v8 offset:25600
    v_mfma_f32_16x16x32_bf16 v[160:163], v[56:59], v[40:43], v[160:163]
    ds_read_b64_tr_b16 v[54:55], v8 offset:30208
    v_mfma_f32_16x16x32_bf16 v[192:195], v[56:59], v[44:47], v[192:195]
    ds_read_b128 v[24:27], v6 offset:2048
    s_waitcnt lgkmcnt(15)
    v_mfma_f32_16x16x32_bf16 v[100:103], v[60:63], v[32:35], v[100:103]
    ds_read_b64_tr_b16 v[56:57], v8 offset:16416
    v_mfma_f32_16x16x32_bf16 v[132:135], v[60:63], v[36:39], v[132:135]
    ds_read_b64_tr_b16 v[58:59], v8 offset:21024
    v_mfma_f32_16x16x32_bf16 v[164:167], v[60:63], v[40:43], v[164:167]
    ds_read_b128 v[28:31], v6 offset:3072
    v_mfma_f32_16x16x32_bf16 v[196:199], v[60:63], v[44:47], v[196:199]
    s_waitcnt lgkmcnt(15)
    v_mfma_f32_16x16x32_bf16 v[104:107], v[64:67], v[32:35], v[104:107]
    ds_read_b64_tr_b16 v[60:61], v8 offset:25632
    v_mfma_f32_16x16x32_bf16 v[136:139], v[64:67], v[36:39], v[136:139]
    ds_read_b64_tr_b16 v[62:63], v8 offset:30240
    v_mfma_f32_16x16x32_bf16 v[168:171], v[64:67], v[40:43], v[168:171]
    v_mfma_f32_16x16x32_bf16 v[200:203], v[64:67], v[44:47], v[200:203]
    s_waitcnt lgkmcnt(15)
    v_mfma_f32_16x16x32_bf16 v[108:111], v[68:71], v[32:35], v[108:111]
    ds_read_b64_tr_b16 v[64:65], v8 offset:16448
    v_mfma_f32_16x16x32_bf16 v[140:143], v[68:71], v[36:39], v[140:143]
    ds_read_b64_tr_b16 v[66:67], v8 offset:21056
    v_mfma_f32_16x16x32_bf16 v[172:175], v[68:71], v[40:43], v[172:175]
    v_mfma_f32_16x16x32_bf16 v[204:207], v[68:71], v[44:47], v[204:207]
    s_waitcnt lgkmcnt(15)
    v_mfma_f32_16x16x32_bf16 v[112:115], v[72:75], v[32:35], v[112:115]
    ds_read_b64_tr_b16 v[68:69], v8 offset:25664
    v_mfma_f32_16x16x32_bf16 v[144:147], v[72:75], v[36:39], v[144:147]
    ds_read_b64_tr_b16 v[70:71], v8 offset:30272
    v_mfma_f32_16x16x32_bf16 v[176:179], v[72:75], v[40:43], v[176:179]
    v_mfma_f32_16x16x32_bf16 v[208:211], v[72:75], v[44:47], v[208:211]
    s_waitcnt lgkmcnt(15)
    v_mfma_f32_16x16x32_bf16 v[116:119], v[76:79], v[32:35], v[116:119]
    ds_read_b64_tr_b16 v[72:73], v8 offset:16480
    v_mfma_f32_16x16x32_bf16 v[148:151], v[76:79], v[36:39], v[148:151]
    ds_read_b64_tr_b16 v[74:75], v8 offset:21088
    v_mfma_f32_16x16x32_bf16 v[180:183], v[76:79], v[40:43], v[180:183]
    v_mfma_f32_16x16x32_bf16 v[212:215], v[76:79], v[44:47], v[212:215]
    ds_read_b64_tr_b16 v[76:77], v8 offset:25696
    ds_read_b64_tr_b16 v[78:79], v8 offset:30304
    s_waitcnt vmcnt(5)
    s_barrier
    s_waitcnt lgkmcnt(15)
    v_mfma_f32_16x16x32_bf16 v[88:91], v[48:51], v[16:19], v[88:91]
    s_add_u32 m0, s30, 104448
    s_mov_b32 s34, 3244032
    buffer_load_dwordx4 v10, s[20:23], s34 offen lds
    v_mfma_f32_16x16x32_bf16 v[120:123], v[48:51], v[20:23], v[120:123]
    ds_read_b128 v[32:35], v6 offset:34816
    s_waitcnt lgkmcnt(14)
    v_mfma_f32_16x16x32_bf16 v[152:155], v[48:51], v[24:27], v[152:155]
    s_add_u32 m0, s30, 105472
    s_mov_b32 s34, 3244032
    buffer_load_dwordx4 v11, s[20:23], s34 offen lds
    s_waitcnt lgkmcnt(11)
    v_mfma_f32_16x16x32_bf16 v[184:187], v[48:51], v[28:31], v[184:187]
    ds_read_b128 v[36:39], v6 offset:35840
    v_mfma_f32_16x16x32_bf16 v[92:95], v[52:55], v[16:19], v[92:95]
    s_add_u32 m0, s30, 106496
    s_mov_b32 s34, 3244032
    buffer_load_dwordx4 v12, s[20:23], s34 offen lds
    v_mfma_f32_16x16x32_bf16 v[124:127], v[52:55], v[20:23], v[124:127]
    ds_read_b64_tr_b16 v[48:49], v8 offset:51200
    v_mfma_f32_16x16x32_bf16 v[156:159], v[52:55], v[24:27], v[156:159]
    s_add_u32 m0, s30, 107520
    s_mov_b32 s34, 3244032
    buffer_load_dwordx4 v13, s[20:23], s34 offen lds
    v_mfma_f32_16x16x32_bf16 v[188:191], v[52:55], v[28:31], v[188:191]
    ds_read_b64_tr_b16 v[50:51], v8 offset:55808
    v_mfma_f32_16x16x32_bf16 v[96:99], v[56:59], v[16:19], v[96:99]
    s_add_u32 m0, s30, 108544
    s_mov_b32 s34, 3244032
    s_mov_b64 exec, 0xffffffff
    buffer_load_dwordx4 v14, s[20:23], s34 offen lds
    s_mov_b64 exec, -1
    v_mfma_f32_16x16x32_bf16 v[128:131], v[56:59], v[20:23], v[128:131]
    ds_read_b64_tr_b16 v[52:53], v8 offset:60416
    v_mfma_f32_16x16x32_bf16 v[160:163], v[56:59], v[24:27], v[160:163]
    ds_read_b64_tr_b16 v[54:55], v8 offset:65024
    v_mfma_f32_16x16x32_bf16 v[192:195], v[56:59], v[28:31], v[192:195]
    ds_read_b128 v[40:43], v6 offset:36864
    s_waitcnt lgkmcnt(15)
    v_mfma_f32_16x16x32_bf16 v[100:103], v[60:63], v[16:19], v[100:103]
    ds_read_b64_tr_b16 v[56:57], v8 offset:51232
    v_mfma_f32_16x16x32_bf16 v[132:135], v[60:63], v[20:23], v[132:135]
    ds_read_b64_tr_b16 v[58:59], v8 offset:55840
    v_mfma_f32_16x16x32_bf16 v[164:167], v[60:63], v[24:27], v[164:167]
    ds_read_b128 v[44:47], v6 offset:37888
    v_mfma_f32_16x16x32_bf16 v[196:199], v[60:63], v[28:31], v[196:199]
    s_waitcnt lgkmcnt(15)
    v_mfma_f32_16x16x32_bf16 v[104:107], v[64:67], v[16:19], v[104:107]
    ds_read_b64_tr_b16 v[60:61], v8 offset:60448
    v_mfma_f32_16x16x32_bf16 v[136:139], v[64:67], v[20:23], v[136:139]
    ds_read_b64_tr_b16 v[62:63], v8 offset:65056
    v_mfma_f32_16x16x32_bf16 v[168:171], v[64:67], v[24:27], v[168:171]
    v_mfma_f32_16x16x32_bf16 v[200:203], v[64:67], v[28:31], v[200:203]
    s_waitcnt lgkmcnt(15)
    v_mfma_f32_16x16x32_bf16 v[108:111], v[68:71], v[16:19], v[108:111]
    ds_read_b64_tr_b16 v[64:65], v8 offset:51264
    v_mfma_f32_16x16x32_bf16 v[140:143], v[68:71], v[20:23], v[140:143]
    ds_read_b64_tr_b16 v[66:67], v8 offset:55872
    v_mfma_f32_16x16x32_bf16 v[172:175], v[68:71], v[24:27], v[172:175]
    v_mfma_f32_16x16x32_bf16 v[204:207], v[68:71], v[28:31], v[204:207]
    s_waitcnt lgkmcnt(15)
    v_mfma_f32_16x16x32_bf16 v[112:115], v[72:75], v[16:19], v[112:115]
    ds_read_b64_tr_b16 v[68:69], v8 offset:60480
    v_mfma_f32_16x16x32_bf16 v[144:147], v[72:75], v[20:23], v[144:147]
    ds_read_b64_tr_b16 v[70:71], v8 offset:65088
    v_mfma_f32_16x16x32_bf16 v[176:179], v[72:75], v[24:27], v[176:179]
    v_mfma_f32_16x16x32_bf16 v[208:211], v[72:75], v[28:31], v[208:211]
    s_waitcnt lgkmcnt(15)
    v_mfma_f32_16x16x32_bf16 v[116:119], v[76:79], v[16:19], v[116:119]
    ds_read_b64_tr_b16 v[72:73], v8 offset:51296
    v_mfma_f32_16x16x32_bf16 v[148:151], v[76:79], v[20:23], v[148:151]
    ds_read_b64_tr_b16 v[74:75], v8 offset:55904
    v_mfma_f32_16x16x32_bf16 v[180:183], v[76:79], v[24:27], v[180:183]
    v_mfma_f32_16x16x32_bf16 v[212:215], v[76:79], v[28:31], v[212:215]
    ds_read_b64_tr_b16 v[76:77], v8 offset:60512
    ds_read_b64_tr_b16 v[78:79], v8 offset:65120
    s_waitcnt vmcnt(5)
    s_barrier
    s_waitcnt lgkmcnt(15)
    v_mfma_f32_16x16x32_bf16 v[88:91], v[48:51], v[32:35], v[88:91]
    s_add_u32 m0, s30, 0
    s_mov_b32 s34, 3538944
    buffer_load_dwordx4 v10, s[20:23], s34 offen lds
    v_mfma_f32_16x16x32_bf16 v[120:123], v[48:51], v[36:39], v[120:123]
    ds_read_b128 v[16:19], v7 offset:0
    s_waitcnt lgkmcnt(14)
    v_mfma_f32_16x16x32_bf16 v[152:155], v[48:51], v[40:43], v[152:155]
    s_add_u32 m0, s30, 1024
    s_mov_b32 s34, 3538944
    buffer_load_dwordx4 v11, s[20:23], s34 offen lds
    s_waitcnt lgkmcnt(11)
    v_mfma_f32_16x16x32_bf16 v[184:187], v[48:51], v[44:47], v[184:187]
    ds_read_b128 v[20:23], v7 offset:1024
    v_mfma_f32_16x16x32_bf16 v[92:95], v[52:55], v[32:35], v[92:95]
    s_add_u32 m0, s30, 2048
    s_mov_b32 s34, 3538944
    buffer_load_dwordx4 v12, s[20:23], s34 offen lds
    v_mfma_f32_16x16x32_bf16 v[124:127], v[52:55], v[36:39], v[124:127]
    ds_read_b64_tr_b16 v[48:49], v9 offset:16384
    v_mfma_f32_16x16x32_bf16 v[156:159], v[52:55], v[40:43], v[156:159]
    s_add_u32 m0, s30, 3072
    s_mov_b32 s34, 3538944
    buffer_load_dwordx4 v13, s[20:23], s34 offen lds
    v_mfma_f32_16x16x32_bf16 v[188:191], v[52:55], v[44:47], v[188:191]
    ds_read_b64_tr_b16 v[50:51], v9 offset:20992
    v_mfma_f32_16x16x32_bf16 v[96:99], v[56:59], v[32:35], v[96:99]
    s_add_u32 m0, s30, 4096
    s_mov_b32 s34, 3538944
    s_mov_b64 exec, 0xffffffff
    buffer_load_dwordx4 v14, s[20:23], s34 offen lds
    s_mov_b64 exec, -1
    v_mfma_f32_16x16x32_bf16 v[128:131], v[56:59], v[36:39], v[128:131]
    ds_read_b64_tr_b16 v[52:53], v9 offset:25600
    v_mfma_f32_16x16x32_bf16 v[160:163], v[56:59], v[40:43], v[160:163]
    ds_read_b64_tr_b16 v[54:55], v9 offset:30208
    v_mfma_f32_16x16x32_bf16 v[192:195], v[56:59], v[44:47], v[192:195]
    ds_read_b128 v[24:27], v7 offset:2048
    s_waitcnt lgkmcnt(15)
    v_mfma_f32_16x16x32_bf16 v[100:103], v[60:63], v[32:35], v[100:103]
    ds_read_b64_tr_b16 v[56:57], v9 offset:16416
    v_mfma_f32_16x16x32_bf16 v[132:135], v[60:63], v[36:39], v[132:135]
    ds_read_b64_tr_b16 v[58:59], v9 offset:21024
    v_mfma_f32_16x16x32_bf16 v[164:167], v[60:63], v[40:43], v[164:167]
    ds_read_b128 v[28:31], v7 offset:3072
    v_mfma_f32_16x16x32_bf16 v[196:199], v[60:63], v[44:47], v[196:199]
    s_waitcnt lgkmcnt(15)
    v_mfma_f32_16x16x32_bf16 v[104:107], v[64:67], v[32:35], v[104:107]
    ds_read_b64_tr_b16 v[60:61], v9 offset:25632
    v_mfma_f32_16x16x32_bf16 v[136:139], v[64:67], v[36:39], v[136:139]
    ds_read_b64_tr_b16 v[62:63], v9 offset:30240
    v_mfma_f32_16x16x32_bf16 v[168:171], v[64:67], v[40:43], v[168:171]
    v_mfma_f32_16x16x32_bf16 v[200:203], v[64:67], v[44:47], v[200:203]
    s_waitcnt lgkmcnt(15)
    v_mfma_f32_16x16x32_bf16 v[108:111], v[68:71], v[32:35], v[108:111]
    ds_read_b64_tr_b16 v[64:65], v9 offset:16448
    v_mfma_f32_16x16x32_bf16 v[140:143], v[68:71], v[36:39], v[140:143]
    ds_read_b64_tr_b16 v[66:67], v9 offset:21056
    v_mfma_f32_16x16x32_bf16 v[172:175], v[68:71], v[40:43], v[172:175]
    v_mfma_f32_16x16x32_bf16 v[204:207], v[68:71], v[44:47], v[204:207]
    s_waitcnt lgkmcnt(15)
    v_mfma_f32_16x16x32_bf16 v[112:115], v[72:75], v[32:35], v[112:115]
    ds_read_b64_tr_b16 v[68:69], v9 offset:25664
    v_mfma_f32_16x16x32_bf16 v[144:147], v[72:75], v[36:39], v[144:147]
    ds_read_b64_tr_b16 v[70:71], v9 offset:30272
    v_mfma_f32_16x16x32_bf16 v[176:179], v[72:75], v[40:43], v[176:179]
    v_mfma_f32_16x16x32_bf16 v[208:211], v[72:75], v[44:47], v[208:211]
    s_waitcnt lgkmcnt(15)
    v_mfma_f32_16x16x32_bf16 v[116:119], v[76:79], v[32:35], v[116:119]
    ds_read_b64_tr_b16 v[72:73], v9 offset:16480
    v_mfma_f32_16x16x32_bf16 v[148:151], v[76:79], v[36:39], v[148:151]
    ds_read_b64_tr_b16 v[74:75], v9 offset:21088
    v_mfma_f32_16x16x32_bf16 v[180:183], v[76:79], v[40:43], v[180:183]
    v_mfma_f32_16x16x32_bf16 v[212:215], v[76:79], v[44:47], v[212:215]
    ds_read_b64_tr_b16 v[76:77], v9 offset:25696
    ds_read_b64_tr_b16 v[78:79], v9 offset:30304
    s_waitcnt vmcnt(5)
    s_barrier
    s_waitcnt lgkmcnt(15)
    v_mfma_f32_16x16x32_bf16 v[88:91], v[48:51], v[16:19], v[88:91]
    s_add_u32 m0, s30, 34816
    s_mov_b32 s34, 3833856
    buffer_load_dwordx4 v10, s[20:23], s34 offen lds
    v_mfma_f32_16x16x32_bf16 v[120:123], v[48:51], v[20:23], v[120:123]
    ds_read_b128 v[32:35], v7 offset:34816
    s_waitcnt lgkmcnt(14)
    v_mfma_f32_16x16x32_bf16 v[152:155], v[48:51], v[24:27], v[152:155]
    s_add_u32 m0, s30, 35840
    s_mov_b32 s34, 3833856
    buffer_load_dwordx4 v11, s[20:23], s34 offen lds
    s_waitcnt lgkmcnt(11)
    v_mfma_f32_16x16x32_bf16 v[184:187], v[48:51], v[28:31], v[184:187]
    ds_read_b128 v[36:39], v7 offset:35840
    v_mfma_f32_16x16x32_bf16 v[92:95], v[52:55], v[16:19], v[92:95]
    s_add_u32 m0, s30, 36864
    s_mov_b32 s34, 3833856
    buffer_load_dwordx4 v12, s[20:23], s34 offen lds
    v_mfma_f32_16x16x32_bf16 v[124:127], v[52:55], v[20:23], v[124:127]
    ds_read_b64_tr_b16 v[48:49], v9 offset:51200
    v_mfma_f32_16x16x32_bf16 v[156:159], v[52:55], v[24:27], v[156:159]
    s_add_u32 m0, s30, 37888
    s_mov_b32 s34, 3833856
    buffer_load_dwordx4 v13, s[20:23], s34 offen lds
    v_mfma_f32_16x16x32_bf16 v[188:191], v[52:55], v[28:31], v[188:191]
    ds_read_b64_tr_b16 v[50:51], v9 offset:55808
    v_mfma_f32_16x16x32_bf16 v[96:99], v[56:59], v[16:19], v[96:99]
    s_add_u32 m0, s30, 38912
    s_mov_b32 s34, 3833856
    s_mov_b64 exec, 0xffffffff
    buffer_load_dwordx4 v14, s[20:23], s34 offen lds
    s_mov_b64 exec, -1
    v_mfma_f32_16x16x32_bf16 v[128:131], v[56:59], v[20:23], v[128:131]
    ds_read_b64_tr_b16 v[52:53], v9 offset:60416
    v_mfma_f32_16x16x32_bf16 v[160:163], v[56:59], v[24:27], v[160:163]
    ds_read_b64_tr_b16 v[54:55], v9 offset:65024
    v_mfma_f32_16x16x32_bf16 v[192:195], v[56:59], v[28:31], v[192:195]
    ds_read_b128 v[40:43], v7 offset:36864
    s_waitcnt lgkmcnt(15)
    v_mfma_f32_16x16x32_bf16 v[100:103], v[60:63], v[16:19], v[100:103]
    ds_read_b64_tr_b16 v[56:57], v9 offset:51232
    v_mfma_f32_16x16x32_bf16 v[132:135], v[60:63], v[20:23], v[132:135]
    ds_read_b64_tr_b16 v[58:59], v9 offset:55840
    v_mfma_f32_16x16x32_bf16 v[164:167], v[60:63], v[24:27], v[164:167]
    ds_read_b128 v[44:47], v7 offset:37888
    v_mfma_f32_16x16x32_bf16 v[196:199], v[60:63], v[28:31], v[196:199]
    s_waitcnt lgkmcnt(15)
    v_mfma_f32_16x16x32_bf16 v[104:107], v[64:67], v[16:19], v[104:107]
    ds_read_b64_tr_b16 v[60:61], v9 offset:60448
    v_mfma_f32_16x16x32_bf16 v[136:139], v[64:67], v[20:23], v[136:139]
    ds_read_b64_tr_b16 v[62:63], v9 offset:65056
    v_mfma_f32_16x16x32_bf16 v[168:171], v[64:67], v[24:27], v[168:171]
    v_mfma_f32_16x16x32_bf16 v[200:203], v[64:67], v[28:31], v[200:203]
    s_waitcnt lgkmcnt(15)
    v_mfma_f32_16x16x32_bf16 v[108:111], v[68:71], v[16:19], v[108:111]
    ds_read_b64_tr_b16 v[64:65], v9 offset:51264
    v_mfma_f32_16x16x32_bf16 v[140:143], v[68:71], v[20:23], v[140:143]
    ds_read_b64_tr_b16 v[66:67], v9 offset:55872
    v_mfma_f32_16x16x32_bf16 v[172:175], v[68:71], v[24:27], v[172:175]
    v_mfma_f32_16x16x32_bf16 v[204:207], v[68:71], v[28:31], v[204:207]
    s_waitcnt lgkmcnt(15)
    v_mfma_f32_16x16x32_bf16 v[112:115], v[72:75], v[16:19], v[112:115]
    ds_read_b64_tr_b16 v[68:69], v9 offset:60480
    v_mfma_f32_16x16x32_bf16 v[144:147], v[72:75], v[20:23], v[144:147]
    ds_read_b64_tr_b16 v[70:71], v9 offset:65088
    v_mfma_f32_16x16x32_bf16 v[176:179], v[72:75], v[24:27], v[176:179]
    v_mfma_f32_16x16x32_bf16 v[208:211], v[72:75], v[28:31], v[208:211]
    s_waitcnt lgkmcnt(15)
    v_mfma_f32_16x16x32_bf16 v[116:119], v[76:79], v[16:19], v[116:119]
    ds_read_b64_tr_b16 v[72:73], v9 offset:51296
    v_mfma_f32_16x16x32_bf16 v[148:151], v[76:79], v[20:23], v[148:151]
    ds_read_b64_tr_b16 v[74:75], v9 offset:55904
    v_mfma_f32_16x16x32_bf16 v[180:183], v[76:79], v[24:27], v[180:183]
    v_mfma_f32_16x16x32_bf16 v[212:215], v[76:79], v[28:31], v[212:215]
    ds_read_b64_tr_b16 v[76:77], v9 offset:60512
    ds_read_b64_tr_b16 v[78:79], v9 offset:65120
    s_waitcnt vmcnt(5)
    s_barrier
    s_waitcnt lgkmcnt(15)
    v_mfma_f32_16x16x32_bf16 v[88:91], v[48:51], v[32:35], v[88:91]
    s_add_u32 m0, s30, 69632
    s_mov_b32 s34, 4128768
    buffer_load_dwordx4 v10, s[20:23], s34 offen lds
    v_mfma_f32_16x16x32_bf16 v[120:123], v[48:51], v[36:39], v[120:123]
    ds_read_b128 v[16:19], v6 offset:0
    s_waitcnt lgkmcnt(14)
    v_mfma_f32_16x16x32_bf16 v[152:155], v[48:51], v[40:43], v[152:155]
    s_add_u32 m0, s30, 70656
    s_mov_b32 s34, 4128768
    buffer_load_dwordx4 v11, s[20:23], s34 offen lds
    s_waitcnt lgkmcnt(11)
    v_mfma_f32_16x16x32_bf16 v[184:187], v[48:51], v[44:47], v[184:187]
    ds_read_b128 v[20:23], v6 offset:1024
    v_mfma_f32_16x16x32_bf16 v[92:95], v[52:55], v[32:35], v[92:95]
    s_add_u32 m0, s30, 71680
    s_mov_b32 s34, 4128768
    buffer_load_dwordx4 v12, s[20:23], s34 offen lds
    v_mfma_f32_16x16x32_bf16 v[124:127], v[52:55], v[36:39], v[124:127]
    ds_read_b64_tr_b16 v[48:49], v8 offset:16384
    v_mfma_f32_16x16x32_bf16 v[156:159], v[52:55], v[40:43], v[156:159]
    s_add_u32 m0, s30, 72704
    s_mov_b32 s34, 4128768
    buffer_load_dwordx4 v13, s[20:23], s34 offen lds
    v_mfma_f32_16x16x32_bf16 v[188:191], v[52:55], v[44:47], v[188:191]
    ds_read_b64_tr_b16 v[50:51], v8 offset:20992
    v_mfma_f32_16x16x32_bf16 v[96:99], v[56:59], v[32:35], v[96:99]
    s_add_u32 m0, s30, 73728
    s_mov_b32 s34, 4128768
    s_mov_b64 exec, 0xffffffff
    buffer_load_dwordx4 v14, s[20:23], s34 offen lds
    s_mov_b64 exec, -1
    v_mfma_f32_16x16x32_bf16 v[128:131], v[56:59], v[36:39], v[128:131]
    ds_read_b64_tr_b16 v[52:53], v8 offset:25600
    v_mfma_f32_16x16x32_bf16 v[160:163], v[56:59], v[40:43], v[160:163]
    ds_read_b64_tr_b16 v[54:55], v8 offset:30208
    v_mfma_f32_16x16x32_bf16 v[192:195], v[56:59], v[44:47], v[192:195]
    ds_read_b128 v[24:27], v6 offset:2048
    s_waitcnt lgkmcnt(15)
    v_mfma_f32_16x16x32_bf16 v[100:103], v[60:63], v[32:35], v[100:103]
    ds_read_b64_tr_b16 v[56:57], v8 offset:16416
    v_mfma_f32_16x16x32_bf16 v[132:135], v[60:63], v[36:39], v[132:135]
    ds_read_b64_tr_b16 v[58:59], v8 offset:21024
    v_mfma_f32_16x16x32_bf16 v[164:167], v[60:63], v[40:43], v[164:167]
    ds_read_b128 v[28:31], v6 offset:3072
    v_mfma_f32_16x16x32_bf16 v[196:199], v[60:63], v[44:47], v[196:199]
    s_waitcnt lgkmcnt(15)
    v_mfma_f32_16x16x32_bf16 v[104:107], v[64:67], v[32:35], v[104:107]
    ds_read_b64_tr_b16 v[60:61], v8 offset:25632
    v_mfma_f32_16x16x32_bf16 v[136:139], v[64:67], v[36:39], v[136:139]
    ds_read_b64_tr_b16 v[62:63], v8 offset:30240
    v_mfma_f32_16x16x32_bf16 v[168:171], v[64:67], v[40:43], v[168:171]
    v_mfma_f32_16x16x32_bf16 v[200:203], v[64:67], v[44:47], v[200:203]
    s_waitcnt lgkmcnt(15)
    v_mfma_f32_16x16x32_bf16 v[108:111], v[68:71], v[32:35], v[108:111]
    ds_read_b64_tr_b16 v[64:65], v8 offset:16448
    v_mfma_f32_16x16x32_bf16 v[140:143], v[68:71], v[36:39], v[140:143]
    ds_read_b64_tr_b16 v[66:67], v8 offset:21056
    v_mfma_f32_16x16x32_bf16 v[172:175], v[68:71], v[40:43], v[172:175]
    v_mfma_f32_16x16x32_bf16 v[204:207], v[68:71], v[44:47], v[204:207]
    s_waitcnt lgkmcnt(15)
    v_mfma_f32_16x16x32_bf16 v[112:115], v[72:75], v[32:35], v[112:115]
    ds_read_b64_tr_b16 v[68:69], v8 offset:25664
    v_mfma_f32_16x16x32_bf16 v[144:147], v[72:75], v[36:39], v[144:147]
    ds_read_b64_tr_b16 v[70:71], v8 offset:30272
    v_mfma_f32_16x16x32_bf16 v[176:179], v[72:75], v[40:43], v[176:179]
    v_mfma_f32_16x16x32_bf16 v[208:211], v[72:75], v[44:47], v[208:211]
    s_waitcnt lgkmcnt(15)
    v_mfma_f32_16x16x32_bf16 v[116:119], v[76:79], v[32:35], v[116:119]
    ds_read_b64_tr_b16 v[72:73], v8 offset:16480
    v_mfma_f32_16x16x32_bf16 v[148:151], v[76:79], v[36:39], v[148:151]
    ds_read_b64_tr_b16 v[74:75], v8 offset:21088
    v_mfma_f32_16x16x32_bf16 v[180:183], v[76:79], v[40:43], v[180:183]
    v_mfma_f32_16x16x32_bf16 v[212:215], v[76:79], v[44:47], v[212:215]
    ds_read_b64_tr_b16 v[76:77], v8 offset:25696
    ds_read_b64_tr_b16 v[78:79], v8 offset:30304
    s_waitcnt vmcnt(5)
    s_barrier
    s_waitcnt lgkmcnt(15)
    v_mfma_f32_16x16x32_bf16 v[88:91], v[48:51], v[16:19], v[88:91]
    s_add_u32 m0, s30, 104448
    s_mov_b32 s34, 4423680
    buffer_load_dwordx4 v10, s[20:23], s34 offen lds
    v_mfma_f32_16x16x32_bf16 v[120:123], v[48:51], v[20:23], v[120:123]
    ds_read_b128 v[32:35], v6 offset:34816
    s_waitcnt lgkmcnt(14)
    v_mfma_f32_16x16x32_bf16 v[152:155], v[48:51], v[24:27], v[152:155]
    s_add_u32 m0, s30, 105472
    s_mov_b32 s34, 4423680
    buffer_load_dwordx4 v11, s[20:23], s34 offen lds
    s_waitcnt lgkmcnt(11)
    v_mfma_f32_16x16x32_bf16 v[184:187], v[48:51], v[28:31], v[184:187]
    ds_read_b128 v[36:39], v6 offset:35840
    v_mfma_f32_16x16x32_bf16 v[92:95], v[52:55], v[16:19], v[92:95]
    s_add_u32 m0, s30, 106496
    s_mov_b32 s34, 4423680
    buffer_load_dwordx4 v12, s[20:23], s34 offen lds
    v_mfma_f32_16x16x32_bf16 v[124:127], v[52:55], v[20:23], v[124:127]
    ds_read_b64_tr_b16 v[48:49], v8 offset:51200
    v_mfma_f32_16x16x32_bf16 v[156:159], v[52:55], v[24:27], v[156:159]
    s_add_u32 m0, s30, 107520
    s_mov_b32 s34, 4423680
    buffer_load_dwordx4 v13, s[20:23], s34 offen lds
    v_mfma_f32_16x16x32_bf16 v[188:191], v[52:55], v[28:31], v[188:191]
    ds_read_b64_tr_b16 v[50:51], v8 offset:55808
    v_mfma_f32_16x16x32_bf16 v[96:99], v[56:59], v[16:19], v[96:99]
    s_add_u32 m0, s30, 108544
    s_mov_b32 s34, 4423680
    s_mov_b64 exec, 0xffffffff
    buffer_load_dwordx4 v14, s[20:23], s34 offen lds
    s_mov_b64 exec, -1
    v_mfma_f32_16x16x32_bf16 v[128:131], v[56:59], v[20:23], v[128:131]
    ds_read_b64_tr_b16 v[52:53], v8 offset:60416
    v_mfma_f32_16x16x32_bf16 v[160:163], v[56:59], v[24:27], v[160:163]
    ds_read_b64_tr_b16 v[54:55], v8 offset:65024
    v_mfma_f32_16x16x32_bf16 v[192:195], v[56:59], v[28:31], v[192:195]
    ds_read_b128 v[40:43], v6 offset:36864
    s_waitcnt lgkmcnt(15)
    v_mfma_f32_16x16x32_bf16 v[100:103], v[60:63], v[16:19], v[100:103]
    ds_read_b64_tr_b16 v[56:57], v8 offset:51232
    v_mfma_f32_16x16x32_bf16 v[132:135], v[60:63], v[20:23], v[132:135]
    ds_read_b64_tr_b16 v[58:59], v8 offset:55840
    v_mfma_f32_16x16x32_bf16 v[164:167], v[60:63], v[24:27], v[164:167]
    ds_read_b128 v[44:47], v6 offset:37888
    v_mfma_f32_16x16x32_bf16 v[196:199], v[60:63], v[28:31], v[196:199]
    s_waitcnt lgkmcnt(15)
    v_mfma_f32_16x16x32_bf16 v[104:107], v[64:67], v[16:19], v[104:107]
    ds_read_b64_tr_b16 v[60:61], v8 offset:60448
    v_mfma_f32_16x16x32_bf16 v[136:139], v[64:67], v[20:23], v[136:139]
    ds_read_b64_tr_b16 v[62:63], v8 offset:65056
    v_mfma_f32_16x16x32_bf16 v[168:171], v[64:67], v[24:27], v[168:171]
    v_mfma_f32_16x16x32_bf16 v[200:203], v[64:67], v[28:31], v[200:203]
    s_waitcnt lgkmcnt(15)
    v_mfma_f32_16x16x32_bf16 v[108:111], v[68:71], v[16:19], v[108:111]
    ds_read_b64_tr_b16 v[64:65], v8 offset:51264
    v_mfma_f32_16x16x32_bf16 v[140:143], v[68:71], v[20:23], v[140:143]
    ds_read_b64_tr_b16 v[66:67], v8 offset:55872
    v_mfma_f32_16x16x32_bf16 v[172:175], v[68:71], v[24:27], v[172:175]
    v_mfma_f32_16x16x32_bf16 v[204:207], v[68:71], v[28:31], v[204:207]
    s_waitcnt lgkmcnt(15)
    v_mfma_f32_16x16x32_bf16 v[112:115], v[72:75], v[16:19], v[112:115]
    ds_read_b64_tr_b16 v[68:69], v8 offset:60480
    v_mfma_f32_16x16x32_bf16 v[144:147], v[72:75], v[20:23], v[144:147]
    ds_read_b64_tr_b16 v[70:71], v8 offset:65088
    v_mfma_f32_16x16x32_bf16 v[176:179], v[72:75], v[24:27], v[176:179]
    v_mfma_f32_16x16x32_bf16 v[208:211], v[72:75], v[28:31], v[208:211]
    s_waitcnt lgkmcnt(15)
    v_mfma_f32_16x16x32_bf16 v[116:119], v[76:79], v[16:19], v[116:119]
    ds_read_b64_tr_b16 v[72:73], v8 offset:51296
    v_mfma_f32_16x16x32_bf16 v[148:151], v[76:79], v[20:23], v[148:151]
    ds_read_b64_tr_b16 v[74:75], v8 offset:55904
    v_mfma_f32_16x16x32_bf16 v[180:183], v[76:79], v[24:27], v[180:183]
    v_mfma_f32_16x16x32_bf16 v[212:215], v[76:79], v[28:31], v[212:215]
    ds_read_b64_tr_b16 v[76:77], v8 offset:60512
    ds_read_b64_tr_b16 v[78:79], v8 offset:65120
    s_waitcnt vmcnt(5)
    s_barrier
    s_waitcnt lgkmcnt(15)
    v_mfma_f32_16x16x32_bf16 v[88:91], v[48:51], v[32:35], v[88:91]
    s_add_u32 m0, s30, 0
    s_mov_b32 s34, 4718592
    buffer_load_dwordx4 v10, s[20:23], s34 offen lds
    v_mfma_f32_16x16x32_bf16 v[120:123], v[48:51], v[36:39], v[120:123]
    ds_read_b128 v[16:19], v7 offset:0
    s_waitcnt lgkmcnt(14)
    v_mfma_f32_16x16x32_bf16 v[152:155], v[48:51], v[40:43], v[152:155]
    s_add_u32 m0, s30, 1024
    s_mov_b32 s34, 4718592
    buffer_load_dwordx4 v11, s[20:23], s34 offen lds
    s_waitcnt lgkmcnt(11)
    v_mfma_f32_16x16x32_bf16 v[184:187], v[48:51], v[44:47], v[184:187]
    ds_read_b128 v[20:23], v7 offset:1024
    v_mfma_f32_16x16x32_bf16 v[92:95], v[52:55], v[32:35], v[92:95]
    s_add_u32 m0, s30, 2048
    s_mov_b32 s34, 4718592
    buffer_load_dwordx4 v12, s[20:23], s34 offen lds
    v_mfma_f32_16x16x32_bf16 v[124:127], v[52:55], v[36:39], v[124:127]
    ds_read_b64_tr_b16 v[48:49], v9 offset:16384
    v_mfma_f32_16x16x32_bf16 v[156:159], v[52:55], v[40:43], v[156:159]
    s_add_u32 m0, s30, 3072
    s_mov_b32 s34, 4718592
    buffer_load_dwordx4 v13, s[20:23], s34 offen lds
    v_mfma_f32_16x16x32_bf16 v[188:191], v[52:55], v[44:47], v[188:191]
    ds_read_b64_tr_b16 v[50:51], v9 offset:20992
    v_mfma_f32_16x16x32_bf16 v[96:99], v[56:59], v[32:35], v[96:99]
    s_add_u32 m0, s30, 4096
    s_mov_b32 s34, 4718592
    s_mov_b64 exec, 0xffffffff
    buffer_load_dwordx4 v14, s[20:23], s34 offen lds
    s_mov_b64 exec, -1
    v_mfma_f32_16x16x32_bf16 v[128:131], v[56:59], v[36:39], v[128:131]
    ds_read_b64_tr_b16 v[52:53], v9 offset:25600
    v_mfma_f32_16x16x32_bf16 v[160:163], v[56:59], v[40:43], v[160:163]
    ds_read_b64_tr_b16 v[54:55], v9 offset:30208
    v_mfma_f32_16x16x32_bf16 v[192:195], v[56:59], v[44:47], v[192:195]
    ds_read_b128 v[24:27], v7 offset:2048
    s_waitcnt lgkmcnt(15)
    v_mfma_f32_16x16x32_bf16 v[100:103], v[60:63], v[32:35], v[100:103]
    ds_read_b64_tr_b16 v[56:57], v9 offset:16416
    v_mfma_f32_16x16x32_bf16 v[132:135], v[60:63], v[36:39], v[132:135]
    ds_read_b64_tr_b16 v[58:59], v9 offset:21024
    v_mfma_f32_16x16x32_bf16 v[164:167], v[60:63], v[40:43], v[164:167]
    ds_read_b128 v[28:31], v7 offset:3072
    v_mfma_f32_16x16x32_bf16 v[196:199], v[60:63], v[44:47], v[196:199]
    s_waitcnt lgkmcnt(15)
    v_mfma_f32_16x16x32_bf16 v[104:107], v[64:67], v[32:35], v[104:107]
    ds_read_b64_tr_b16 v[60:61], v9 offset:25632
    v_mfma_f32_16x16x32_bf16 v[136:139], v[64:67], v[36:39], v[136:139]
    ds_read_b64_tr_b16 v[62:63], v9 offset:30240
    v_mfma_f32_16x16x32_bf16 v[168:171], v[64:67], v[40:43], v[168:171]
    v_mfma_f32_16x16x32_bf16 v[200:203], v[64:67], v[44:47], v[200:203]
    s_waitcnt lgkmcnt(15)
    v_mfma_f32_16x16x32_bf16 v[108:111], v[68:71], v[32:35], v[108:111]
    ds_read_b64_tr_b16 v[64:65], v9 offset:16448
    v_mfma_f32_16x16x32_bf16 v[140:143], v[68:71], v[36:39], v[140:143]
    ds_read_b64_tr_b16 v[66:67], v9 offset:21056
    v_mfma_f32_16x16x32_bf16 v[172:175], v[68:71], v[40:43], v[172:175]
    v_mfma_f32_16x16x32_bf16 v[204:207], v[68:71], v[44:47], v[204:207]
    s_waitcnt lgkmcnt(15)
    v_mfma_f32_16x16x32_bf16 v[112:115], v[72:75], v[32:35], v[112:115]
    ds_read_b64_tr_b16 v[68:69], v9 offset:25664
    v_mfma_f32_16x16x32_bf16 v[144:147], v[72:75], v[36:39], v[144:147]
    ds_read_b64_tr_b16 v[70:71], v9 offset:30272
    v_mfma_f32_16x16x32_bf16 v[176:179], v[72:75], v[40:43], v[176:179]
    v_mfma_f32_16x16x32_bf16 v[208:211], v[72:75], v[44:47], v[208:211]
    s_waitcnt lgkmcnt(15)
    v_mfma_f32_16x16x32_bf16 v[116:119], v[76:79], v[32:35], v[116:119]
    ds_read_b64_tr_b16 v[72:73], v9 offset:16480
    v_mfma_f32_16x16x32_bf16 v[148:151], v[76:79], v[36:39], v[148:151]
    ds_read_b64_tr_b16 v[74:75], v9 offset:21088
    v_mfma_f32_16x16x32_bf16 v[180:183], v[76:79], v[40:43], v[180:183]
    v_mfma_f32_16x16x32_bf16 v[212:215], v[76:79], v[44:47], v[212:215]
    ds_read_b64_tr_b16 v[76:77], v9 offset:25696
    ds_read_b64_tr_b16 v[78:79], v9 offset:30304
    s_waitcnt vmcnt(5)
    s_barrier
    s_waitcnt lgkmcnt(15)
    v_mfma_f32_16x16x32_bf16 v[88:91], v[48:51], v[16:19], v[88:91]
    s_add_u32 m0, s30, 34816
    s_mov_b32 s34, 5013504
    buffer_load_dwordx4 v10, s[20:23], s34 offen lds
    v_mfma_f32_16x16x32_bf16 v[120:123], v[48:51], v[20:23], v[120:123]
    ds_read_b128 v[32:35], v7 offset:34816
    s_waitcnt lgkmcnt(14)
    v_mfma_f32_16x16x32_bf16 v[152:155], v[48:51], v[24:27], v[152:155]
    s_add_u32 m0, s30, 35840
    s_mov_b32 s34, 5013504
    buffer_load_dwordx4 v11, s[20:23], s34 offen lds
    s_waitcnt lgkmcnt(11)
    v_mfma_f32_16x16x32_bf16 v[184:187], v[48:51], v[28:31], v[184:187]
    ds_read_b128 v[36:39], v7 offset:35840
    v_mfma_f32_16x16x32_bf16 v[92:95], v[52:55], v[16:19], v[92:95]
    s_add_u32 m0, s30, 36864
    s_mov_b32 s34, 5013504
    buffer_load_dwordx4 v12, s[20:23], s34 offen lds
    v_mfma_f32_16x16x32_bf16 v[124:127], v[52:55], v[20:23], v[124:127]
    ds_read_b64_tr_b16 v[48:49], v9 offset:51200
    v_mfma_f32_16x16x32_bf16 v[156:159], v[52:55], v[24:27], v[156:159]
    s_add_u32 m0, s30, 37888
    s_mov_b32 s34, 5013504
    buffer_load_dwordx4 v13, s[20:23], s34 offen lds
    v_mfma_f32_16x16x32_bf16 v[188:191], v[52:55], v[28:31], v[188:191]
    ds_read_b64_tr_b16 v[50:51], v9 offset:55808
    v_mfma_f32_16x16x32_bf16 v[96:99], v[56:59], v[16:19], v[96:99]
    s_add_u32 m0, s30, 38912
    s_mov_b32 s34, 5013504
    s_mov_b64 exec, 0xffffffff
    buffer_load_dwordx4 v14, s[20:23], s34 offen lds
    s_mov_b64 exec, -1
    v_mfma_f32_16x16x32_bf16 v[128:131], v[56:59], v[20:23], v[128:131]
    ds_read_b64_tr_b16 v[52:53], v9 offset:60416
    v_mfma_f32_16x16x32_bf16 v[160:163], v[56:59], v[24:27], v[160:163]
    ds_read_b64_tr_b16 v[54:55], v9 offset:65024
    v_mfma_f32_16x16x32_bf16 v[192:195], v[56:59], v[28:31], v[192:195]
    ds_read_b128 v[40:43], v7 offset:36864
    s_waitcnt lgkmcnt(15)
    v_mfma_f32_16x16x32_bf16 v[100:103], v[60:63], v[16:19], v[100:103]
    ds_read_b64_tr_b16 v[56:57], v9 offset:51232
    v_mfma_f32_16x16x32_bf16 v[132:135], v[60:63], v[20:23], v[132:135]
    ds_read_b64_tr_b16 v[58:59], v9 offset:55840
    v_mfma_f32_16x16x32_bf16 v[164:167], v[60:63], v[24:27], v[164:167]
    ds_read_b128 v[44:47], v7 offset:37888
    v_mfma_f32_16x16x32_bf16 v[196:199], v[60:63], v[28:31], v[196:199]
    s_waitcnt lgkmcnt(15)
    v_mfma_f32_16x16x32_bf16 v[104:107], v[64:67], v[16:19], v[104:107]
    ds_read_b64_tr_b16 v[60:61], v9 offset:60448
    v_mfma_f32_16x16x32_bf16 v[136:139], v[64:67], v[20:23], v[136:139]
    ds_read_b64_tr_b16 v[62:63], v9 offset:65056
    v_mfma_f32_16x16x32_bf16 v[168:171], v[64:67], v[24:27], v[168:171]
    v_mfma_f32_16x16x32_bf16 v[200:203], v[64:67], v[28:31], v[200:203]
    s_waitcnt lgkmcnt(15)
    v_mfma_f32_16x16x32_bf16 v[108:111], v[68:71], v[16:19], v[108:111]
    ds_read_b64_tr_b16 v[64:65], v9 offset:51264
    v_mfma_f32_16x16x32_bf16 v[140:143], v[68:71], v[20:23], v[140:143]
    ds_read_b64_tr_b16 v[66:67], v9 offset:55872
    v_mfma_f32_16x16x32_bf16 v[172:175], v[68:71], v[24:27], v[172:175]
    v_mfma_f32_16x16x32_bf16 v[204:207], v[68:71], v[28:31], v[204:207]
    s_waitcnt lgkmcnt(15)
    v_mfma_f32_16x16x32_bf16 v[112:115], v[72:75], v[16:19], v[112:115]
    ds_read_b64_tr_b16 v[68:69], v9 offset:60480
    v_mfma_f32_16x16x32_bf16 v[144:147], v[72:75], v[20:23], v[144:147]
    ds_read_b64_tr_b16 v[70:71], v9 offset:65088
    v_mfma_f32_16x16x32_bf16 v[176:179], v[72:75], v[24:27], v[176:179]
    v_mfma_f32_16x16x32_bf16 v[208:211], v[72:75], v[28:31], v[208:211]
    s_waitcnt lgkmcnt(15)
    v_mfma_f32_16x16x32_bf16 v[116:119], v[76:79], v[16:19], v[116:119]
    ds_read_b64_tr_b16 v[72:73], v9 offset:51296
    v_mfma_f32_16x16x32_bf16 v[148:151], v[76:79], v[20:23], v[148:151]
    ds_read_b64_tr_b16 v[74:75], v9 offset:55904
    v_mfma_f32_16x16x32_bf16 v[180:183], v[76:79], v[24:27], v[180:183]
    v_mfma_f32_16x16x32_bf16 v[212:215], v[76:79], v[28:31], v[212:215]
    ds_read_b64_tr_b16 v[76:77], v9 offset:60512
    ds_read_b64_tr_b16 v[78:79], v9 offset:65120
    s_waitcnt vmcnt(5)
    s_barrier
    s_waitcnt lgkmcnt(15)
    v_mfma_f32_16x16x32_bf16 v[88:91], v[48:51], v[32:35], v[88:91]
    ds_read_b128 v[16:19], v6 offset:0
    v_mfma_f32_16x16x32_bf16 v[120:123], v[48:51], v[36:39], v[120:123]
    ds_read_b128 v[20:23], v6 offset:1024
    s_waitcnt lgkmcnt(15)
    v_mfma_f32_16x16x32_bf16 v[152:155], v[48:51], v[40:43], v[152:155]
    ds_read_b128 v[24:27], v6 offset:2048
    s_waitcnt lgkmcnt(13)
    v_mfma_f32_16x16x32_bf16 v[184:187], v[48:51], v[44:47], v[184:187]
    ds_read_b128 v[28:31], v6 offset:3072
    v_mfma_f32_16x16x32_bf16 v[92:95], v[52:55], v[32:35], v[92:95]
    ds_read_b64_tr_b16 v[48:49], v8 offset:16384
    v_mfma_f32_16x16x32_bf16 v[124:127], v[52:55], v[36:39], v[124:127]
    ds_read_b64_tr_b16 v[50:51], v8 offset:20992
    v_mfma_f32_16x16x32_bf16 v[156:159], v[52:55], v[40:43], v[156:159]
    v_mfma_f32_16x16x32_bf16 v[188:191], v[52:55], v[44:47], v[188:191]
    v_mfma_f32_16x16x32_bf16 v[96:99], v[56:59], v[32:35], v[96:99]
    ds_read_b64_tr_b16 v[52:53], v8 offset:25600
    v_mfma_f32_16x16x32_bf16 v[128:131], v[56:59], v[36:39], v[128:131]
    ds_read_b64_tr_b16 v[54:55], v8 offset:30208
    v_mfma_f32_16x16x32_bf16 v[160:163], v[56:59], v[40:43], v[160:163]
    v_mfma_f32_16x16x32_bf16 v[192:195], v[56:59], v[44:47], v[192:195]
    s_waitcnt lgkmcnt(15)
    v_mfma_f32_16x16x32_bf16 v[100:103], v[60:63], v[32:35], v[100:103]
    ds_read_b64_tr_b16 v[56:57], v8 offset:16416
    v_mfma_f32_16x16x32_bf16 v[132:135], v[60:63], v[36:39], v[132:135]
    ds_read_b64_tr_b16 v[58:59], v8 offset:21024
    v_mfma_f32_16x16x32_bf16 v[164:167], v[60:63], v[40:43], v[164:167]
    v_mfma_f32_16x16x32_bf16 v[196:199], v[60:63], v[44:47], v[196:199]
    s_waitcnt lgkmcnt(15)
    v_mfma_f32_16x16x32_bf16 v[104:107], v[64:67], v[32:35], v[104:107]
    ds_read_b64_tr_b16 v[60:61], v8 offset:25632
    v_mfma_f32_16x16x32_bf16 v[136:139], v[64:67], v[36:39], v[136:139]
    ds_read_b64_tr_b16 v[62:63], v8 offset:30240
    v_mfma_f32_16x16x32_bf16 v[168:171], v[64:67], v[40:43], v[168:171]
    v_mfma_f32_16x16x32_bf16 v[200:203], v[64:67], v[44:47], v[200:203]
    s_waitcnt lgkmcnt(15)
    v_mfma_f32_16x16x32_bf16 v[108:111], v[68:71], v[32:35], v[108:111]
    ds_read_b64_tr_b16 v[64:65], v8 offset:16448
    v_mfma_f32_16x16x32_bf16 v[140:143], v[68:71], v[36:39], v[140:143]
    ds_read_b64_tr_b16 v[66:67], v8 offset:21056
    v_mfma_f32_16x16x32_bf16 v[172:175], v[68:71], v[40:43], v[172:175]
    v_mfma_f32_16x16x32_bf16 v[204:207], v[68:71], v[44:47], v[204:207]
    s_waitcnt lgkmcnt(15)
    v_mfma_f32_16x16x32_bf16 v[112:115], v[72:75], v[32:35], v[112:115]
    ds_read_b64_tr_b16 v[68:69], v8 offset:25664
    v_mfma_f32_16x16x32_bf16 v[144:147], v[72:75], v[36:39], v[144:147]
    ds_read_b64_tr_b16 v[70:71], v8 offset:30272
    v_mfma_f32_16x16x32_bf16 v[176:179], v[72:75], v[40:43], v[176:179]
    v_mfma_f32_16x16x32_bf16 v[208:211], v[72:75], v[44:47], v[208:211]
    s_waitcnt lgkmcnt(15)
    v_mfma_f32_16x16x32_bf16 v[116:119], v[76:79], v[32:35], v[116:119]
    ds_read_b64_tr_b16 v[72:73], v8 offset:16480
    v_mfma_f32_16x16x32_bf16 v[148:151], v[76:79], v[36:39], v[148:151]
    ds_read_b64_tr_b16 v[74:75], v8 offset:21088
    v_mfma_f32_16x16x32_bf16 v[180:183], v[76:79], v[40:43], v[180:183]
    v_mfma_f32_16x16x32_bf16 v[212:215], v[76:79], v[44:47], v[212:215]
    ds_read_b64_tr_b16 v[76:77], v8 offset:25696
    ds_read_b64_tr_b16 v[78:79], v8 offset:30304
    s_waitcnt vmcnt(0)
    s_barrier
    s_waitcnt lgkmcnt(14)
    v_mfma_f32_16x16x32_bf16 v[88:91], v[48:51], v[16:19], v[88:91]
    ds_read_b128 v[32:35], v6 offset:34816
    v_mfma_f32_16x16x32_bf16 v[120:123], v[48:51], v[20:23], v[120:123]
    ds_read_b128 v[36:39], v6 offset:35840
    v_mfma_f32_16x16x32_bf16 v[152:155], v[48:51], v[24:27], v[152:155]
    ds_read_b128 v[40:43], v6 offset:36864
    v_mfma_f32_16x16x32_bf16 v[184:187], v[48:51], v[28:31], v[184:187]
    ds_read_b128 v[44:47], v6 offset:37888
    s_waitcnt lgkmcnt(15)
    v_mfma_f32_16x16x32_bf16 v[92:95], v[52:55], v[16:19], v[92:95]
    ds_read_b64_tr_b16 v[48:49], v8 offset:51200
    v_mfma_f32_16x16x32_bf16 v[124:127], v[52:55], v[20:23], v[124:127]
    ds_read_b64_tr_b16 v[50:51], v8 offset:55808
    v_mfma_f32_16x16x32_bf16 v[156:159], v[52:55], v[24:27], v[156:159]
    v_mfma_f32_16x16x32_bf16 v[188:191], v[52:55], v[28:31], v[188:191]
    s_waitcnt lgkmcnt(15)
    v_mfma_f32_16x16x32_bf16 v[96:99], v[56:59], v[16:19], v[96:99]
    ds_read_b64_tr_b16 v[52:53], v8 offset:60416
    v_mfma_f32_16x16x32_bf16 v[128:131], v[56:59], v[20:23], v[128:131]
    ds_read_b64_tr_b16 v[54:55], v8 offset:65024
    v_mfma_f32_16x16x32_bf16 v[160:163], v[56:59], v[24:27], v[160:163]
    v_mfma_f32_16x16x32_bf16 v[192:195], v[56:59], v[28:31], v[192:195]
    s_waitcnt lgkmcnt(15)
    v_mfma_f32_16x16x32_bf16 v[100:103], v[60:63], v[16:19], v[100:103]
    ds_read_b64_tr_b16 v[56:57], v8 offset:51232
    v_mfma_f32_16x16x32_bf16 v[132:135], v[60:63], v[20:23], v[132:135]
    ds_read_b64_tr_b16 v[58:59], v8 offset:55840
    v_mfma_f32_16x16x32_bf16 v[164:167], v[60:63], v[24:27], v[164:167]
    v_mfma_f32_16x16x32_bf16 v[196:199], v[60:63], v[28:31], v[196:199]
    s_waitcnt lgkmcnt(15)
    v_mfma_f32_16x16x32_bf16 v[104:107], v[64:67], v[16:19], v[104:107]
    ds_read_b64_tr_b16 v[60:61], v8 offset:60448
    v_mfma_f32_16x16x32_bf16 v[136:139], v[64:67], v[20:23], v[136:139]
    ds_read_b64_tr_b16 v[62:63], v8 offset:65056
    v_mfma_f32_16x16x32_bf16 v[168:171], v[64:67], v[24:27], v[168:171]
    v_mfma_f32_16x16x32_bf16 v[200:203], v[64:67], v[28:31], v[200:203]
    s_waitcnt lgkmcnt(15)
    v_mfma_f32_16x16x32_bf16 v[108:111], v[68:71], v[16:19], v[108:111]
    ds_read_b64_tr_b16 v[64:65], v8 offset:51264
    v_mfma_f32_16x16x32_bf16 v[140:143], v[68:71], v[20:23], v[140:143]
    ds_read_b64_tr_b16 v[66:67], v8 offset:55872
    v_mfma_f32_16x16x32_bf16 v[172:175], v[68:71], v[24:27], v[172:175]
    v_mfma_f32_16x16x32_bf16 v[204:207], v[68:71], v[28:31], v[204:207]
    s_waitcnt lgkmcnt(15)
    v_mfma_f32_16x16x32_bf16 v[112:115], v[72:75], v[16:19], v[112:115]
    ds_read_b64_tr_b16 v[68:69], v8 offset:60480
    v_mfma_f32_16x16x32_bf16 v[144:147], v[72:75], v[20:23], v[144:147]
    ds_read_b64_tr_b16 v[70:71], v8 offset:65088
    v_mfma_f32_16x16x32_bf16 v[176:179], v[72:75], v[24:27], v[176:179]
    v_mfma_f32_16x16x32_bf16 v[208:211], v[72:75], v[28:31], v[208:211]
    s_waitcnt lgkmcnt(15)
    v_mfma_f32_16x16x32_bf16 v[116:119], v[76:79], v[16:19], v[116:119]
    ds_read_b64_tr_b16 v[72:73], v8 offset:51296
    v_mfma_f32_16x16x32_bf16 v[148:151], v[76:79], v[20:23], v[148:151]
    ds_read_b64_tr_b16 v[74:75], v8 offset:55904
    v_mfma_f32_16x16x32_bf16 v[180:183], v[76:79], v[24:27], v[180:183]
    v_mfma_f32_16x16x32_bf16 v[212:215], v[76:79], v[28:31], v[212:215]
    ds_read_b64_tr_b16 v[76:77], v8 offset:60512
    ds_read_b64_tr_b16 v[78:79], v8 offset:65120
    s_waitcnt lgkmcnt(14)
    v_mfma_f32_16x16x32_bf16 v[88:91], v[48:51], v[32:35], v[88:91]
    v_mfma_f32_16x16x32_bf16 v[120:123], v[48:51], v[36:39], v[120:123]
    v_mfma_f32_16x16x32_bf16 v[152:155], v[48:51], v[40:43], v[152:155]
    v_mfma_f32_16x16x32_bf16 v[184:187], v[48:51], v[44:47], v[184:187]
    s_waitcnt lgkmcnt(12)
    v_mfma_f32_16x16x32_bf16 v[92:95], v[52:55], v[32:35], v[92:95]
    v_mfma_f32_16x16x32_bf16 v[124:127], v[52:55], v[36:39], v[124:127]
    v_mfma_f32_16x16x32_bf16 v[156:159], v[52:55], v[40:43], v[156:159]
    v_mfma_f32_16x16x32_bf16 v[188:191], v[52:55], v[44:47], v[188:191]
    s_waitcnt lgkmcnt(10)
    v_mfma_f32_16x16x32_bf16 v[96:99], v[56:59], v[32:35], v[96:99]
    v_mfma_f32_16x16x32_bf16 v[128:131], v[56:59], v[36:39], v[128:131]
    v_mfma_f32_16x16x32_bf16 v[160:163], v[56:59], v[40:43], v[160:163]
    v_mfma_f32_16x16x32_bf16 v[192:195], v[56:59], v[44:47], v[192:195]
    s_waitcnt lgkmcnt(8)
    v_mfma_f32_16x16x32_bf16 v[100:103], v[60:63], v[32:35], v[100:103]
    v_mfma_f32_16x16x32_bf16 v[132:135], v[60:63], v[36:39], v[132:135]
    v_mfma_f32_16x16x32_bf16 v[164:167], v[60:63], v[40:43], v[164:167]
    v_mfma_f32_16x16x32_bf16 v[196:199], v[60:63], v[44:47], v[196:199]
    s_waitcnt lgkmcnt(6)
    v_mfma_f32_16x16x32_bf16 v[104:107], v[64:67], v[32:35], v[104:107]
    v_mfma_f32_16x16x32_bf16 v[136:139], v[64:67], v[36:39], v[136:139]
    v_mfma_f32_16x16x32_bf16 v[168:171], v[64:67], v[40:43], v[168:171]
    v_mfma_f32_16x16x32_bf16 v[200:203], v[64:67], v[44:47], v[200:203]
    s_waitcnt lgkmcnt(4)
    v_mfma_f32_16x16x32_bf16 v[108:111], v[68:71], v[32:35], v[108:111]
    v_mfma_f32_16x16x32_bf16 v[140:143], v[68:71], v[36:39], v[140:143]
    v_mfma_f32_16x16x32_bf16 v[172:175], v[68:71], v[40:43], v[172:175]
    v_mfma_f32_16x16x32_bf16 v[204:207], v[68:71], v[44:47], v[204:207]
    s_waitcnt lgkmcnt(2)
    v_mfma_f32_16x16x32_bf16 v[112:115], v[72:75], v[32:35], v[112:115]
    v_mfma_f32_16x16x32_bf16 v[144:147], v[72:75], v[36:39], v[144:147]
    v_mfma_f32_16x16x32_bf16 v[176:179], v[72:75], v[40:43], v[176:179]
    v_mfma_f32_16x16x32_bf16 v[208:211], v[72:75], v[44:47], v[208:211]
    s_waitcnt lgkmcnt(0)
    v_mfma_f32_16x16x32_bf16 v[116:119], v[76:79], v[32:35], v[116:119]
    v_mfma_f32_16x16x32_bf16 v[148:151], v[76:79], v[36:39], v[148:151]
    v_mfma_f32_16x16x32_bf16 v[180:183], v[76:79], v[40:43], v[180:183]
    v_mfma_f32_16x16x32_bf16 v[212:215], v[76:79], v[44:47], v[212:215]
gemm1_kernel_epi1:
    s_lshl_b32 s14, s11, 4
    s_lshl_b32 s15, s13, 2
    s_add_u32 s14, s14, s15
    s_mul_i32 s35, s14, 147456
    s_mul_i32 s36, s10, 9
    s_add_u32 s39, s36, s44
    s_add_u32 s39, s39, 4
    s_lshl_b32 s39, s39, 9
    s_add_u32 s39, s39, s35
    s_xor_b32 s40, s44, 1
    s_lshl_b32 s40, s40, 3
    s_add_u32 s40, s40, s36
    s_lshr_b32 s40, s40, 1
    s_lshl_b32 s40, s40, 10
    s_lshl_b32 s41, s44, 3
    s_add_u32 s40, s40, s41
    s_add_u32 s40, s40, s35
    s_mov_b32 s42, 0xbfb8aa3b
    s_mov_b32 s43, 0xbfb8aa3b
    s_nop 7

    v_pk_mul_f32 v[16:17], v[88:89], s[42:43]
    v_pk_mul_f32 v[18:19], v[90:91], s[42:43]
    v_pk_mul_f32 v[20:21], v[96:97], s[42:43]
    v_pk_mul_f32 v[22:23], v[98:99], s[42:43]
    v_exp_f32 v16, v16
    v_exp_f32 v17, v17
    v_exp_f32 v18, v18
    v_exp_f32 v19, v19
    v_exp_f32 v20, v20
    v_exp_f32 v21, v21
    v_exp_f32 v22, v22
    v_exp_f32 v23, v23
    v_pk_mul_f32 v[88:89], v[88:89], v[92:93]
    v_pk_mul_f32 v[90:91], v[90:91], v[94:95]
    v_pk_mul_f32 v[96:97], v[96:97], v[100:101]
    v_pk_mul_f32 v[98:99], v[98:99], v[102:103]
    v_pk_add_f32 v[16:17], v[16:17], 1.0 op_sel_hi:[1,0]
    v_pk_add_f32 v[18:19], v[18:19], 1.0 op_sel_hi:[1,0]
    v_pk_add_f32 v[20:21], v[20:21], 1.0 op_sel_hi:[1,0]
    v_pk_add_f32 v[22:23], v[22:23], 1.0 op_sel_hi:[1,0]
    v_rcp_f32 v16, v16
    v_rcp_f32 v17, v17
    v_rcp_f32 v18, v18
    v_rcp_f32 v19, v19
    v_rcp_f32 v20, v20
    v_rcp_f32 v21, v21
    v_rcp_f32 v22, v22
    v_rcp_f32 v23, v23
    s_nop 0
    v_pk_mul_f32 v[16:17], v[88:89], v[16:17]
    v_pk_mul_f32 v[18:19], v[90:91], v[18:19]
    v_pk_mul_f32 v[20:21], v[96:97], v[20:21]
    v_pk_mul_f32 v[22:23], v[98:99], v[22:23]
    v_cvt_pk_bf16_f32 v24, v16, v17
    v_cvt_pk_bf16_f32 v25, v18, v19
    v_cvt_pk_bf16_f32 v26, v20, v21
    v_cvt_pk_bf16_f32 v27, v22, v23
    s_add_u32 s41, s39, 0
    buffer_store_dwordx4 v[24:27], v2, s[24:27], s41 offen
    v_pk_mul_f32 v[32:33], v[120:121], s[42:43]
    v_pk_mul_f32 v[34:35], v[122:123], s[42:43]
    v_pk_mul_f32 v[36:37], v[128:129], s[42:43]
    v_pk_mul_f32 v[38:39], v[130:131], s[42:43]
    v_exp_f32 v32, v32
    v_exp_f32 v33, v33
    v_exp_f32 v34, v34
    v_exp_f32 v35, v35
    v_exp_f32 v36, v36
    v_exp_f32 v37, v37
    v_exp_f32 v38, v38
    v_exp_f32 v39, v39
    v_pk_mul_f32 v[120:121], v[120:121], v[124:125]
    v_pk_mul_f32 v[122:123], v[122:123], v[126:127]
    v_pk_mul_f32 v[128:129], v[128:129], v[132:133]
    v_pk_mul_f32 v[130:131], v[130:131], v[134:135]
    v_pk_add_f32 v[32:33], v[32:33], 1.0 op_sel_hi:[1,0]
    v_pk_add_f32 v[34:35], v[34:35], 1.0 op_sel_hi:[1,0]
    v_pk_add_f32 v[36:37], v[36:37], 1.0 op_sel_hi:[1,0]
    v_pk_add_f32 v[38:39], v[38:39], 1.0 op_sel_hi:[1,0]
    v_rcp_f32 v32, v32
    v_rcp_f32 v33, v33
    v_rcp_f32 v34, v34
    v_rcp_f32 v35, v35
    v_rcp_f32 v36, v36
    v_rcp_f32 v37, v37
    v_rcp_f32 v38, v38
    v_rcp_f32 v39, v39
    s_nop 0
    v_pk_mul_f32 v[32:33], v[120:121], v[32:33]
    v_pk_mul_f32 v[34:35], v[122:123], v[34:35]
    v_pk_mul_f32 v[36:37], v[128:129], v[36:37]
    v_pk_mul_f32 v[38:39], v[130:131], v[38:39]
    v_cvt_pk_bf16_f32 v40, v32, v33
    v_cvt_pk_bf16_f32 v41, v34, v35
    v_cvt_pk_bf16_f32 v42, v36, v37
    v_cvt_pk_bf16_f32 v43, v38, v39
    s_add_u32 s41, s39, 147456
    buffer_store_dwordx4 v[40:43], v2, s[24:27], s41 offen
    v_pk_mul_f32 v[48:49], v[152:153], s[42:43]
    v_pk_mul_f32 v[50:51], v[154:155], s[42:43]
    v_pk_mul_f32 v[52:53], v[160:161], s[42:43]
    v_pk_mul_f32 v[54:55], v[162:163], s[42:43]
    v_exp_f32 v48, v48
    v_exp_f32 v49, v49
    v_exp_f32 v50, v50
    v_exp_f32 v51, v51
    v_exp_f32 v52, v52
    v_exp_f32 v53, v53
    v_exp_f32 v54, v54
    v_exp_f32 v55, v55
    v_pk_mul_f32 v[152:153], v[152:153], v[156:157]
    v_pk_mul_f32 v[154:155], v[154:155], v[158:159]
    v_pk_mul_f32 v[160:161], v[160:161], v[164:165]
    v_pk_mul_f32 v[162:163], v[162:163], v[166:167]
    v_pk_add_f32 v[48:49], v[48:49], 1.0 op_sel_hi:[1,0]
    v_pk_add_f32 v[50:51], v[50:51], 1.0 op_sel_hi:[1,0]
    v_pk_add_f32 v[52:53], v[52:53], 1.0 op_sel_hi:[1,0]
    v_pk_add_f32 v[54:55], v[54:55], 1.0 op_sel_hi:[1,0]
    v_rcp_f32 v48, v48
    v_rcp_f32 v49, v49
    v_rcp_f32 v50, v50
    v_rcp_f32 v51, v51
    v_rcp_f32 v52, v52
    v_rcp_f32 v53, v53
    v_rcp_f32 v54, v54
    v_rcp_f32 v55, v55
    s_nop 0
    v_pk_mul_f32 v[48:49], v[152:153], v[48:49]
    v_pk_mul_f32 v[50:51], v[154:155], v[50:51]
    v_pk_mul_f32 v[52:53], v[160:161], v[52:53]
    v_pk_mul_f32 v[54:55], v[162:163], v[54:55]
    v_cvt_pk_bf16_f32 v56, v48, v49
    v_cvt_pk_bf16_f32 v57, v50, v51
    v_cvt_pk_bf16_f32 v58, v52, v53
    v_cvt_pk_bf16_f32 v59, v54, v55
    s_add_u32 s41, s39, 294912
    buffer_store_dwordx4 v[56:59], v2, s[24:27], s41 offen
    v_pk_mul_f32 v[64:65], v[184:185], s[42:43]
    v_pk_mul_f32 v[66:67], v[186:187], s[42:43]
    v_pk_mul_f32 v[68:69], v[192:193], s[42:43]
    v_pk_mul_f32 v[70:71], v[194:195], s[42:43]
    v_exp_f32 v64, v64
    v_exp_f32 v65, v65
    v_exp_f32 v66, v66
    v_exp_f32 v67, v67
    v_exp_f32 v68, v68
    v_exp_f32 v69, v69
    v_exp_f32 v70, v70
    v_exp_f32 v71, v71
    v_pk_mul_f32 v[184:185], v[184:185], v[188:189]
    v_pk_mul_f32 v[186:187], v[186:187], v[190:191]
    v_pk_mul_f32 v[192:193], v[192:193], v[196:197]
    v_pk_mul_f32 v[194:195], v[194:195], v[198:199]
    v_pk_add_f32 v[64:65], v[64:65], 1.0 op_sel_hi:[1,0]
    v_pk_add_f32 v[66:67], v[66:67], 1.0 op_sel_hi:[1,0]
    v_pk_add_f32 v[68:69], v[68:69], 1.0 op_sel_hi:[1,0]
    v_pk_add_f32 v[70:71], v[70:71], 1.0 op_sel_hi:[1,0]
    v_rcp_f32 v64, v64
    v_rcp_f32 v65, v65
    v_rcp_f32 v66, v66
    v_rcp_f32 v67, v67
    v_rcp_f32 v68, v68
    v_rcp_f32 v69, v69
    v_rcp_f32 v70, v70
    v_rcp_f32 v71, v71
    s_nop 0
    v_pk_mul_f32 v[64:65], v[184:185], v[64:65]
    v_pk_mul_f32 v[66:67], v[186:187], v[66:67]
    v_pk_mul_f32 v[68:69], v[192:193], v[68:69]
    v_pk_mul_f32 v[70:71], v[194:195], v[70:71]
    v_cvt_pk_bf16_f32 v72, v64, v65
    v_cvt_pk_bf16_f32 v73, v66, v67
    v_cvt_pk_bf16_f32 v74, v68, v69
    v_cvt_pk_bf16_f32 v75, v70, v71
    s_add_u32 s41, s39, 442368
    buffer_store_dwordx4 v[72:75], v2, s[24:27], s41 offen
    v_pk_mul_f32 v[16:17], v[104:105], s[42:43]
    v_pk_mul_f32 v[18:19], v[106:107], s[42:43]
    v_pk_mul_f32 v[20:21], v[112:113], s[42:43]
    v_pk_mul_f32 v[22:23], v[114:115], s[42:43]
    v_exp_f32 v16, v16
    v_exp_f32 v17, v17
    v_exp_f32 v18, v18
    v_exp_f32 v19, v19
    v_exp_f32 v20, v20
    v_exp_f32 v21, v21
    v_exp_f32 v22, v22
    v_exp_f32 v23, v23
    v_pk_mul_f32 v[104:105], v[104:105], v[108:109]
    v_pk_mul_f32 v[106:107], v[106:107], v[110:111]
    v_pk_mul_f32 v[112:113], v[112:113], v[116:117]
    v_pk_mul_f32 v[114:115], v[114:115], v[118:119]
    v_pk_add_f32 v[16:17], v[16:17], 1.0 op_sel_hi:[1,0]
    v_pk_add_f32 v[18:19], v[18:19], 1.0 op_sel_hi:[1,0]
    v_pk_add_f32 v[20:21], v[20:21], 1.0 op_sel_hi:[1,0]
    v_pk_add_f32 v[22:23], v[22:23], 1.0 op_sel_hi:[1,0]
    v_rcp_f32 v16, v16
    v_rcp_f32 v17, v17
    v_rcp_f32 v18, v18
    v_rcp_f32 v19, v19
    v_rcp_f32 v20, v20
    v_rcp_f32 v21, v21
    v_rcp_f32 v22, v22
    v_rcp_f32 v23, v23
    s_nop 0
    v_pk_mul_f32 v[16:17], v[104:105], v[16:17]
    v_pk_mul_f32 v[18:19], v[106:107], v[18:19]
    v_pk_mul_f32 v[20:21], v[112:113], v[20:21]
    v_pk_mul_f32 v[22:23], v[114:115], v[22:23]
    v_cvt_pk_bf16_f32 v24, v16, v17
    v_cvt_pk_bf16_f32 v25, v18, v19
    v_cvt_pk_bf16_f32 v26, v20, v21
    v_cvt_pk_bf16_f32 v27, v22, v23
    s_add_u32 s41, s39, 1024
    buffer_store_dwordx4 v[24:27], v2, s[24:27], s41 offen
    v_pk_mul_f32 v[32:33], v[136:137], s[42:43]
    v_pk_mul_f32 v[34:35], v[138:139], s[42:43]
    v_pk_mul_f32 v[36:37], v[144:145], s[42:43]
    v_pk_mul_f32 v[38:39], v[146:147], s[42:43]
    v_exp_f32 v32, v32
    v_exp_f32 v33, v33
    v_exp_f32 v34, v34
    v_exp_f32 v35, v35
    v_exp_f32 v36, v36
    v_exp_f32 v37, v37
    v_exp_f32 v38, v38
    v_exp_f32 v39, v39
    v_pk_mul_f32 v[136:137], v[136:137], v[140:141]
    v_pk_mul_f32 v[138:139], v[138:139], v[142:143]
    v_pk_mul_f32 v[144:145], v[144:145], v[148:149]
    v_pk_mul_f32 v[146:147], v[146:147], v[150:151]
    v_pk_add_f32 v[32:33], v[32:33], 1.0 op_sel_hi:[1,0]
    v_pk_add_f32 v[34:35], v[34:35], 1.0 op_sel_hi:[1,0]
    v_pk_add_f32 v[36:37], v[36:37], 1.0 op_sel_hi:[1,0]
    v_pk_add_f32 v[38:39], v[38:39], 1.0 op_sel_hi:[1,0]
    v_rcp_f32 v32, v32
    v_rcp_f32 v33, v33
    v_rcp_f32 v34, v34
    v_rcp_f32 v35, v35
    v_rcp_f32 v36, v36
    v_rcp_f32 v37, v37
    v_rcp_f32 v38, v38
    v_rcp_f32 v39, v39
    s_nop 0
    v_pk_mul_f32 v[32:33], v[136:137], v[32:33]
    v_pk_mul_f32 v[34:35], v[138:139], v[34:35]
    v_pk_mul_f32 v[36:37], v[144:145], v[36:37]
    v_pk_mul_f32 v[38:39], v[146:147], v[38:39]
    v_cvt_pk_bf16_f32 v40, v32, v33
    v_cvt_pk_bf16_f32 v41, v34, v35
    v_cvt_pk_bf16_f32 v42, v36, v37
    v_cvt_pk_bf16_f32 v43, v38, v39
    s_add_u32 s41, s39, 148480
    buffer_store_dwordx4 v[40:43], v2, s[24:27], s41 offen
    v_pk_mul_f32 v[48:49], v[168:169], s[42:43]
    v_pk_mul_f32 v[50:51], v[170:171], s[42:43]
    v_pk_mul_f32 v[52:53], v[176:177], s[42:43]
    v_pk_mul_f32 v[54:55], v[178:179], s[42:43]
    v_exp_f32 v48, v48
    v_exp_f32 v49, v49
    v_exp_f32 v50, v50
    v_exp_f32 v51, v51
    v_exp_f32 v52, v52
    v_exp_f32 v53, v53
    v_exp_f32 v54, v54
    v_exp_f32 v55, v55
    v_pk_mul_f32 v[168:169], v[168:169], v[172:173]
    v_pk_mul_f32 v[170:171], v[170:171], v[174:175]
    v_pk_mul_f32 v[176:177], v[176:177], v[180:181]
    v_pk_mul_f32 v[178:179], v[178:179], v[182:183]
    v_pk_add_f32 v[48:49], v[48:49], 1.0 op_sel_hi:[1,0]
    v_pk_add_f32 v[50:51], v[50:51], 1.0 op_sel_hi:[1,0]
    v_pk_add_f32 v[52:53], v[52:53], 1.0 op_sel_hi:[1,0]
    v_pk_add_f32 v[54:55], v[54:55], 1.0 op_sel_hi:[1,0]
    v_rcp_f32 v48, v48
    v_rcp_f32 v49, v49
    v_rcp_f32 v50, v50
    v_rcp_f32 v51, v51
    v_rcp_f32 v52, v52
    v_rcp_f32 v53, v53
    v_rcp_f32 v54, v54
    v_rcp_f32 v55, v55
    s_nop 0
    v_pk_mul_f32 v[48:49], v[168:169], v[48:49]
    v_pk_mul_f32 v[50:51], v[170:171], v[50:51]
    v_pk_mul_f32 v[52:53], v[176:177], v[52:53]
    v_pk_mul_f32 v[54:55], v[178:179], v[54:55]
    v_cvt_pk_bf16_f32 v56, v48, v49
    v_cvt_pk_bf16_f32 v57, v50, v51
    v_cvt_pk_bf16_f32 v58, v52, v53
    v_cvt_pk_bf16_f32 v59, v54, v55
    s_add_u32 s41, s39, 295936
    buffer_store_dwordx4 v[56:59], v2, s[24:27], s41 offen
    v_pk_mul_f32 v[64:65], v[200:201], s[42:43]
    v_pk_mul_f32 v[66:67], v[202:203], s[42:43]
    v_pk_mul_f32 v[68:69], v[208:209], s[42:43]
    v_pk_mul_f32 v[70:71], v[210:211], s[42:43]
    v_exp_f32 v64, v64
    v_exp_f32 v65, v65
    v_exp_f32 v66, v66
    v_exp_f32 v67, v67
    v_exp_f32 v68, v68
    v_exp_f32 v69, v69
    v_exp_f32 v70, v70
    v_exp_f32 v71, v71
    v_pk_mul_f32 v[200:201], v[200:201], v[204:205]
    v_pk_mul_f32 v[202:203], v[202:203], v[206:207]
    v_pk_mul_f32 v[208:209], v[208:209], v[212:213]
    v_pk_mul_f32 v[210:211], v[210:211], v[214:215]
    v_pk_add_f32 v[64:65], v[64:65], 1.0 op_sel_hi:[1,0]
    v_pk_add_f32 v[66:67], v[66:67], 1.0 op_sel_hi:[1,0]
    v_pk_add_f32 v[68:69], v[68:69], 1.0 op_sel_hi:[1,0]
    v_pk_add_f32 v[70:71], v[70:71], 1.0 op_sel_hi:[1,0]
    v_rcp_f32 v64, v64
    v_rcp_f32 v65, v65
    v_rcp_f32 v66, v66
    v_rcp_f32 v67, v67
    v_rcp_f32 v68, v68
    v_rcp_f32 v69, v69
    v_rcp_f32 v70, v70
    v_rcp_f32 v71, v71
    s_nop 0
    v_pk_mul_f32 v[64:65], v[200:201], v[64:65]
    v_pk_mul_f32 v[66:67], v[202:203], v[66:67]
    v_pk_mul_f32 v[68:69], v[208:209], v[68:69]
    v_pk_mul_f32 v[70:71], v[210:211], v[70:71]
    v_cvt_pk_bf16_f32 v72, v64, v65
    v_cvt_pk_bf16_f32 v73, v66, v67
    v_cvt_pk_bf16_f32 v74, v68, v69
    v_cvt_pk_bf16_f32 v75, v70, v71
    s_add_u32 s41, s39, 443392
    buffer_store_dwordx4 v[72:75], v2, s[24:27], s41 offen
gemm1_kernel_end:
    s_endpgm
.globl gemm2_kernel
.p2align 8
.type gemm2_kernel,@function
gemm2_kernel:
    s_cmp_ge_u32 s2, 256
    s_cbranch_scc1 gemm2_kernel_end
    s_load_dwordx2 s[6:7], s[0:1], 104
    s_load_dwordx2 s[8:9], s[0:1], 120
    v_lshrrev_b32 v2, 6, v0
    v_and_b32 v1, 63, v0
    s_nop 0
    v_readfirstlane_b32 s3, v2
    s_and_b32 s10, s2, 7
    s_lshr_b32 s11, s2, 3
    s_and_b32 s12, s11, 3
    s_and_b32 s13, s10, 1
    s_lshl_b32 s13, s13, 2
    s_add_u32 s12, s12, s13
    s_lshr_b32 s11, s11, 2
    s_lshr_b32 s10, s10, 1
    s_lshl_b32 s10, s10, 3
    s_add_u32 s11, s11, s10
    s_waitcnt lgkmcnt(0)

    s_add_u32 s16, s8, 9437184
    s_addc_u32 s17, s9, 0
    s_and_b32 s17, s17, 0xffff
    s_mov_b32 s18, 18874368
    s_mov_b32 s19, 0x00020000
    s_add_u32 s20, s8, 41943040
    s_addc_u32 s21, s9, 0
    s_and_b32 s21, s21, 0xffff
    s_mov_b32 s22, 5308416
    s_mov_b32 s23, 0x00020000
    s_mov_b32 s24, s6
    s_mov_b32 s25, s7
    s_and_b32 s25, s25, 0xffff
    s_mov_b32 s26, 2359296
    s_mov_b32 s27, 0x00020000
    s_add_u32 s28, s8, 3145728
    s_addc_u32 s29, s9, 0
    s_and_b32 s29, s29, 0xffff
    s_mov_b32 s30, 2359296
    s_mov_b32 s31, 0x00020000
    v_and_b32 v3, 15, v1
    v_lshrrev_b32 v4, 4, v1
    v_bfe_u32 v5, v1, 2, 2
    v_sub_u32 v5, 4, v5
    v_and_b32 v5, 3, v5
    v_xor_b32 v5, v5, v4
    v_lshlrev_b32 v5, 4, v5
    v_lshl_add_u32 v6, v3, 6, v5
    v_lshlrev_b32 v8, 4, v1
    s_mul_i32 s33, s11, 589824
    s_lshl_b32 s14, s3, 10
    s_add_u32 s33, s33, s14
    v_lshlrev_b32 v7, 3, v4
    v_add_u32 v7, v7, v3
    v_lshlrev_b32 v7, 4, v7
    v_cmp_gt_u32 vcc, 8, v3
    s_mov_b64 s[48:49], vcc
    s_mul_i32 s34, s12, 589824
    s_lshl_b32 s14, s3, 12
    s_add_u32 s34, s34, s14
    s_lshl_b32 s37, s12, 3
    s_add_u32 s37, s37, s3
    s_mul_i32 s37, s37, 9216
    s_add_u32 s37, s37, 4718592

    s_mul_i32 s46, s3, 20480
    v_add_u32 v10, s46, v6
    v_add_u32 v11, s46, v8
    v_and_b32 v12, 7, v3
    v_lshl_add_u32 v12, v4, 3, v12
    v_lshlrev_b32 v12, 4, v12
    v_add_u32 v12, s46, v12

    s_add_u32 m0, s46, 0
    s_add_u32 s35, s33, 0
    buffer_load_dwordx4 v8, s[16:19], s35 offen lds
    s_add_u32 m0, s46, 1024
    s_add_u32 s35, s33, 147456
    buffer_load_dwordx4 v8, s[16:19], s35 offen lds
    s_add_u32 m0, s46, 2048
    s_add_u32 s35, s33, 294912
    buffer_load_dwordx4 v8, s[16:19], s35 offen lds
    s_add_u32 m0, s46, 3072
    s_add_u32 s35, s33, 442368
    buffer_load_dwordx4 v8, s[16:19], s35 offen lds
    s_add_u32 m0, s46, 4096
    s_add_u32 s35, s34, 0
    buffer_load_dwordx4 v8, s[20:23], s35 offen lds
    s_add_u32 m0, s46, 5120
    s_add_u32 s35, s34, 1024
    buffer_load_dwordx4 v8, s[20:23], s35 offen lds
    s_add_u32 m0, s46, 6144
    s_add_u32 s35, s34, 2048
    buffer_load_dwordx4 v8, s[20:23], s35 offen lds
    s_add_u32 m0, s46, 7168
    s_add_u32 s35, s34, 3072
    buffer_load_dwordx4 v8, s[20:23], s35 offen lds
    s_add_u32 m0, s46, 16384
    s_add_u32 s35, s37, 0
    buffer_load_dwordx4 v8, s[20:23], s35 offen lds
    s_add_u32 m0, s46, 8192
    s_add_u32 s35, s33, 8192
    buffer_load_dwordx4 v8, s[16:19], s35 offen lds
    s_add_u32 m0, s46, 9216
    s_add_u32 s35, s33, 155648
    buffer_load_dwordx4 v8, s[16:19], s35 offen lds
    s_add_u32 m0, s46, 10240
    s_add_u32 s35, s33, 303104
    buffer_load_dwordx4 v8, s[16:19], s35 offen lds
    s_add_u32 m0, s46, 11264
    s_add_u32 s35, s33, 450560
    buffer_load_dwordx4 v8, s[16:19], s35 offen lds
    s_add_u32 m0, s46, 12288
    s_add_u32 s35, s34, 32768
    buffer_load_dwordx4 v8, s[20:23], s35 offen lds
    s_add_u32 m0, s46, 13312
    s_add_u32 s35, s34, 33792
    buffer_load_dwordx4 v8, s[20:23], s35 offen lds
    s_add_u32 m0, s46, 14336
    s_add_u32 s35, s34, 34816
    buffer_load_dwordx4 v8, s[20:23], s35 offen lds
    s_add_u32 m0, s46, 15360
    s_add_u32 s35, s34, 35840
    buffer_load_dwordx4 v8, s[20:23], s35 offen lds
    v_mov_b32 v64, 0
    v_mov_b32 v65, 0
    v_mov_b32 v66, 0
    v_mov_b32 v67, 0
    v_mov_b32 v68, 0
    v_mov_b32 v69, 0
    v_mov_b32 v70, 0
    v_mov_b32 v71, 0
    v_mov_b32 v72, 0
    v_mov_b32 v73, 0
    v_mov_b32 v74, 0
    v_mov_b32 v75, 0
    v_mov_b32 v76, 0
    v_mov_b32 v77, 0
    v_mov_b32 v78, 0
    v_mov_b32 v79, 0
    v_mov_b32 v80, 0
    v_mov_b32 v81, 0
    v_mov_b32 v82, 0
    v_mov_b32 v83, 0
    v_mov_b32 v84, 0
    v_mov_b32 v85, 0
    v_mov_b32 v86, 0
    v_mov_b32 v87, 0
    v_mov_b32 v88, 0
    v_mov_b32 v89, 0
    v_mov_b32 v90, 0
    v_mov_b32 v91, 0
    v_mov_b32 v92, 0
    v_mov_b32 v93, 0
    v_mov_b32 v94, 0
    v_mov_b32 v95, 0
    v_mov_b32 v96, 0
    v_mov_b32 v97, 0
    v_mov_b32 v98, 0
    v_mov_b32 v99, 0
    v_mov_b32 v100, 0
    v_mov_b32 v101, 0
    v_mov_b32 v102, 0
    v_mov_b32 v103, 0
    v_mov_b32 v104, 0
    v_mov_b32 v105, 0
    v_mov_b32 v106, 0
    v_mov_b32 v107, 0
    v_mov_b32 v108, 0
    v_mov_b32 v109, 0
    v_mov_b32 v110, 0
    v_mov_b32 v111, 0
    v_mov_b32 v112, 0
    v_mov_b32 v113, 0
    v_mov_b32 v114, 0
    v_mov_b32 v115, 0
    v_mov_b32 v116, 0
    v_mov_b32 v117, 0
    v_mov_b32 v118, 0
    v_mov_b32 v119, 0
    v_mov_b32 v120, 0
    v_mov_b32 v121, 0
    v_mov_b32 v122, 0
    v_mov_b32 v123, 0
    v_mov_b32 v124, 0
    v_mov_b32 v125, 0
    v_mov_b32 v126, 0
    v_mov_b32 v127, 0
    v_mov_b32 v128, 0
    v_mov_b32 v129, 0
    v_mov_b32 v130, 0
    v_mov_b32 v131, 0
    v_mov_b32 v132, 0
    v_mov_b32 v133, 0
    v_mov_b32 v134, 0
    v_mov_b32 v135, 0
    v_mov_b32 v136, 0
    v_mov_b32 v137, 0
    v_mov_b32 v138, 0
    v_mov_b32 v139, 0
    v_mov_b32 v140, 0
    v_mov_b32 v141, 0
    v_mov_b32 v142, 0
    v_mov_b32 v143, 0
    s_waitcnt vmcnt(8)
    ds_read_b128 v[144:147], v10 offset:0
    ds_read_b128 v[148:151], v10 offset:1024
    ds_read_b128 v[152:155], v10 offset:2048
    ds_read_b128 v[156:159], v10 offset:3072
    ds_read_b128 v[160:163], v11 offset:4096
    ds_read_b128 v[164:167], v11 offset:5120
    ds_read_b128 v[168:171], v11 offset:6144
    ds_read_b128 v[172:175], v11 offset:7168
    ds_read_b128 v[176:179], v12 offset:16384
    s_waitcnt lgkmcnt(0)
    v_mfma_f32_16x16x32_bf16 v[64:67], v[160:163], v[144:147], v[64:67]
    s_add_u32 m0, s46, 0
    s_add_u32 s35, s33, 16384
    buffer_load_dwordx4 v8, s[16:19], s35 offen lds
    v_mfma_f32_16x16x32_bf16 v[84:87], v[160:163], v[148:151], v[84:87]
    s_add_u32 m0, s46, 1024
    s_add_u32 s35, s33, 163840
    buffer_load_dwordx4 v8, s[16:19], s35 offen lds
    v_mfma_f32_16x16x32_bf16 v[104:107], v[160:163], v[152:155], v[104:107]
    s_add_u32 m0, s46, 2048
    s_add_u32 s35, s33, 311296
    buffer_load_dwordx4 v8, s[16:19], s35 offen lds
    v_mfma_f32_16x16x32_bf16 v[124:127], v[160:163], v[156:159], v[124:127]
    s_add_u32 m0, s46, 3072
    s_add_u32 s35, s33, 458752
    buffer_load_dwordx4 v8, s[16:19], s35 offen lds
    v_mfma_f32_16x16x32_bf16 v[68:71], v[164:167], v[144:147], v[68:71]
    s_add_u32 m0, s46, 4096
    s_add_u32 s35, s34, 65536
    buffer_load_dwordx4 v8, s[20:23], s35 offen lds
    v_mfma_f32_16x16x32_bf16 v[88:91], v[164:167], v[148:151], v[88:91]
    s_add_u32 m0, s46, 5120
    s_add_u32 s35, s34, 66560
    buffer_load_dwordx4 v8, s[20:23], s35 offen lds
    v_mfma_f32_16x16x32_bf16 v[108:111], v[164:167], v[152:155], v[108:111]
    s_add_u32 m0, s46, 6144
    s_add_u32 s35, s34, 67584
    buffer_load_dwordx4 v8, s[20:23], s35 offen lds
    v_mfma_f32_16x16x32_bf16 v[128:131], v[164:167], v[156:159], v[128:131]
    s_add_u32 m0, s46, 7168
    s_add_u32 s35, s34, 68608
    buffer_load_dwordx4 v8, s[20:23], s35 offen lds
    v_mfma_f32_16x16x32_bf16 v[72:75], v[168:171], v[144:147], v[72:75]
    s_add_u32 m0, s46, 17408
    s_add_u32 s35, s37, 1024
    buffer_load_dwordx4 v8, s[20:23], s35 offen lds
    v_mfma_f32_16x16x32_bf16 v[92:95], v[168:171], v[148:151], v[92:95]
    v_mfma_f32_16x16x32_bf16 v[112:115], v[168:171], v[152:155], v[112:115]
    v_mfma_f32_16x16x32_bf16 v[132:135], v[168:171], v[156:159], v[132:135]
    s_waitcnt vmcnt(9)
    ds_read_b128 v[180:183], v10 offset:8192
    ds_read_b128 v[184:187], v10 offset:9216
    ds_read_b128 v[188:191], v10 offset:10240
    ds_read_b128 v[192:195], v10 offset:11264
    ds_read_b128 v[196:199], v11 offset:12288
    ds_read_b128 v[200:203], v11 offset:13312
    ds_read_b128 v[204:207], v11 offset:14336
    ds_read_b128 v[208:211], v11 offset:15360
    ds_read_b128 v[212:215], v12 offset:16896
    v_mfma_f32_16x16x32_bf16 v[76:79], v[172:175], v[144:147], v[76:79]
    v_mfma_f32_16x16x32_bf16 v[96:99], v[172:175], v[148:151], v[96:99]
    v_mfma_f32_16x16x32_bf16 v[116:119], v[172:175], v[152:155], v[116:119]
    v_mfma_f32_16x16x32_bf16 v[136:139], v[172:175], v[156:159], v[136:139]
    v_mfma_f32_16x16x32_bf16 v[80:83], v[176:179], v[144:147], v[80:83]
    v_mfma_f32_16x16x32_bf16 v[100:103], v[176:179], v[148:151], v[100:103]
    v_mfma_f32_16x16x32_bf16 v[120:123], v[176:179], v[152:155], v[120:123]
    v_mfma_f32_16x16x32_bf16 v[140:143], v[176:179], v[156:159], v[140:143]
    s_waitcnt lgkmcnt(0)
    s_barrier
    v_mfma_f32_16x16x32_bf16 v[64:67], v[196:199], v[180:183], v[64:67]
    s_add_u32 m0, s46, 8192
    s_add_u32 s35, s33, 24576
    buffer_load_dwordx4 v8, s[16:19], s35 offen lds
    v_mfma_f32_16x16x32_bf16 v[84:87], v[196:199], v[184:187], v[84:87]
    s_add_u32 m0, s46, 9216
    s_add_u32 s35, s33, 172032
    buffer_load_dwordx4 v8, s[16:19], s35 offen lds
    v_mfma_f32_16x16x32_bf16 v[104:107], v[196:199], v[188:191], v[104:107]
    s_add_u32 m0, s46, 10240
    s_add_u32 s35, s33, 319488
    buffer_load_dwordx4 v8, s[16:19], s35 offen lds
    v_mfma_f32_16x16x32_bf16 v[124:127], v[196:199], v[192:195], v[124:127]
    s_add_u32 m0, s46, 11264
    s_add_u32 s35, s33, 466944
    buffer_load_dwordx4 v8, s[16:19], s35 offen lds
    v_mfma_f32_16x16x32_bf16 v[68:71], v[200:203], v[180:183], v[68:71]
    s_add_u32 m0, s46, 12288
    s_add_u32 s35, s34, 98304
    buffer_load_dwordx4 v8, s[20:23], s35 offen lds
    v_mfma_f32_16x16x32_bf16 v[88:91], v[200:203], v[184:187], v[88:91]
    s_add_u32 m0, s46, 13312
    s_add_u32 s35, s34, 99328
    buffer_load_dwordx4 v8, s[20:23], s35 offen lds
    v_mfma_f32_16x16x32_bf16 v[108:111], v[200:203], v[188:191], v[108:111]
    s_add_u32 m0, s46, 14336
    s_add_u32 s35, s34, 100352
    buffer_load_dwordx4 v8, s[20:23], s35 offen lds
    v_mfma_f32_16x16x32_bf16 v[128:131], v[200:203], v[192:195], v[128:131]
    s_add_u32 m0, s46, 15360
    s_add_u32 s35, s34, 101376
    buffer_load_dwordx4 v8, s[20:23], s35 offen lds
    v_mfma_f32_16x16x32_bf16 v[72:75], v[204:207], v[180:183], v[72:75]
    v_mfma_f32_16x16x32_bf16 v[92:95], v[204:207], v[184:187], v[92:95]
    v_mfma_f32_16x16x32_bf16 v[112:115], v[204:207], v[188:191], v[112:115]
    v_mfma_f32_16x16x32_bf16 v[132:135], v[204:207], v[192:195], v[132:135]
    s_waitcnt vmcnt(8)
    ds_read_b128 v[144:147], v10 offset:0
    ds_read_b128 v[148:151], v10 offset:1024
    ds_read_b128 v[152:155], v10 offset:2048
    ds_read_b128 v[156:159], v10 offset:3072
    ds_read_b128 v[160:163], v11 offset:4096
    ds_read_b128 v[164:167], v11 offset:5120
    ds_read_b128 v[168:171], v11 offset:6144
    ds_read_b128 v[172:175], v11 offset:7168
    ds_read_b128 v[176:179], v12 offset:17408
    v_mfma_f32_16x16x32_bf16 v[76:79], v[208:211], v[180:183], v[76:79]
    v_mfma_f32_16x16x32_bf16 v[96:99], v[208:211], v[184:187], v[96:99]
    v_mfma_f32_16x16x32_bf16 v[116:119], v[208:211], v[188:191], v[116:119]
    v_mfma_f32_16x16x32_bf16 v[136:139], v[208:211], v[192:195], v[136:139]
    v_mfma_f32_16x16x32_bf16 v[80:83], v[212:215], v[180:183], v[80:83]
    v_mfma_f32_16x16x32_bf16 v[100:103], v[212:215], v[184:187], v[100:103]
    v_mfma_f32_16x16x32_bf16 v[120:123], v[212:215], v[188:191], v[120:123]
    v_mfma_f32_16x16x32_bf16 v[140:143], v[212:215], v[192:195], v[140:143]
    s_waitcnt lgkmcnt(0)
    v_mfma_f32_16x16x32_bf16 v[64:67], v[160:163], v[144:147], v[64:67]
    s_add_u32 m0, s46, 0
    s_add_u32 s35, s33, 32768
    buffer_load_dwordx4 v8, s[16:19], s35 offen lds
    v_mfma_f32_16x16x32_bf16 v[84:87], v[160:163], v[148:151], v[84:87]
    s_add_u32 m0, s46, 1024
    s_add_u32 s35, s33, 180224
    buffer_load_dwordx4 v8, s[16:19], s35 offen lds
    v_mfma_f32_16x16x32_bf16 v[104:107], v[160:163], v[152:155], v[104:107]
    s_add_u32 m0, s46, 2048
    s_add_u32 s35, s33, 327680
    buffer_load_dwordx4 v8, s[16:19], s35 offen lds
    v_mfma_f32_16x16x32_bf16 v[124:127], v[160:163], v[156:159], v[124:127]
    s_add_u32 m0, s46, 3072
    s_add_u32 s35, s33, 475136
    buffer_load_dwordx4 v8, s[16:19], s35 offen lds
    v_mfma_f32_16x16x32_bf16 v[68:71], v[164:167], v[144:147], v[68:71]
    s_add_u32 m0, s46, 4096
    s_add_u32 s35, s34, 131072
    buffer_load_dwordx4 v8, s[20:23], s35 offen lds
    v_mfma_f32_16x16x32_bf16 v[88:91], v[164:167], v[148:151], v[88:91]
    s_add_u32 m0, s46, 5120
    s_add_u32 s35, s34, 132096
    buffer_load_dwordx4 v8, s[20:23], s35 offen lds
    v_mfma_f32_16x16x32_bf16 v[108:111], v[164:167], v[152:155], v[108:111]
    s_add_u32 m0, s46, 6144
    s_add_u32 s35, s34, 133120
    buffer_load_dwordx4 v8, s[20:23], s35 offen lds
    v_mfma_f32_16x16x32_bf16 v[128:131], v[164:167], v[156:159], v[128:131]
    s_add_u32 m0, s46, 7168
    s_add_u32 s35, s34, 134144
    buffer_load_dwordx4 v8, s[20:23], s35 offen lds
    v_mfma_f32_16x16x32_bf16 v[72:75], v[168:171], v[144:147], v[72:75]
    s_add_u32 m0, s46, 16384
    s_add_u32 s35, s37, 2048
    buffer_load_dwordx4 v8, s[20:23], s35 offen lds
    v_mfma_f32_16x16x32_bf16 v[92:95], v[168:171], v[148:151], v[92:95]
    v_mfma_f32_16x16x32_bf16 v[112:115], v[168:171], v[152:155], v[112:115]
    v_mfma_f32_16x16x32_bf16 v[132:135], v[168:171], v[156:159], v[132:135]
    s_waitcnt vmcnt(9)
    ds_read_b128 v[180:183], v10 offset:8192
    ds_read_b128 v[184:187], v10 offset:9216
    ds_read_b128 v[188:191], v10 offset:10240
    ds_read_b128 v[192:195], v10 offset:11264
    ds_read_b128 v[196:199], v11 offset:12288
    ds_read_b128 v[200:203], v11 offset:13312
    ds_read_b128 v[204:207], v11 offset:14336
    ds_read_b128 v[208:211], v11 offset:15360
    ds_read_b128 v[212:215], v12 offset:17920
    v_mfma_f32_16x16x32_bf16 v[76:79], v[172:175], v[144:147], v[76:79]
    v_mfma_f32_16x16x32_bf16 v[96:99], v[172:175], v[148:151], v[96:99]
    v_mfma_f32_16x16x32_bf16 v[116:119], v[172:175], v[152:155], v[116:119]
    v_mfma_f32_16x16x32_bf16 v[136:139], v[172:175], v[156:159], v[136:139]
    v_mfma_f32_16x16x32_bf16 v[80:83], v[176:179], v[144:147], v[80:83]
    v_mfma_f32_16x16x32_bf16 v[100:103], v[176:179], v[148:151], v[100:103]
    v_mfma_f32_16x16x32_bf16 v[120:123], v[176:179], v[152:155], v[120:123]
    v_mfma_f32_16x16x32_bf16 v[140:143], v[176:179], v[156:159], v[140:143]
    s_waitcnt lgkmcnt(0)
    s_barrier
    v_mfma_f32_16x16x32_bf16 v[64:67], v[196:199], v[180:183], v[64:67]
    s_add_u32 m0, s46, 8192
    s_add_u32 s35, s33, 40960
    buffer_load_dwordx4 v8, s[16:19], s35 offen lds
    v_mfma_f32_16x16x32_bf16 v[84:87], v[196:199], v[184:187], v[84:87]
    s_add_u32 m0, s46, 9216
    s_add_u32 s35, s33, 188416
    buffer_load_dwordx4 v8, s[16:19], s35 offen lds
    v_mfma_f32_16x16x32_bf16 v[104:107], v[196:199], v[188:191], v[104:107]
    s_add_u32 m0, s46, 10240
    s_add_u32 s35, s33, 335872
    buffer_load_dwordx4 v8, s[16:19], s35 offen lds
    v_mfma_f32_16x16x32_bf16 v[124:127], v[196:199], v[192:195], v[124:127]
    s_add_u32 m0, s46, 11264
    s_add_u32 s35, s33, 483328
    buffer_load_dwordx4 v8, s[16:19], s35 offen lds
    v_mfma_f32_16x16x32_bf16 v[68:71], v[200:203], v[180:183], v[68:71]
    s_add_u32 m0, s46, 12288
    s_add_u32 s35, s34, 163840
    buffer_load_dwordx4 v8, s[20:23], s35 offen lds
    v_mfma_f32_16x16x32_bf16 v[88:91], v[200:203], v[184:187], v[88:91]
    s_add_u32 m0, s46, 13312
    s_add_u32 s35, s34, 164864
    buffer_load_dwordx4 v8, s[20:23], s35 offen lds
    v_mfma_f32_16x16x32_bf16 v[108:111], v[200:203], v[188:191], v[108:111]
    s_add_u32 m0, s46, 14336
    s_add_u32 s35, s34, 165888
    buffer_load_dwordx4 v8, s[20:23], s35 offen lds
    v_mfma_f32_16x16x32_bf16 v[128:131], v[200:203], v[192:195], v[128:131]
    s_add_u32 m0, s46, 15360
    s_add_u32 s35, s34, 166912
    buffer_load_dwordx4 v8, s[20:23], s35 offen lds
    v_mfma_f32_16x16x32_bf16 v[72:75], v[204:207], v[180:183], v[72:75]
    v_mfma_f32_16x16x32_bf16 v[92:95], v[204:207], v[184:187], v[92:95]
    v_mfma_f32_16x16x32_bf16 v[112:115], v[204:207], v[188:191], v[112:115]
    v_mfma_f32_16x16x32_bf16 v[132:135], v[204:207], v[192:195], v[132:135]
    s_waitcnt vmcnt(8)
    ds_read_b128 v[144:147], v10 offset:0
    ds_read_b128 v[148:151], v10 offset:1024
    ds_read_b128 v[152:155], v10 offset:2048
    ds_read_b128 v[156:159], v10 offset:3072
    ds_read_b128 v[160:163], v11 offset:4096
    ds_read_b128 v[164:167], v11 offset:5120
    ds_read_b128 v[168:171], v11 offset:6144
    ds_read_b128 v[172:175], v11 offset:7168
    ds_read_b128 v[176:179], v12 offset:16384
    v_mfma_f32_16x16x32_bf16 v[76:79], v[208:211], v[180:183], v[76:79]
    v_mfma_f32_16x16x32_bf16 v[96:99], v[208:211], v[184:187], v[96:99]
    v_mfma_f32_16x16x32_bf16 v[116:119], v[208:211], v[188:191], v[116:119]
    v_mfma_f32_16x16x32_bf16 v[136:139], v[208:211], v[192:195], v[136:139]
    v_mfma_f32_16x16x32_bf16 v[80:83], v[212:215], v[180:183], v[80:83]
    v_mfma_f32_16x16x32_bf16 v[100:103], v[212:215], v[184:187], v[100:103]
    v_mfma_f32_16x16x32_bf16 v[120:123], v[212:215], v[188:191], v[120:123]
    v_mfma_f32_16x16x32_bf16 v[140:143], v[212:215], v[192:195], v[140:143]
    s_waitcnt lgkmcnt(0)
    v_mfma_f32_16x16x32_bf16 v[64:67], v[160:163], v[144:147], v[64:67]
    s_add_u32 m0, s46, 0
    s_add_u32 s35, s33, 49152
    buffer_load_dwordx4 v8, s[16:19], s35 offen lds
    v_mfma_f32_16x16x32_bf16 v[84:87], v[160:163], v[148:151], v[84:87]
    s_add_u32 m0, s46, 1024
    s_add_u32 s35, s33, 196608
    buffer_load_dwordx4 v8, s[16:19], s35 offen lds
    v_mfma_f32_16x16x32_bf16 v[104:107], v[160:163], v[152:155], v[104:107]
    s_add_u32 m0, s46, 2048
    s_add_u32 s35, s33, 344064
    buffer_load_dwordx4 v8, s[16:19], s35 offen lds
    v_mfma_f32_16x16x32_bf16 v[124:127], v[160:163], v[156:159], v[124:127]
    s_add_u32 m0, s46, 3072
    s_add_u32 s35, s33, 491520
    buffer_load_dwordx4 v8, s[16:19], s35 offen lds
    v_mfma_f32_16x16x32_bf16 v[68:71], v[164:167], v[144:147], v[68:71]
    s_add_u32 m0, s46, 4096
    s_add_u32 s35, s34, 196608
    buffer_load_dwordx4 v8, s[20:23], s35 offen lds
    v_mfma_f32_16x16x32_bf16 v[88:91], v[164:167], v[148:151], v[88:91]
    s_add_u32 m0, s46, 5120
    s_add_u32 s35, s34, 197632
    buffer_load_dwordx4 v8, s[20:23], s35 offen lds
    v_mfma_f32_16x16x32_bf16 v[108:111], v[164:167], v[152:155], v[108:111]
    s_add_u32 m0, s46, 6144
    s_add_u32 s35, s34, 198656
    buffer_load_dwordx4 v8, s[20:23], s35 offen lds
    v_mfma_f32_16x16x32_bf16 v[128:131], v[164:167], v[156:159], v[128:131]
    s_add_u32 m0, s46, 7168
    s_add_u32 s35, s34, 199680
    buffer_load_dwordx4 v8, s[20:23], s35 offen lds
    v_mfma_f32_16x16x32_bf16 v[72:75], v[168:171], v[144:147], v[72:75]
    s_add_u32 m0, s46, 17408
    s_add_u32 s35, s37, 3072
    buffer_load_dwordx4 v8, s[20:23], s35 offen lds
    v_mfma_f32_16x16x32_bf16 v[92:95], v[168:171], v[148:151], v[92:95]
    v_mfma_f32_16x16x32_bf16 v[112:115], v[168:171], v[152:155], v[112:115]
    v_mfma_f32_16x16x32_bf16 v[132:135], v[168:171], v[156:159], v[132:135]
    s_waitcnt vmcnt(9)
    ds_read_b128 v[180:183], v10 offset:8192
    ds_read_b128 v[184:187], v10 offset:9216
    ds_read_b128 v[188:191], v10 offset:10240
    ds_read_b128 v[192:195], v10 offset:11264
    ds_read_b128 v[196:199], v11 offset:12288
    ds_read_b128 v[200:203], v11 offset:13312
    ds_read_b128 v[204:207], v11 offset:14336
    ds_read_b128 v[208:211], v11 offset:15360
    ds_read_b128 v[212:215], v12 offset:16896
    v_mfma_f32_16x16x32_bf16 v[76:79], v[172:175], v[144:147], v[76:79]
    v_mfma_f32_16x16x32_bf16 v[96:99], v[172:175], v[148:151], v[96:99]
    v_mfma_f32_16x16x32_bf16 v[116:119], v[172:175], v[152:155], v[116:119]
    v_mfma_f32_16x16x32_bf16 v[136:139], v[172:175], v[156:159], v[136:139]
    v_mfma_f32_16x16x32_bf16 v[80:83], v[176:179], v[144:147], v[80:83]
    v_mfma_f32_16x16x32_bf16 v[100:103], v[176:179], v[148:151], v[100:103]
    v_mfma_f32_16x16x32_bf16 v[120:123], v[176:179], v[152:155], v[120:123]
    v_mfma_f32_16x16x32_bf16 v[140:143], v[176:179], v[156:159], v[140:143]
    s_waitcnt lgkmcnt(0)
    s_barrier
    v_mfma_f32_16x16x32_bf16 v[64:67], v[196:199], v[180:183], v[64:67]
    s_add_u32 m0, s46, 8192
    s_add_u32 s35, s33, 57344
    buffer_load_dwordx4 v8, s[16:19], s35 offen lds
    v_mfma_f32_16x16x32_bf16 v[84:87], v[196:199], v[184:187], v[84:87]
    s_add_u32 m0, s46, 9216
    s_add_u32 s35, s33, 204800
    buffer_load_dwordx4 v8, s[16:19], s35 offen lds
    v_mfma_f32_16x16x32_bf16 v[104:107], v[196:199], v[188:191], v[104:107]
    s_add_u32 m0, s46, 10240
    s_add_u32 s35, s33, 352256
    buffer_load_dwordx4 v8, s[16:19], s35 offen lds
    v_mfma_f32_16x16x32_bf16 v[124:127], v[196:199], v[192:195], v[124:127]
    s_add_u32 m0, s46, 11264
    s_add_u32 s35, s33, 499712
    buffer_load_dwordx4 v8, s[16:19], s35 offen lds
    v_mfma_f32_16x16x32_bf16 v[68:71], v[200:203], v[180:183], v[68:71]
    s_add_u32 m0, s46, 12288
    s_add_u32 s35, s34, 229376
    buffer_load_dwordx4 v8, s[20:23], s35 offen lds
    v_mfma_f32_16x16x32_bf16 v[88:91], v[200:203], v[184:187], v[88:91]
    s_add_u32 m0, s46, 13312
    s_add_u32 s35, s34, 230400
    buffer_load_dwordx4 v8, s[20:23], s35 offen lds
    v_mfma_f32_16x16x32_bf16 v[108:111], v[200:203], v[188:191], v[108:111]
    s_add_u32 m0, s46, 14336
    s_add_u32 s35, s34, 231424
    buffer_load_dwordx4 v8, s[20:23], s35 offen lds
    v_mfma_f32_16x16x32_bf16 v[128:131], v[200:203], v[192:195], v[128:131]
    s_add_u32 m0, s46, 15360
    s_add_u32 s35, s34, 232448
    buffer_load_dwordx4 v8, s[20:23], s35 offen lds
    v_mfma_f32_16x16x32_bf16 v[72:75], v[204:207], v[180:183], v[72:75]
    v_mfma_f32_16x16x32_bf16 v[92:95], v[204:207], v[184:187], v[92:95]
    v_mfma_f32_16x16x32_bf16 v[112:115], v[204:207], v[188:191], v[112:115]
    v_mfma_f32_16x16x32_bf16 v[132:135], v[204:207], v[192:195], v[132:135]
    s_waitcnt vmcnt(8)
    ds_read_b128 v[144:147], v10 offset:0
    ds_read_b128 v[148:151], v10 offset:1024
    ds_read_b128 v[152:155], v10 offset:2048
    ds_read_b128 v[156:159], v10 offset:3072
    ds_read_b128 v[160:163], v11 offset:4096
    ds_read_b128 v[164:167], v11 offset:5120
    ds_read_b128 v[168:171], v11 offset:6144
    ds_read_b128 v[172:175], v11 offset:7168
    ds_read_b128 v[176:179], v12 offset:17408
    v_mfma_f32_16x16x32_bf16 v[76:79], v[208:211], v[180:183], v[76:79]
    v_mfma_f32_16x16x32_bf16 v[96:99], v[208:211], v[184:187], v[96:99]
    v_mfma_f32_16x16x32_bf16 v[116:119], v[208:211], v[188:191], v[116:119]
    v_mfma_f32_16x16x32_bf16 v[136:139], v[208:211], v[192:195], v[136:139]
    v_mfma_f32_16x16x32_bf16 v[80:83], v[212:215], v[180:183], v[80:83]
    v_mfma_f32_16x16x32_bf16 v[100:103], v[212:215], v[184:187], v[100:103]
    v_mfma_f32_16x16x32_bf16 v[120:123], v[212:215], v[188:191], v[120:123]
    v_mfma_f32_16x16x32_bf16 v[140:143], v[212:215], v[192:195], v[140:143]
    s_waitcnt lgkmcnt(0)
    v_mfma_f32_16x16x32_bf16 v[64:67], v[160:163], v[144:147], v[64:67]
    s_add_u32 m0, s46, 0
    s_add_u32 s35, s33, 65536
    buffer_load_dwordx4 v8, s[16:19], s35 offen lds
    v_mfma_f32_16x16x32_bf16 v[84:87], v[160:163], v[148:151], v[84:87]
    s_add_u32 m0, s46, 1024
    s_add_u32 s35, s33, 212992
    buffer_load_dwordx4 v8, s[16:19], s35 offen lds
    v_mfma_f32_16x16x32_bf16 v[104:107], v[160:163], v[152:155], v[104:107]
    s_add_u32 m0, s46, 2048
    s_add_u32 s35, s33, 360448
    buffer_load_dwordx4 v8, s[16:19], s35 offen lds
    v_mfma_f32_16x16x32_bf16 v[124:127], v[160:163], v[156:159], v[124:127]
    s_add_u32 m0, s46, 3072
    s_add_u32 s35, s33, 507904
    buffer_load_dwordx4 v8, s[16:19], s35 offen lds
    v_mfma_f32_16x16x32_bf16 v[68:71], v[164:167], v[144:147], v[68:71]
    s_add_u32 m0, s46, 4096
    s_add_u32 s35, s34, 262144
    buffer_load_dwordx4 v8, s[20:23], s35 offen lds
    v_mfma_f32_16x16x32_bf16 v[88:91], v[164:167], v[148:151], v[88:91]
    s_add_u32 m0, s46, 5120
    s_add_u32 s35, s34, 263168
    buffer_load_dwordx4 v8, s[20:23], s35 offen lds
    v_mfma_f32_16x16x32_bf16 v[108:111], v[164:167], v[152:155], v[108:111]
    s_add_u32 m0, s46, 6144
    s_add_u32 s35, s34, 264192
    buffer_load_dwordx4 v8, s[20:23], s35 offen lds
    v_mfma_f32_16x16x32_bf16 v[128:131], v[164:167], v[156:159], v[128:131]
    s_add_u32 m0, s46, 7168
    s_add_u32 s35, s34, 265216
    buffer_load_dwordx4 v8, s[20:23], s35 offen lds
    v_mfma_f32_16x16x32_bf16 v[72:75], v[168:171], v[144:147], v[72:75]
    s_add_u32 m0, s46, 16384
    s_add_u32 s35, s37, 4096
    buffer_load_dwordx4 v8, s[20:23], s35 offen lds
    v_mfma_f32_16x16x32_bf16 v[92:95], v[168:171], v[148:151], v[92:95]
    v_mfma_f32_16x16x32_bf16 v[112:115], v[168:171], v[152:155], v[112:115]
    v_mfma_f32_16x16x32_bf16 v[132:135], v[168:171], v[156:159], v[132:135]
    s_waitcnt vmcnt(9)
    ds_read_b128 v[180:183], v10 offset:8192
    ds_read_b128 v[184:187], v10 offset:9216
    ds_read_b128 v[188:191], v10 offset:10240
    ds_read_b128 v[192:195], v10 offset:11264
    ds_read_b128 v[196:199], v11 offset:12288
    ds_read_b128 v[200:203], v11 offset:13312
    ds_read_b128 v[204:207], v11 offset:14336
    ds_read_b128 v[208:211], v11 offset:15360
    ds_read_b128 v[212:215], v12 offset:17920
    v_mfma_f32_16x16x32_bf16 v[76:79], v[172:175], v[144:147], v[76:79]
    v_mfma_f32_16x16x32_bf16 v[96:99], v[172:175], v[148:151], v[96:99]
    v_mfma_f32_16x16x32_bf16 v[116:119], v[172:175], v[152:155], v[116:119]
    v_mfma_f32_16x16x32_bf16 v[136:139], v[172:175], v[156:159], v[136:139]
    v_mfma_f32_16x16x32_bf16 v[80:83], v[176:179], v[144:147], v[80:83]
    v_mfma_f32_16x16x32_bf16 v[100:103], v[176:179], v[148:151], v[100:103]
    v_mfma_f32_16x16x32_bf16 v[120:123], v[176:179], v[152:155], v[120:123]
    v_mfma_f32_16x16x32_bf16 v[140:143], v[176:179], v[156:159], v[140:143]
    s_waitcnt lgkmcnt(0)
    s_barrier
    v_mfma_f32_16x16x32_bf16 v[64:67], v[196:199], v[180:183], v[64:67]
    s_add_u32 m0, s46, 8192
    s_add_u32 s35, s33, 73728
    buffer_load_dwordx4 v8, s[16:19], s35 offen lds
    v_mfma_f32_16x16x32_bf16 v[84:87], v[196:199], v[184:187], v[84:87]
    s_add_u32 m0, s46, 9216
    s_add_u32 s35, s33, 221184
    buffer_load_dwordx4 v8, s[16:19], s35 offen lds
    v_mfma_f32_16x16x32_bf16 v[104:107], v[196:199], v[188:191], v[104:107]
    s_add_u32 m0, s46, 10240
    s_add_u32 s35, s33, 368640
    buffer_load_dwordx4 v8, s[16:19], s35 offen lds
    v_mfma_f32_16x16x32_bf16 v[124:127], v[196:199], v[192:195], v[124:127]
    s_add_u32 m0, s46, 11264
    s_add_u32 s35, s33, 516096
    buffer_load_dwordx4 v8, s[16:19], s35 offen lds
    v_mfma_f32_16x16x32_bf16 v[68:71], v[200:203], v[180:183], v[68:71]
    s_add_u32 m0, s46, 12288
    s_add_u32 s35, s34, 294912
    buffer_load_dwordx4 v8, s[20:23], s35 offen lds
    v_mfma_f32_16x16x32_bf16 v[88:91], v[200:203], v[184:187], v[88:91]
    s_add_u32 m0, s46, 13312
    s_add_u32 s35, s34, 295936
    buffer_load_dwordx4 v8, s[20:23], s35 offen lds
    v_mfma_f32_16x16x32_bf16 v[108:111], v[200:203], v[188:191], v[108:111]
    s_add_u32 m0, s46, 14336
    s_add_u32 s35, s34, 296960
    buffer_load_dwordx4 v8, s[20:23], s35 offen lds
    v_mfma_f32_16x16x32_bf16 v[128:131], v[200:203], v[192:195], v[128:131]
    s_add_u32 m0, s46, 15360
    s_add_u32 s35, s34, 297984
    buffer_load_dwordx4 v8, s[20:23], s35 offen lds
    v_mfma_f32_16x16x32_bf16 v[72:75], v[204:207], v[180:183], v[72:75]
    v_mfma_f32_16x16x32_bf16 v[92:95], v[204:207], v[184:187], v[92:95]
    v_mfma_f32_16x16x32_bf16 v[112:115], v[204:207], v[188:191], v[112:115]
    v_mfma_f32_16x16x32_bf16 v[132:135], v[204:207], v[192:195], v[132:135]
    s_waitcnt vmcnt(8)
    ds_read_b128 v[144:147], v10 offset:0
    ds_read_b128 v[148:151], v10 offset:1024
    ds_read_b128 v[152:155], v10 offset:2048
    ds_read_b128 v[156:159], v10 offset:3072
    ds_read_b128 v[160:163], v11 offset:4096
    ds_read_b128 v[164:167], v11 offset:5120
    ds_read_b128 v[168:171], v11 offset:6144
    ds_read_b128 v[172:175], v11 offset:7168
    ds_read_b128 v[176:179], v12 offset:16384
    v_mfma_f32_16x16x32_bf16 v[76:79], v[208:211], v[180:183], v[76:79]
    v_mfma_f32_16x16x32_bf16 v[96:99], v[208:211], v[184:187], v[96:99]
    v_mfma_f32_16x16x32_bf16 v[116:119], v[208:211], v[188:191], v[116:119]
    v_mfma_f32_16x16x32_bf16 v[136:139], v[208:211], v[192:195], v[136:139]
    v_mfma_f32_16x16x32_bf16 v[80:83], v[212:215], v[180:183], v[80:83]
    v_mfma_f32_16x16x32_bf16 v[100:103], v[212:215], v[184:187], v[100:103]
    v_mfma_f32_16x16x32_bf16 v[120:123], v[212:215], v[188:191], v[120:123]
    v_mfma_f32_16x16x32_bf16 v[140:143], v[212:215], v[192:195], v[140:143]
    s_waitcnt lgkmcnt(0)
    v_mfma_f32_16x16x32_bf16 v[64:67], v[160:163], v[144:147], v[64:67]
    s_add_u32 m0, s46, 0
    s_add_u32 s35, s33, 81920
    buffer_load_dwordx4 v8, s[16:19], s35 offen lds
    v_mfma_f32_16x16x32_bf16 v[84:87], v[160:163], v[148:151], v[84:87]
    s_add_u32 m0, s46, 1024
    s_add_u32 s35, s33, 229376
    buffer_load_dwordx4 v8, s[16:19], s35 offen lds
    v_mfma_f32_16x16x32_bf16 v[104:107], v[160:163], v[152:155], v[104:107]
    s_add_u32 m0, s46, 2048
    s_add_u32 s35, s33, 376832
    buffer_load_dwordx4 v8, s[16:19], s35 offen lds
    v_mfma_f32_16x16x32_bf16 v[124:127], v[160:163], v[156:159], v[124:127]
    s_add_u32 m0, s46, 3072
    s_add_u32 s35, s33, 524288
    buffer_load_dwordx4 v8, s[16:19], s35 offen lds
    v_mfma_f32_16x16x32_bf16 v[68:71], v[164:167], v[144:147], v[68:71]
    s_add_u32 m0, s46, 4096
    s_add_u32 s35, s34, 327680
    buffer_load_dwordx4 v8, s[20:23], s35 offen lds
    v_mfma_f32_16x16x32_bf16 v[88:91], v[164:167], v[148:151], v[88:91]
    s_add_u32 m0, s46, 5120
    s_add_u32 s35, s34, 328704
    buffer_load_dwordx4 v8, s[20:23], s35 offen lds
    v_mfma_f32_16x16x32_bf16 v[108:111], v[164:167], v[152:155], v[108:111]
    s_add_u32 m0, s46, 6144
    s_add_u32 s35, s34, 329728
    buffer_load_dwordx4 v8, s[20:23], s35 offen lds
    v_mfma_f32_16x16x32_bf16 v[128:131], v[164:167], v[156:159], v[128:131]
    s_add_u32 m0, s46, 7168
    s_add_u32 s35, s34, 330752
    buffer_load_dwordx4 v8, s[20:23], s35 offen lds
    v_mfma_f32_16x16x32_bf16 v[72:75], v[168:171], v[144:147], v[72:75]
    s_add_u32 m0, s46, 17408
    s_add_u32 s35, s37, 5120
    buffer_load_dwordx4 v8, s[20:23], s35 offen lds
    v_mfma_f32_16x16x32_bf16 v[92:95], v[168:171], v[148:151], v[92:95]
    v_mfma_f32_16x16x32_bf16 v[112:115], v[168:171], v[152:155], v[112:115]
    v_mfma_f32_16x16x32_bf16 v[132:135], v[168:171], v[156:159], v[132:135]
    s_waitcnt vmcnt(9)
    ds_read_b128 v[180:183], v10 offset:8192
    ds_read_b128 v[184:187], v10 offset:9216
    ds_read_b128 v[188:191], v10 offset:10240
    ds_read_b128 v[192:195], v10 offset:11264
    ds_read_b128 v[196:199], v11 offset:12288
    ds_read_b128 v[200:203], v11 offset:13312
    ds_read_b128 v[204:207], v11 offset:14336
    ds_read_b128 v[208:211], v11 offset:15360
    ds_read_b128 v[212:215], v12 offset:16896
    v_mfma_f32_16x16x32_bf16 v[76:79], v[172:175], v[144:147], v[76:79]
    v_mfma_f32_16x16x32_bf16 v[96:99], v[172:175], v[148:151], v[96:99]
    v_mfma_f32_16x16x32_bf16 v[116:119], v[172:175], v[152:155], v[116:119]
    v_mfma_f32_16x16x32_bf16 v[136:139], v[172:175], v[156:159], v[136:139]
    v_mfma_f32_16x16x32_bf16 v[80:83], v[176:179], v[144:147], v[80:83]
    v_mfma_f32_16x16x32_bf16 v[100:103], v[176:179], v[148:151], v[100:103]
    v_mfma_f32_16x16x32_bf16 v[120:123], v[176:179], v[152:155], v[120:123]
    v_mfma_f32_16x16x32_bf16 v[140:143], v[176:179], v[156:159], v[140:143]
    s_waitcnt lgkmcnt(0)
    s_barrier
    v_mfma_f32_16x16x32_bf16 v[64:67], v[196:199], v[180:183], v[64:67]
    s_add_u32 m0, s46, 8192
    s_add_u32 s35, s33, 90112
    buffer_load_dwordx4 v8, s[16:19], s35 offen lds
    v_mfma_f32_16x16x32_bf16 v[84:87], v[196:199], v[184:187], v[84:87]
    s_add_u32 m0, s46, 9216
    s_add_u32 s35, s33, 237568
    buffer_load_dwordx4 v8, s[16:19], s35 offen lds
    v_mfma_f32_16x16x32_bf16 v[104:107], v[196:199], v[188:191], v[104:107]
    s_add_u32 m0, s46, 10240
    s_add_u32 s35, s33, 385024
    buffer_load_dwordx4 v8, s[16:19], s35 offen lds
    v_mfma_f32_16x16x32_bf16 v[124:127], v[196:199], v[192:195], v[124:127]
    s_add_u32 m0, s46, 11264
    s_add_u32 s35, s33, 532480
    buffer_load_dwordx4 v8, s[16:19], s35 offen lds
    v_mfma_f32_16x16x32_bf16 v[68:71], v[200:203], v[180:183], v[68:71]
    s_add_u32 m0, s46, 12288
    s_add_u32 s35, s34, 360448
    buffer_load_dwordx4 v8, s[20:23], s35 offen lds
    v_mfma_f32_16x16x32_bf16 v[88:91], v[200:203], v[184:187], v[88:91]
    s_add_u32 m0, s46, 13312
    s_add_u32 s35, s34, 361472
    buffer_load_dwordx4 v8, s[20:23], s35 offen lds
    v_mfma_f32_16x16x32_bf16 v[108:111], v[200:203], v[188:191], v[108:111]
    s_add_u32 m0, s46, 14336
    s_add_u32 s35, s34, 362496
    buffer_load_dwordx4 v8, s[20:23], s35 offen lds
    v_mfma_f32_16x16x32_bf16 v[128:131], v[200:203], v[192:195], v[128:131]
    s_add_u32 m0, s46, 15360
    s_add_u32 s35, s34, 363520
    buffer_load_dwordx4 v8, s[20:23], s35 offen lds
    v_mfma_f32_16x16x32_bf16 v[72:75], v[204:207], v[180:183], v[72:75]
    v_mfma_f32_16x16x32_bf16 v[92:95], v[204:207], v[184:187], v[92:95]
    v_mfma_f32_16x16x32_bf16 v[112:115], v[204:207], v[188:191], v[112:115]
    v_mfma_f32_16x16x32_bf16 v[132:135], v[204:207], v[192:195], v[132:135]
    s_waitcnt vmcnt(8)
    ds_read_b128 v[144:147], v10 offset:0
    ds_read_b128 v[148:151], v10 offset:1024
    ds_read_b128 v[152:155], v10 offset:2048
    ds_read_b128 v[156:159], v10 offset:3072
    ds_read_b128 v[160:163], v11 offset:4096
    ds_read_b128 v[164:167], v11 offset:5120
    ds_read_b128 v[168:171], v11 offset:6144
    ds_read_b128 v[172:175], v11 offset:7168
    ds_read_b128 v[176:179], v12 offset:17408
    v_mfma_f32_16x16x32_bf16 v[76:79], v[208:211], v[180:183], v[76:79]
    v_mfma_f32_16x16x32_bf16 v[96:99], v[208:211], v[184:187], v[96:99]
    v_mfma_f32_16x16x32_bf16 v[116:119], v[208:211], v[188:191], v[116:119]
    v_mfma_f32_16x16x32_bf16 v[136:139], v[208:211], v[192:195], v[136:139]
    v_mfma_f32_16x16x32_bf16 v[80:83], v[212:215], v[180:183], v[80:83]
    v_mfma_f32_16x16x32_bf16 v[100:103], v[212:215], v[184:187], v[100:103]
    v_mfma_f32_16x16x32_bf16 v[120:123], v[212:215], v[188:191], v[120:123]
    v_mfma_f32_16x16x32_bf16 v[140:143], v[212:215], v[192:195], v[140:143]
    s_waitcnt lgkmcnt(0)
    v_mfma_f32_16x16x32_bf16 v[64:67], v[160:163], v[144:147], v[64:67]
    s_add_u32 m0, s46, 0
    s_add_u32 s35, s33, 98304
    buffer_load_dwordx4 v8, s[16:19], s35 offen lds
    v_mfma_f32_16x16x32_bf16 v[84:87], v[160:163], v[148:151], v[84:87]
    s_add_u32 m0, s46, 1024
    s_add_u32 s35, s33, 245760
    buffer_load_dwordx4 v8, s[16:19], s35 offen lds
    v_mfma_f32_16x16x32_bf16 v[104:107], v[160:163], v[152:155], v[104:107]
    s_add_u32 m0, s46, 2048
    s_add_u32 s35, s33, 393216
    buffer_load_dwordx4 v8, s[16:19], s35 offen lds
    v_mfma_f32_16x16x32_bf16 v[124:127], v[160:163], v[156:159], v[124:127]
    s_add_u32 m0, s46, 3072
    s_add_u32 s35, s33, 540672
    buffer_load_dwordx4 v8, s[16:19], s35 offen lds
    v_mfma_f32_16x16x32_bf16 v[68:71], v[164:167], v[144:147], v[68:71]
    s_add_u32 m0, s46, 4096
    s_add_u32 s35, s34, 393216
    buffer_load_dwordx4 v8, s[20:23], s35 offen lds
    v_mfma_f32_16x16x32_bf16 v[88:91], v[164:167], v[148:151], v[88:91]
    s_add_u32 m0, s46, 5120
    s_add_u32 s35, s34, 394240
    buffer_load_dwordx4 v8, s[20:23], s35 offen lds
    v_mfma_f32_16x16x32_bf16 v[108:111], v[164:167], v[152:155], v[108:111]
    s_add_u32 m0, s46, 6144
    s_add_u32 s35, s34, 395264
    buffer_load_dwordx4 v8, s[20:23], s35 offen lds
    v_mfma_f32_16x16x32_bf16 v[128:131], v[164:167], v[156:159], v[128:131]
    s_add_u32 m0, s46, 7168
    s_add_u32 s35, s34, 396288
    buffer_load_dwordx4 v8, s[20:23], s35 offen lds
    v_mfma_f32_16x16x32_bf16 v[72:75], v[168:171], v[144:147], v[72:75]
    s_add_u32 m0, s46, 16384
    s_add_u32 s35, s37, 6144
    buffer_load_dwordx4 v8, s[20:23], s35 offen lds
    v_mfma_f32_16x16x32_bf16 v[92:95], v[168:171], v[148:151], v[92:95]
    v_mfma_f32_16x16x32_bf16 v[112:115], v[168:171], v[152:155], v[112:115]
    v_mfma_f32_16x16x32_bf16 v[132:135], v[168:171], v[156:159], v[132:135]
    s_waitcnt vmcnt(9)
    ds_read_b128 v[180:183], v10 offset:8192
    ds_read_b128 v[184:187], v10 offset:9216
    ds_read_b128 v[188:191], v10 offset:10240
    ds_read_b128 v[192:195], v10 offset:11264
    ds_read_b128 v[196:199], v11 offset:12288
    ds_read_b128 v[200:203], v11 offset:13312
    ds_read_b128 v[204:207], v11 offset:14336
    ds_read_b128 v[208:211], v11 offset:15360
    ds_read_b128 v[212:215], v12 offset:17920
    v_mfma_f32_16x16x32_bf16 v[76:79], v[172:175], v[144:147], v[76:79]
    v_mfma_f32_16x16x32_bf16 v[96:99], v[172:175], v[148:151], v[96:99]
    v_mfma_f32_16x16x32_bf16 v[116:119], v[172:175], v[152:155], v[116:119]
    v_mfma_f32_16x16x32_bf16 v[136:139], v[172:175], v[156:159], v[136:139]
    v_mfma_f32_16x16x32_bf16 v[80:83], v[176:179], v[144:147], v[80:83]
    v_mfma_f32_16x16x32_bf16 v[100:103], v[176:179], v[148:151], v[100:103]
    v_mfma_f32_16x16x32_bf16 v[120:123], v[176:179], v[152:155], v[120:123]
    v_mfma_f32_16x16x32_bf16 v[140:143], v[176:179], v[156:159], v[140:143]
    s_waitcnt lgkmcnt(0)
    s_barrier
    v_mfma_f32_16x16x32_bf16 v[64:67], v[196:199], v[180:183], v[64:67]
    s_add_u32 m0, s46, 8192
    s_add_u32 s35, s33, 106496
    buffer_load_dwordx4 v8, s[16:19], s35 offen lds
    v_mfma_f32_16x16x32_bf16 v[84:87], v[196:199], v[184:187], v[84:87]
    s_add_u32 m0, s46, 9216
    s_add_u32 s35, s33, 253952
    buffer_load_dwordx4 v8, s[16:19], s35 offen lds
    v_mfma_f32_16x16x32_bf16 v[104:107], v[196:199], v[188:191], v[104:107]
    s_add_u32 m0, s46, 10240
    s_add_u32 s35, s33, 401408
    buffer_load_dwordx4 v8, s[16:19], s35 offen lds
    v_mfma_f32_16x16x32_bf16 v[124:127], v[196:199], v[192:195], v[124:127]
    s_add_u32 m0, s46, 11264
    s_add_u32 s35, s33, 548864
    buffer_load_dwordx4 v8, s[16:19], s35 offen lds
    v_mfma_f32_16x16x32_bf16 v[68:71], v[200:203], v[180:183], v[68:71]
    s_add_u32 m0, s46, 12288
    s_add_u32 s35, s34, 425984
    buffer_load_dwordx4 v8, s[20:23], s35 offen lds
    v_mfma_f32_16x16x32_bf16 v[88:91], v[200:203], v[184:187], v[88:91]
    s_add_u32 m0, s46, 13312
    s_add_u32 s35, s34, 427008
    buffer_load_dwordx4 v8, s[20:23], s35 offen lds
    v_mfma_f32_16x16x32_bf16 v[108:111], v[200:203], v[188:191], v[108:111]
    s_add_u32 m0, s46, 14336
    s_add_u32 s35, s34, 428032
    buffer_load_dwordx4 v8, s[20:23], s35 offen lds
    v_mfma_f32_16x16x32_bf16 v[128:131], v[200:203], v[192:195], v[128:131]
    s_add_u32 m0, s46, 15360
    s_add_u32 s35, s34, 429056
    buffer_load_dwordx4 v8, s[20:23], s35 offen lds
    v_mfma_f32_16x16x32_bf16 v[72:75], v[204:207], v[180:183], v[72:75]
    v_mfma_f32_16x16x32_bf16 v[92:95], v[204:207], v[184:187], v[92:95]
    v_mfma_f32_16x16x32_bf16 v[112:115], v[204:207], v[188:191], v[112:115]
    v_mfma_f32_16x16x32_bf16 v[132:135], v[204:207], v[192:195], v[132:135]
    s_waitcnt vmcnt(8)
    ds_read_b128 v[144:147], v10 offset:0
    ds_read_b128 v[148:151], v10 offset:1024
    ds_read_b128 v[152:155], v10 offset:2048
    ds_read_b128 v[156:159], v10 offset:3072
    ds_read_b128 v[160:163], v11 offset:4096
    ds_read_b128 v[164:167], v11 offset:5120
    ds_read_b128 v[168:171], v11 offset:6144
    ds_read_b128 v[172:175], v11 offset:7168
    ds_read_b128 v[176:179], v12 offset:16384
    v_mfma_f32_16x16x32_bf16 v[76:79], v[208:211], v[180:183], v[76:79]
    v_mfma_f32_16x16x32_bf16 v[96:99], v[208:211], v[184:187], v[96:99]
    v_mfma_f32_16x16x32_bf16 v[116:119], v[208:211], v[188:191], v[116:119]
    v_mfma_f32_16x16x32_bf16 v[136:139], v[208:211], v[192:195], v[136:139]
    v_mfma_f32_16x16x32_bf16 v[80:83], v[212:215], v[180:183], v[80:83]
    v_mfma_f32_16x16x32_bf16 v[100:103], v[212:215], v[184:187], v[100:103]
    v_mfma_f32_16x16x32_bf16 v[120:123], v[212:215], v[188:191], v[120:123]
    v_mfma_f32_16x16x32_bf16 v[140:143], v[212:215], v[192:195], v[140:143]
    s_waitcnt lgkmcnt(0)
    v_mfma_f32_16x16x32_bf16 v[64:67], v[160:163], v[144:147], v[64:67]
    s_add_u32 m0, s46, 0
    s_add_u32 s35, s33, 114688
    buffer_load_dwordx4 v8, s[16:19], s35 offen lds
    v_mfma_f32_16x16x32_bf16 v[84:87], v[160:163], v[148:151], v[84:87]
    s_add_u32 m0, s46, 1024
    s_add_u32 s35, s33, 262144
    buffer_load_dwordx4 v8, s[16:19], s35 offen lds
    v_mfma_f32_16x16x32_bf16 v[104:107], v[160:163], v[152:155], v[104:107]
    s_add_u32 m0, s46, 2048
    s_add_u32 s35, s33, 409600
    buffer_load_dwordx4 v8, s[16:19], s35 offen lds
    v_mfma_f32_16x16x32_bf16 v[124:127], v[160:163], v[156:159], v[124:127]
    s_add_u32 m0, s46, 3072
    s_add_u32 s35, s33, 557056
    buffer_load_dwordx4 v8, s[16:19], s35 offen lds
    v_mfma_f32_16x16x32_bf16 v[68:71], v[164:167], v[144:147], v[68:71]
    s_add_u32 m0, s46, 4096
    s_add_u32 s35, s34, 458752
    buffer_load_dwordx4 v8, s[20:23], s35 offen lds
    v_mfma_f32_16x16x32_bf16 v[88:91], v[164:167], v[148:151], v[88:91]
    s_add_u32 m0, s46, 5120
    s_add_u32 s35, s34, 459776
    buffer_load_dwordx4 v8, s[20:23], s35 offen lds
    v_mfma_f32_16x16x32_bf16 v[108:111], v[164:167], v[152:155], v[108:111]
    s_add_u32 m0, s46, 6144
    s_add_u32 s35, s34, 460800
    buffer_load_dwordx4 v8, s[20:23], s35 offen lds
    v_mfma_f32_16x16x32_bf16 v[128:131], v[164:167], v[156:159], v[128:131]
    s_add_u32 m0, s46, 7168
    s_add_u32 s35, s34, 461824
    buffer_load_dwordx4 v8, s[20:23], s35 offen lds
    v_mfma_f32_16x16x32_bf16 v[72:75], v[168:171], v[144:147], v[72:75]
    s_add_u32 m0, s46, 17408
    s_add_u32 s35, s37, 7168
    buffer_load_dwordx4 v8, s[20:23], s35 offen lds
    v_mfma_f32_16x16x32_bf16 v[92:95], v[168:171], v[148:151], v[92:95]
    v_mfma_f32_16x16x32_bf16 v[112:115], v[168:171], v[152:155], v[112:115]
    v_mfma_f32_16x16x32_bf16 v[132:135], v[168:171], v[156:159], v[132:135]
    s_waitcnt vmcnt(9)
    ds_read_b128 v[180:183], v10 offset:8192
    ds_read_b128 v[184:187], v10 offset:9216
    ds_read_b128 v[188:191], v10 offset:10240
    ds_read_b128 v[192:195], v10 offset:11264
    ds_read_b128 v[196:199], v11 offset:12288
    ds_read_b128 v[200:203], v11 offset:13312
    ds_read_b128 v[204:207], v11 offset:14336
    ds_read_b128 v[208:211], v11 offset:15360
    ds_read_b128 v[212:215], v12 offset:16896
    v_mfma_f32_16x16x32_bf16 v[76:79], v[172:175], v[144:147], v[76:79]
    v_mfma_f32_16x16x32_bf16 v[96:99], v[172:175], v[148:151], v[96:99]
    v_mfma_f32_16x16x32_bf16 v[116:119], v[172:175], v[152:155], v[116:119]
    v_mfma_f32_16x16x32_bf16 v[136:139], v[172:175], v[156:159], v[136:139]
    v_mfma_f32_16x16x32_bf16 v[80:83], v[176:179], v[144:147], v[80:83]
    v_mfma_f32_16x16x32_bf16 v[100:103], v[176:179], v[148:151], v[100:103]
    v_mfma_f32_16x16x32_bf16 v[120:123], v[176:179], v[152:155], v[120:123]
    v_mfma_f32_16x16x32_bf16 v[140:143], v[176:179], v[156:159], v[140:143]
    s_waitcnt lgkmcnt(0)
    s_barrier
    v_mfma_f32_16x16x32_bf16 v[64:67], v[196:199], v[180:183], v[64:67]
    s_add_u32 m0, s46, 8192
    s_add_u32 s35, s33, 122880
    buffer_load_dwordx4 v8, s[16:19], s35 offen lds
    v_mfma_f32_16x16x32_bf16 v[84:87], v[196:199], v[184:187], v[84:87]
    s_add_u32 m0, s46, 9216
    s_add_u32 s35, s33, 270336
    buffer_load_dwordx4 v8, s[16:19], s35 offen lds
    v_mfma_f32_16x16x32_bf16 v[104:107], v[196:199], v[188:191], v[104:107]
    s_add_u32 m0, s46, 10240
    s_add_u32 s35, s33, 417792
    buffer_load_dwordx4 v8, s[16:19], s35 offen lds
    v_mfma_f32_16x16x32_bf16 v[124:127], v[196:199], v[192:195], v[124:127]
    s_add_u32 m0, s46, 11264
    s_add_u32 s35, s33, 565248
    buffer_load_dwordx4 v8, s[16:19], s35 offen lds
    v_mfma_f32_16x16x32_bf16 v[68:71], v[200:203], v[180:183], v[68:71]
    s_add_u32 m0, s46, 12288
    s_add_u32 s35, s34, 491520
    buffer_load_dwordx4 v8, s[20:23], s35 offen lds
    v_mfma_f32_16x16x32_bf16 v[88:91], v[200:203], v[184:187], v[88:91]
    s_add_u32 m0, s46, 13312
    s_add_u32 s35, s34, 492544
    buffer_load_dwordx4 v8, s[20:23], s35 offen lds
    v_mfma_f32_16x16x32_bf16 v[108:111], v[200:203], v[188:191], v[108:111]
    s_add_u32 m0, s46, 14336
    s_add_u32 s35, s34, 493568
    buffer_load_dwordx4 v8, s[20:23], s35 offen lds
    v_mfma_f32_16x16x32_bf16 v[128:131], v[200:203], v[192:195], v[128:131]
    s_add_u32 m0, s46, 15360
    s_add_u32 s35, s34, 494592
    buffer_load_dwordx4 v8, s[20:23], s35 offen lds
    v_mfma_f32_16x16x32_bf16 v[72:75], v[204:207], v[180:183], v[72:75]
    v_mfma_f32_16x16x32_bf16 v[92:95], v[204:207], v[184:187], v[92:95]
    v_mfma_f32_16x16x32_bf16 v[112:115], v[204:207], v[188:191], v[112:115]
    v_mfma_f32_16x16x32_bf16 v[132:135], v[204:207], v[192:195], v[132:135]
    s_waitcnt vmcnt(8)
    ds_read_b128 v[144:147], v10 offset:0
    ds_read_b128 v[148:151], v10 offset:1024
    ds_read_b128 v[152:155], v10 offset:2048
    ds_read_b128 v[156:159], v10 offset:3072
    ds_read_b128 v[160:163], v11 offset:4096
    ds_read_b128 v[164:167], v11 offset:5120
    ds_read_b128 v[168:171], v11 offset:6144
    ds_read_b128 v[172:175], v11 offset:7168
    ds_read_b128 v[176:179], v12 offset:17408
    v_mfma_f32_16x16x32_bf16 v[76:79], v[208:211], v[180:183], v[76:79]
    v_mfma_f32_16x16x32_bf16 v[96:99], v[208:211], v[184:187], v[96:99]
    v_mfma_f32_16x16x32_bf16 v[116:119], v[208:211], v[188:191], v[116:119]
    v_mfma_f32_16x16x32_bf16 v[136:139], v[208:211], v[192:195], v[136:139]
    v_mfma_f32_16x16x32_bf16 v[80:83], v[212:215], v[180:183], v[80:83]
    v_mfma_f32_16x16x32_bf16 v[100:103], v[212:215], v[184:187], v[100:103]
    v_mfma_f32_16x16x32_bf16 v[120:123], v[212:215], v[188:191], v[120:123]
    v_mfma_f32_16x16x32_bf16 v[140:143], v[212:215], v[192:195], v[140:143]
    s_waitcnt lgkmcnt(0)
    v_mfma_f32_16x16x32_bf16 v[64:67], v[160:163], v[144:147], v[64:67]
    s_add_u32 m0, s46, 0
    s_add_u32 s35, s33, 131072
    buffer_load_dwordx4 v8, s[16:19], s35 offen lds
    v_mfma_f32_16x16x32_bf16 v[84:87], v[160:163], v[148:151], v[84:87]
    s_add_u32 m0, s46, 1024
    s_add_u32 s35, s33, 278528
    buffer_load_dwordx4 v8, s[16:19], s35 offen lds
    v_mfma_f32_16x16x32_bf16 v[104:107], v[160:163], v[152:155], v[104:107]
    s_add_u32 m0, s46, 2048
    s_add_u32 s35, s33, 425984
    buffer_load_dwordx4 v8, s[16:19], s35 offen lds
    v_mfma_f32_16x16x32_bf16 v[124:127], v[160:163], v[156:159], v[124:127]
    s_add_u32 m0, s46, 3072
    s_add_u32 s35, s33, 573440
    buffer_load_dwordx4 v8, s[16:19], s35 offen lds
    v_mfma_f32_16x16x32_bf16 v[68:71], v[164:167], v[144:147], v[68:71]
    s_add_u32 m0, s46, 4096
    s_add_u32 s35, s34, 524288
    buffer_load_dwordx4 v8, s[20:23], s35 offen lds
    v_mfma_f32_16x16x32_bf16 v[88:91], v[164:167], v[148:151], v[88:91]
    s_add_u32 m0, s46, 5120
    s_add_u32 s35, s34, 525312
    buffer_load_dwordx4 v8, s[20:23], s35 offen lds
    v_mfma_f32_16x16x32_bf16 v[108:111], v[164:167], v[152:155], v[108:111]
    s_add_u32 m0, s46, 6144
    s_add_u32 s35, s34, 526336
    buffer_load_dwordx4 v8, s[20:23], s35 offen lds
    v_mfma_f32_16x16x32_bf16 v[128:131], v[164:167], v[156:159], v[128:131]
    s_add_u32 m0, s46, 7168
    s_add_u32 s35, s34, 527360
    buffer_load_dwordx4 v8, s[20:23], s35 offen lds
    v_mfma_f32_16x16x32_bf16 v[72:75], v[168:171], v[144:147], v[72:75]
    s_add_u32 m0, s46, 16384
    s_add_u32 s35, s37, 8192
    buffer_load_dwordx4 v8, s[20:23], s35 offen lds
    v_mfma_f32_16x16x32_bf16 v[92:95], v[168:171], v[148:151], v[92:95]
    v_mfma_f32_16x16x32_bf16 v[112:115], v[168:171], v[152:155], v[112:115]
    v_mfma_f32_16x16x32_bf16 v[132:135], v[168:171], v[156:159], v[132:135]
    s_waitcnt vmcnt(9)
    ds_read_b128 v[180:183], v10 offset:8192
    ds_read_b128 v[184:187], v10 offset:9216
    ds_read_b128 v[188:191], v10 offset:10240
    ds_read_b128 v[192:195], v10 offset:11264
    ds_read_b128 v[196:199], v11 offset:12288
    ds_read_b128 v[200:203], v11 offset:13312
    ds_read_b128 v[204:207], v11 offset:14336
    ds_read_b128 v[208:211], v11 offset:15360
    ds_read_b128 v[212:215], v12 offset:17920
    v_mfma_f32_16x16x32_bf16 v[76:79], v[172:175], v[144:147], v[76:79]
    v_mfma_f32_16x16x32_bf16 v[96:99], v[172:175], v[148:151], v[96:99]
    v_mfma_f32_16x16x32_bf16 v[116:119], v[172:175], v[152:155], v[116:119]
    v_mfma_f32_16x16x32_bf16 v[136:139], v[172:175], v[156:159], v[136:139]
    v_mfma_f32_16x16x32_bf16 v[80:83], v[176:179], v[144:147], v[80:83]
    v_mfma_f32_16x16x32_bf16 v[100:103], v[176:179], v[148:151], v[100:103]
    v_mfma_f32_16x16x32_bf16 v[120:123], v[176:179], v[152:155], v[120:123]
    v_mfma_f32_16x16x32_bf16 v[140:143], v[176:179], v[156:159], v[140:143]
    s_waitcnt lgkmcnt(0)
    s_barrier
    v_mfma_f32_16x16x32_bf16 v[64:67], v[196:199], v[180:183], v[64:67]
    s_add_u32 m0, s46, 8192
    s_add_u32 s35, s33, 139264
    buffer_load_dwordx4 v8, s[16:19], s35 offen lds
    v_mfma_f32_16x16x32_bf16 v[84:87], v[196:199], v[184:187], v[84:87]
    s_add_u32 m0, s46, 9216
    s_add_u32 s35, s33, 286720
    buffer_load_dwordx4 v8, s[16:19], s35 offen lds
    v_mfma_f32_16x16x32_bf16 v[104:107], v[196:199], v[188:191], v[104:107]
    s_add_u32 m0, s46, 10240
    s_add_u32 s35, s33, 434176
    buffer_load_dwordx4 v8, s[16:19], s35 offen lds
    v_mfma_f32_16x16x32_bf16 v[124:127], v[196:199], v[192:195], v[124:127]
    s_add_u32 m0, s46, 11264
    s_add_u32 s35, s33, 581632
    buffer_load_dwordx4 v8, s[16:19], s35 offen lds
    v_mfma_f32_16x16x32_bf16 v[68:71], v[200:203], v[180:183], v[68:71]
    s_add_u32 m0, s46, 12288
    s_add_u32 s35, s34, 557056
    buffer_load_dwordx4 v8, s[20:23], s35 offen lds
    v_mfma_f32_16x16x32_bf16 v[88:91], v[200:203], v[184:187], v[88:91]
    s_add_u32 m0, s46, 13312
    s_add_u32 s35, s34, 558080
    buffer_load_dwordx4 v8, s[20:23], s35 offen lds
    v_mfma_f32_16x16x32_bf16 v[108:111], v[200:203], v[188:191], v[108:111]
    s_add_u32 m0, s46, 14336
    s_add_u32 s35, s34, 559104
    buffer_load_dwordx4 v8, s[20:23], s35 offen lds
    v_mfma_f32_16x16x32_bf16 v[128:131], v[200:203], v[192:195], v[128:131]
    s_add_u32 m0, s46, 15360
    s_add_u32 s35, s34, 560128
    buffer_load_dwordx4 v8, s[20:23], s35 offen lds
    v_mfma_f32_16x16x32_bf16 v[72:75], v[204:207], v[180:183], v[72:75]
    v_mfma_f32_16x16x32_bf16 v[92:95], v[204:207], v[184:187], v[92:95]
    v_mfma_f32_16x16x32_bf16 v[112:115], v[204:207], v[188:191], v[112:115]
    v_mfma_f32_16x16x32_bf16 v[132:135], v[204:207], v[192:195], v[132:135]
    s_waitcnt vmcnt(8)
    ds_read_b128 v[144:147], v10 offset:0
    ds_read_b128 v[148:151], v10 offset:1024
    ds_read_b128 v[152:155], v10 offset:2048
    ds_read_b128 v[156:159], v10 offset:3072
    ds_read_b128 v[160:163], v11 offset:4096
    ds_read_b128 v[164:167], v11 offset:5120
    ds_read_b128 v[168:171], v11 offset:6144
    ds_read_b128 v[172:175], v11 offset:7168
    ds_read_b128 v[176:179], v12 offset:16384
    v_mfma_f32_16x16x32_bf16 v[76:79], v[208:211], v[180:183], v[76:79]
    v_mfma_f32_16x16x32_bf16 v[96:99], v[208:211], v[184:187], v[96:99]
    v_mfma_f32_16x16x32_bf16 v[116:119], v[208:211], v[188:191], v[116:119]
    v_mfma_f32_16x16x32_bf16 v[136:139], v[208:211], v[192:195], v[136:139]
    v_mfma_f32_16x16x32_bf16 v[80:83], v[212:215], v[180:183], v[80:83]
    v_mfma_f32_16x16x32_bf16 v[100:103], v[212:215], v[184:187], v[100:103]
    v_mfma_f32_16x16x32_bf16 v[120:123], v[212:215], v[188:191], v[120:123]
    v_mfma_f32_16x16x32_bf16 v[140:143], v[212:215], v[192:195], v[140:143]
    s_waitcnt lgkmcnt(0)
    v_mfma_f32_16x16x32_bf16 v[64:67], v[160:163], v[144:147], v[64:67]
    v_mfma_f32_16x16x32_bf16 v[84:87], v[160:163], v[148:151], v[84:87]
    v_mfma_f32_16x16x32_bf16 v[104:107], v[160:163], v[152:155], v[104:107]
    v_mfma_f32_16x16x32_bf16 v[124:127], v[160:163], v[156:159], v[124:127]
    v_mfma_f32_16x16x32_bf16 v[68:71], v[164:167], v[144:147], v[68:71]
    v_mfma_f32_16x16x32_bf16 v[88:91], v[164:167], v[148:151], v[88:91]
    v_mfma_f32_16x16x32_bf16 v[108:111], v[164:167], v[152:155], v[108:111]
    v_mfma_f32_16x16x32_bf16 v[128:131], v[164:167], v[156:159], v[128:131]
    v_mfma_f32_16x16x32_bf16 v[72:75], v[168:171], v[144:147], v[72:75]
    v_mfma_f32_16x16x32_bf16 v[92:95], v[168:171], v[148:151], v[92:95]
    v_mfma_f32_16x16x32_bf16 v[112:115], v[168:171], v[152:155], v[112:115]
    v_mfma_f32_16x16x32_bf16 v[132:135], v[168:171], v[156:159], v[132:135]
    s_waitcnt vmcnt(0)
    ds_read_b128 v[180:183], v10 offset:8192
    ds_read_b128 v[184:187], v10 offset:9216
    ds_read_b128 v[188:191], v10 offset:10240
    ds_read_b128 v[192:195], v10 offset:11264
    ds_read_b128 v[196:199], v11 offset:12288
    ds_read_b128 v[200:203], v11 offset:13312
    ds_read_b128 v[204:207], v11 offset:14336
    ds_read_b128 v[208:211], v11 offset:15360
    ds_read_b128 v[212:215], v12 offset:16896
    v_mfma_f32_16x16x32_bf16 v[76:79], v[172:175], v[144:147], v[76:79]
    v_mfma_f32_16x16x32_bf16 v[96:99], v[172:175], v[148:151], v[96:99]
    v_mfma_f32_16x16x32_bf16 v[116:119], v[172:175], v[152:155], v[116:119]
    v_mfma_f32_16x16x32_bf16 v[136:139], v[172:175], v[156:159], v[136:139]
    v_mfma_f32_16x16x32_bf16 v[80:83], v[176:179], v[144:147], v[80:83]
    v_mfma_f32_16x16x32_bf16 v[100:103], v[176:179], v[148:151], v[100:103]
    v_mfma_f32_16x16x32_bf16 v[120:123], v[176:179], v[152:155], v[120:123]
    v_mfma_f32_16x16x32_bf16 v[140:143], v[176:179], v[156:159], v[140:143]
    s_waitcnt lgkmcnt(0)
    v_mfma_f32_16x16x32_bf16 v[64:67], v[196:199], v[180:183], v[64:67]
    v_mfma_f32_16x16x32_bf16 v[84:87], v[196:199], v[184:187], v[84:87]
    v_mfma_f32_16x16x32_bf16 v[104:107], v[196:199], v[188:191], v[104:107]
    v_mfma_f32_16x16x32_bf16 v[124:127], v[196:199], v[192:195], v[124:127]
    v_mfma_f32_16x16x32_bf16 v[68:71], v[200:203], v[180:183], v[68:71]
    v_mfma_f32_16x16x32_bf16 v[88:91], v[200:203], v[184:187], v[88:91]
    v_mfma_f32_16x16x32_bf16 v[108:111], v[200:203], v[188:191], v[108:111]
    v_mfma_f32_16x16x32_bf16 v[128:131], v[200:203], v[192:195], v[128:131]
    v_mfma_f32_16x16x32_bf16 v[72:75], v[204:207], v[180:183], v[72:75]
    v_mfma_f32_16x16x32_bf16 v[92:95], v[204:207], v[184:187], v[92:95]
    v_mfma_f32_16x16x32_bf16 v[112:115], v[204:207], v[188:191], v[112:115]
    v_mfma_f32_16x16x32_bf16 v[132:135], v[204:207], v[192:195], v[132:135]
    v_mfma_f32_16x16x32_bf16 v[76:79], v[208:211], v[180:183], v[76:79]
    v_mfma_f32_16x16x32_bf16 v[96:99], v[208:211], v[184:187], v[96:99]
    v_mfma_f32_16x16x32_bf16 v[116:119], v[208:211], v[188:191], v[116:119]
    v_mfma_f32_16x16x32_bf16 v[136:139], v[208:211], v[192:195], v[136:139]
    v_mfma_f32_16x16x32_bf16 v[80:83], v[212:215], v[180:183], v[80:83]
    v_mfma_f32_16x16x32_bf16 v[100:103], v[212:215], v[184:187], v[100:103]
    v_mfma_f32_16x16x32_bf16 v[120:123], v[212:215], v[188:191], v[120:123]
    v_mfma_f32_16x16x32_bf16 v[140:143], v[212:215], v[192:195], v[140:143]
    s_mov_b32 s38, 0xffff0000
    s_movk_i32 s47, 72
    s_add_u32 s39, s3, 0
    s_mul_i32 s40, s39, 52
    s_lshr_b32 s40, s40, 8
    s_mul_i32 s41, s40, 5
    s_sub_u32 s41, s39, s41
    s_lshl_b32 s42, s11, 6
    s_lshl_b32 s40, s40, 4
    s_add_u32 s42, s42, s40
    v_add_u32 v7, s42, v3
    v_mul_u32_u24 v7, 1152, v7
    s_mul_i32 s42, s12, 144
    s_lshl_b32 s43, s41, 5
    s_add_u32 s42, s42, s43
    v_lshrrev_b32 v9, 4, v1
    v_lshl_add_u32 v7, v9, 3, v7
    v_add_u32 v150, s42, v7
    s_lshl_b32 s43, s41, 4
    v_lshl_add_u32 v9, v9, 2, s43
    v_cmp_lt_u32 s[50:51], v9, s47

    s_add_u32 s39, s3, 8
    s_mul_i32 s40, s39, 52
    s_lshr_b32 s40, s40, 8
    s_mul_i32 s41, s40, 5
    s_sub_u32 s41, s39, s41
    s_lshl_b32 s42, s11, 6
    s_lshl_b32 s40, s40, 4
    s_add_u32 s42, s42, s40
    v_add_u32 v7, s42, v3
    v_mul_u32_u24 v7, 1152, v7
    s_mul_i32 s42, s12, 144
    s_lshl_b32 s43, s41, 5
    s_add_u32 s42, s42, s43
    v_lshrrev_b32 v9, 4, v1
    v_lshl_add_u32 v7, v9, 3, v7
    v_add_u32 v151, s42, v7
    s_lshl_b32 s43, s41, 4
    v_lshl_add_u32 v9, v9, 2, s43
    v_cmp_lt_u32 s[52:53], v9, s47

    s_add_u32 s39, s3, 16
    s_mul_i32 s40, s39, 52
    s_lshr_b32 s40, s40, 8
    s_mul_i32 s41, s40, 5
    s_sub_u32 s41, s39, s41
    s_lshl_b32 s42, s11, 6
    s_lshl_b32 s40, s40, 4
    s_add_u32 s42, s42, s40
    v_add_u32 v7, s42, v3
    v_mul_u32_u24 v7, 1152, v7
    s_mul_i32 s42, s12, 144
    s_lshl_b32 s43, s41, 5
    s_add_u32 s42, s42, s43
    v_lshrrev_b32 v9, 4, v1
    v_lshl_add_u32 v7, v9, 3, v7
    v_add_u32 v152, s42, v7
    s_lshl_b32 s43, s41, 4
    v_lshl_add_u32 v9, v9, 2, s43
    v_cmp_lt_u32 s[54:55], v9, s47

    s_mul_i32 s46, s3, 20480
    v_lshl_add_u32 v4, v1, 4, s46
    s_cmp_ge_u32 s3, 4
    s_cselect_b64 s[54:55], 0, s[54:55]

    s_mov_b64 exec, s[50:51]
    buffer_load_dwordx2 v[154:155], v150, s[28:31], 0 offen
    s_mov_b64 exec, s[52:53]
    buffer_load_dwordx2 v[156:157], v151, s[28:31], 0 offen
    s_mov_b64 exec, s[54:55]
    s_cbranch_execz gemm2_kernel_nold
    buffer_load_dwordx2 v[158:159], v152, s[28:31], 0 offen
gemm2_kernel_nold:
    s_mov_b64 exec, -1
    ds_write_b128 v4, v[64:67] offset:0
    ds_write_b128 v4, v[68:71] offset:1024
    ds_write_b128 v4, v[72:75] offset:2048
    ds_write_b128 v4, v[76:79] offset:3072
    ds_write_b128 v4, v[80:83] offset:4096
    ds_write_b128 v4, v[84:87] offset:5120
    ds_write_b128 v4, v[88:91] offset:6144
    ds_write_b128 v4, v[92:95] offset:7168
    ds_write_b128 v4, v[96:99] offset:8192
    ds_write_b128 v4, v[100:103] offset:9216
    ds_write_b128 v4, v[104:107] offset:10240
    ds_write_b128 v4, v[108:111] offset:11264
    ds_write_b128 v4, v[112:115] offset:12288
    ds_write_b128 v4, v[116:119] offset:13312
    ds_write_b128 v4, v[120:123] offset:14336
    ds_write_b128 v4, v[124:127] offset:15360
    ds_write_b128 v4, v[128:131] offset:16384
    ds_write_b128 v4, v[132:135] offset:17408
    ds_write_b128 v4, v[136:139] offset:18432
    ds_write_b128 v4, v[140:143] offset:19456
    s_waitcnt lgkmcnt(0)
    s_barrier
    v_lshlrev_b32 v4, 4, v0
    v_add_u32 v5, 81920, v4
    v_add_u32 v6, 61440, v4
    v_add_u32 v7, 143360, v4

    ds_read_b128 v[16:19], v4 offset:0
    ds_read_b128 v[20:23], v4 offset:20480
    ds_read_b128 v[24:27], v4 offset:40960
    ds_read_b128 v[28:31], v6 offset:0
    ds_read_b128 v[32:35], v5 offset:0
    ds_read_b128 v[36:39], v5 offset:20480
    ds_read_b128 v[40:43], v5 offset:40960
    ds_read_b128 v[44:47], v7 offset:0
    s_waitcnt lgkmcnt(0)
    v_pk_add_f32 v[16:17], v[16:17], v[20:21]
    v_pk_add_f32 v[24:25], v[24:25], v[28:29]
    v_pk_add_f32 v[32:33], v[32:33], v[36:37]
    v_pk_add_f32 v[40:41], v[40:41], v[44:45]
    v_pk_add_f32 v[18:19], v[18:19], v[22:23]
    v_pk_add_f32 v[26:27], v[26:27], v[30:31]
    v_pk_add_f32 v[34:35], v[34:35], v[38:39]
    v_pk_add_f32 v[42:43], v[42:43], v[46:47]
    v_pk_add_f32 v[16:17], v[16:17], v[24:25]
    v_pk_add_f32 v[32:33], v[32:33], v[40:41]
    v_pk_add_f32 v[18:19], v[18:19], v[26:27]
    v_pk_add_f32 v[34:35], v[34:35], v[42:43]
    v_pk_add_f32 v[16:17], v[16:17], v[32:33]
    v_pk_add_f32 v[18:19], v[18:19], v[34:35]
    v_cvt_pk_bf16_f32 v20, v16, v17
    v_cvt_pk_bf16_f32 v21, v18, v19
    v_lshlrev_b32 v16, 16, v20
    v_and_b32 v17, s38, v20
    v_lshlrev_b32 v18, 16, v21
    v_and_b32 v19, s38, v21

    s_waitcnt vmcnt(0)
    v_lshlrev_b32 v20, 16, v154
    v_and_b32 v21, s38, v154
    v_lshlrev_b32 v22, 16, v155
    v_and_b32 v23, s38, v155
    v_pk_add_f32 v[16:17], v[16:17], v[20:21]
    v_pk_add_f32 v[18:19], v[18:19], v[22:23]
    v_cvt_pk_bf16_f32 v24, v16, v17
    v_cvt_pk_bf16_f32 v25, v18, v19
    s_mov_b64 exec, s[50:51]
    buffer_store_dwordx2 v[24:25], v150, s[24:27], 0 offen
    s_mov_b64 exec, -1

    ds_read_b128 v[48:51], v4 offset:8192
    ds_read_b128 v[52:55], v4 offset:28672
    ds_read_b128 v[56:59], v4 offset:49152
    ds_read_b128 v[60:63], v6 offset:8192
    ds_read_b128 v[64:67], v5 offset:8192
    ds_read_b128 v[68:71], v5 offset:28672
    ds_read_b128 v[72:75], v5 offset:49152
    ds_read_b128 v[76:79], v7 offset:8192
    s_waitcnt lgkmcnt(0)
    v_pk_add_f32 v[48:49], v[48:49], v[52:53]
    v_pk_add_f32 v[56:57], v[56:57], v[60:61]
    v_pk_add_f32 v[64:65], v[64:65], v[68:69]
    v_pk_add_f32 v[72:73], v[72:73], v[76:77]
    v_pk_add_f32 v[50:51], v[50:51], v[54:55]
    v_pk_add_f32 v[58:59], v[58:59], v[62:63]
    v_pk_add_f32 v[66:67], v[66:67], v[70:71]
    v_pk_add_f32 v[74:75], v[74:75], v[78:79]
    v_pk_add_f32 v[48:49], v[48:49], v[56:57]
    v_pk_add_f32 v[64:65], v[64:65], v[72:73]
    v_pk_add_f32 v[50:51], v[50:51], v[58:59]
    v_pk_add_f32 v[66:67], v[66:67], v[74:75]
    v_pk_add_f32 v[48:49], v[48:49], v[64:65]
    v_pk_add_f32 v[50:51], v[50:51], v[66:67]
    v_cvt_pk_bf16_f32 v52, v48, v49
    v_cvt_pk_bf16_f32 v53, v50, v51
    v_lshlrev_b32 v48, 16, v52
    v_and_b32 v49, s38, v52
    v_lshlrev_b32 v50, 16, v53
    v_and_b32 v51, s38, v53

    v_lshlrev_b32 v52, 16, v156
    v_and_b32 v53, s38, v156
    v_lshlrev_b32 v54, 16, v157
    v_and_b32 v55, s38, v157
    v_pk_add_f32 v[48:49], v[48:49], v[52:53]
    v_pk_add_f32 v[50:51], v[50:51], v[54:55]
    v_cvt_pk_bf16_f32 v56, v48, v49
    v_cvt_pk_bf16_f32 v57, v50, v51
    s_mov_b64 exec, s[52:53]
    buffer_store_dwordx2 v[56:57], v151, s[24:27], 0 offen
    s_mov_b64 exec, -1

    s_cmp_ge_u32 s3, 4
    s_cbranch_scc1 gemm2_kernel_fin
    ds_read_b128 v[16:19], v4 offset:16384
    ds_read_b128 v[20:23], v4 offset:36864
    ds_read_b128 v[24:27], v4 offset:57344
    ds_read_b128 v[28:31], v6 offset:16384
    ds_read_b128 v[32:35], v5 offset:16384
    ds_read_b128 v[36:39], v5 offset:36864
    ds_read_b128 v[40:43], v5 offset:57344
    ds_read_b128 v[44:47], v7 offset:16384
    s_waitcnt lgkmcnt(0)
    v_pk_add_f32 v[16:17], v[16:17], v[20:21]
    v_pk_add_f32 v[24:25], v[24:25], v[28:29]
    v_pk_add_f32 v[32:33], v[32:33], v[36:37]
    v_pk_add_f32 v[40:41], v[40:41], v[44:45]
    v_pk_add_f32 v[18:19], v[18:19], v[22:23]
    v_pk_add_f32 v[26:27], v[26:27], v[30:31]
    v_pk_add_f32 v[34:35], v[34:35], v[38:39]
    v_pk_add_f32 v[42:43], v[42:43], v[46:47]
    v_pk_add_f32 v[16:17], v[16:17], v[24:25]
    v_pk_add_f32 v[32:33], v[32:33], v[40:41]
    v_pk_add_f32 v[18:19], v[18:19], v[26:27]
    v_pk_add_f32 v[34:35], v[34:35], v[42:43]
    v_pk_add_f32 v[16:17], v[16:17], v[32:33]
    v_pk_add_f32 v[18:19], v[18:19], v[34:35]
    v_cvt_pk_bf16_f32 v20, v16, v17
    v_cvt_pk_bf16_f32 v21, v18, v19
    v_lshlrev_b32 v16, 16, v20
    v_and_b32 v17, s38, v20
    v_lshlrev_b32 v18, 16, v21
    v_and_b32 v19, s38, v21

    v_lshlrev_b32 v20, 16, v158
    v_and_b32 v21, s38, v158
    v_lshlrev_b32 v22, 16, v159
    v_and_b32 v23, s38, v159
    v_pk_add_f32 v[16:17], v[16:17], v[20:21]
    v_pk_add_f32 v[18:19], v[18:19], v[22:23]
    v_cvt_pk_bf16_f32 v24, v16, v17
    v_cvt_pk_bf16_f32 v25, v18, v19
    s_mov_b64 exec, s[54:55]
    buffer_store_dwordx2 v[24:25], v152, s[24:27], 0 offen
    s_mov_b64 exec, -1

gemm2_kernel_fin:
gemm2_kernel_end:
    s_endpgm
.section .rodata,"a"
.p2align 6
.amdhsa_kernel front_kernel
  .amdhsa_next_free_vgpr 164
  .amdhsa_next_free_sgpr 102
  .amdhsa_accum_offset 164
  .amdhsa_group_segment_fixed_size 0
  .amdhsa_kernarg_size 128
  .amdhsa_user_sgpr_count 2
  .amdhsa_user_sgpr_kernarg_segment_ptr 1
  .amdhsa_system_sgpr_workgroup_id_x 1
.end_amdhsa_kernel
.p2align 6
.amdhsa_kernel gemm1_kernel
  .amdhsa_next_free_vgpr 256
  .amdhsa_next_free_sgpr 102
  .amdhsa_accum_offset 256
  .amdhsa_group_segment_fixed_size 0
  .amdhsa_kernarg_size 128
  .amdhsa_user_sgpr_count 2
  .amdhsa_user_sgpr_kernarg_segment_ptr 1
  .amdhsa_system_sgpr_workgroup_id_x 1
.end_amdhsa_kernel
.p2align 6
.amdhsa_kernel gemm2_kernel
  .amdhsa_next_free_vgpr 256
  .amdhsa_next_free_sgpr 102
  .amdhsa_accum_offset 256
  .amdhsa_group_segment_fixed_size 0
  .amdhsa_kernarg_size 128
  .amdhsa_user_sgpr_count 2
  .amdhsa_user_sgpr_kernarg_segment_ptr 1
  .amdhsa_system_sgpr_workgroup_id_x 1
.end_amdhsa_kernel
```
